```python
import torch

def _softmax(x, axis=-1):
    return torch.softmax(x, dim=axis)
def _gelu(x):
    return torch.nn.functional.gelu(x, approximate="tanh")
def _silu(x):
    return torch.nn.functional.silu(x)
def _sigmoid(x):
    return torch.sigmoid(x)
def _layernorm(x, axis=-1, eps=1e-5):
    m = x.mean(dim=axis, keepdim=True)
    v = x.var(dim=axis, keepdim=True, unbiased=False)
    return (x - m) / torch.sqrt(v + eps)
def _scatter_add(tgt, idx, src, axis=0):
    return tgt.clone().index_add_(axis, idx, src)
def _segment_sum(src, seg, n):
    out = torch.zeros((n,) + src.shape[1:], dtype=src.dtype)
    return out.index_add_(0, seg, src)
def _pad(x, pw):
    flat = tuple(v for pair in reversed(pw) for v in pair)
    return torch.nn.functional.pad(x, flat)

kernel_name = 'interleave_layers__spectral_gfnet__grouped_kv_mqa__prompt'

def setup_inputs():

    _w = (lambda a: (lambda t: t.to(torch.bfloat16) if t.is_floating_point() else t)(torch.as_tensor(a)))
    def _A_setup():
        B, S, D = 1, 2048, 512
        Df = D // 2 + 1
        return {
            "x": _w((lambda *s: torch.randn(*s, dtype=torch.bfloat16) * 0.05)(B, S, D)),
            "w_r": _w((lambda *s: torch.randn(*s, dtype=torch.bfloat16) * 0.8)(S, Df) * 0.02),
            "w_i": _w((lambda *s: torch.randn(*s, dtype=torch.bfloat16) * 0.8)(S, Df) * 0.02),
        }
    _A_in = _A_setup()

    def _B_setup():
        B, S, D, H = 1, 2048, 512, 32
        Dh = D // H
        return {
            "x": _w((lambda *s: torch.randn(*s, dtype=torch.bfloat16) * 0.05)(B, S, D)),
            "wq": _w((lambda *s: torch.randn(*s, dtype=torch.bfloat16) * 0.05)(D, H * Dh)),
            "wk": _w((lambda *s: torch.randn(*s, dtype=torch.bfloat16) * 0.05)(D, Dh)),
            "wv": _w((lambda *s: torch.randn(*s, dtype=torch.bfloat16) * 0.05)(D, Dh)),
            "wo": _w((lambda *s: torch.randn(*s, dtype=torch.bfloat16) * 0.05)(H * Dh, D)),
        }
    _B_in = _B_setup()

    return {
        "A_x": _A_in["x"],
        "A_w_r": _A_in["w_r"],
        "A_w_i": _A_in["w_i"],
        "B_x": _B_in["x"],
        "B_wq": _B_in["wq"],
        "B_wk": _B_in["wk"],
        "B_wv": _B_in["wv"],
        "B_wo": _B_in["wo"],
    }

def reference(A_x, A_w_r, A_w_i, B_x, B_wq, B_wk, B_wv, B_wo):
    def _A_ref(x, w_r, w_i):
        B, S, D = x.shape
        X = (lambda x, axes=(-2,-1): torch.fft.rfft2(x.float(), dim=axes))(x, axes=(-2, -1))
        W = w_r + 1j * w_i
        X = X * W
        y = (lambda x, s, axes=(-2,-1): torch.fft.irfft2(x, s=s, dim=axes).to(torch.bfloat16))(X, (S, D), axes=(-2, -1))
        return y

    def _B_ref(x, wq, wk, wv, wo):
        B, S, D = x.shape
        H = 32
        Dh = D // H
        q = (lambda x, *d: x.permute(*d))((x @ wq).reshape(B, S, H, Dh), 0, 2, 1, 3)
        k = x @ wk
        v = x @ wv
        scores = torch.einsum("bhqd,bkd->bhqk", q, k) * (Dh ** -0.5)
        p = _softmax(scores, axis=-1)
        o = torch.einsum("bhqk,bkd->bhqd", p, v)
        return (lambda x, *d: x.permute(*d))(o, 0, 2, 1, 3).reshape(B, S, H * Dh) @ wo

    x = A_x
    x = x + _A_ref(_layernorm(x, axis=-1), A_w_r, A_w_i)
    x = x + _B_ref(_layernorm(x, axis=-1), B_wq, B_wk, B_wv, B_wo)
    x = x + _A_ref(_layernorm(x, axis=-1), A_w_r, A_w_i)
    x = x + _B_ref(_layernorm(x, axis=-1), B_wq, B_wk, B_wv, B_wo)
    return x
```

```asm
; @launch kernel=s0_kernel grid=(388,1,1) block=(384,1,1) lds=28992
; @launch kernel=m_kernel grid=(256,1,1) block=(512,1,1) lds=147712
.amdgcn_target "amdgcn-amd-amdhsa--gfx950"
.text
.globl s0_kernel
.p2align 12
.type s0_kernel,@function
s0_kernel:
S0_COMMON:
    s_load_dwordx16 s[4:19], s[0:1], 0
    s_load_dwordx2 s[20:21], s[0:1], 80
    v_lshrrev_b32 v1, 6, v0
    v_and_b32 v0, 63, v0
    v_readfirstlane_b32 s3, v1
    v_and_b32 v2, 15, v0
    v_lshrrev_b32 v3, 4, v0
    s_mov_b32 s22, 0x1d22000
    s_mov_b32 s23, 0x20000
    s_mov_b32 s27, s23
    s_cmp_ge_u32 s2, 388
    s_cbranch_scc1 S0_END
    s_movk_i32 s28, -4
    s_cmp_lt_u32 s2, 208
    s_cselect_b32 s28, 180, s28
    s_cmp_lt_u32 s2, 204
    s_cselect_b32 s28, -136, s28
    s_cmp_lt_u32 s2, 136
    s_cselect_b32 s28, 68, s28
    s_add_u32 s2, s2, s28
    s_sub_u32 s31, s2, 68
    s_sub_u32 s45, s2, 132
    s_cmp_eq_u32 s3, 5
    s_cbranch_scc1 S0_W5
    s_lshl_b32 s32, s3, 11
    s_mov_b32 m0, s32
    s_mov_b32 s34, 0x3d800000
    s_cmp_lt_u32 s2, 68
    s_cbranch_scc1 S0_QP
    s_and_b32 s28, s45, 7
    s_lshl_b32 s30, s28, 5
    s_lshr_b32 s29, s45, 3
    s_add_u32 s30, s30, s29
    s_and_b32 s28, s30, 0xb0
    s_and_b32 s29, s30, 48
    s_add_u32 s28, s28, s29
    s_and_b32 s29, s30, 15
    s_lshl3_add_u32 s28, s28, s29
    s_bfe_u32 s29, s30, 0x10006
    s_lshl4_add_u32 s28, s29, s28
    s_lshl_b32 s29, s31, 3
    s_cmp_lt_u32 s2, 132
    s_cselect_b32 s28, s29, s28
    s_cselect_b32 s29, 10, 15
    s_cselect_b32 s26, 8, 32
    s_lshl_b32 s28, s28, 10
    s_lshl_b32 s26, s26, 16
    s_cmp_lg_u32 s3, 4
    s_cbranch_scc1 S0_XP
    v_and_b32 v5, 7, v0
    v_lshlrev_b32 v4, s29, v5
    v_and_b32 v6, 8, v0
    v_lshl_add_u32 v4, v6, 3, v4
    v_lshl_add_u32 v4, v3, 4, v4
    s_cmp_lt_u32 s2, 132
    s_waitcnt lgkmcnt(0)
    s_cselect_b32 s24, s18, s4
    s_cselect_b32 s25, s19, s5
    buffer_load_dwordx4 v[8:11], v4, s[24:27], s28 offen offset:0
    buffer_load_dwordx4 v[12:15], v4, s[24:27], s28 offen offset:128
    buffer_load_dwordx4 v[16:19], v4, s[24:27], s28 offen offset:256
    buffer_load_dwordx4 v[20:23], v4, s[24:27], s28 offen offset:384
    buffer_load_dwordx4 v[24:27], v4, s[24:27], s28 offen offset:512
    buffer_load_dwordx4 v[28:31], v4, s[24:27], s28 offen offset:640
    buffer_load_dwordx4 v[32:35], v4, s[24:27], s28 offen offset:768
    buffer_load_dwordx4 v[36:39], v4, s[24:27], s28 offen offset:896
    s_bfe_u32 s36, s45, 0x50003
    s_mul_i32 s36, s36, 65792
    s_and_b32 s37, s45, 7
    s_lshl_b32 s37, s37, 13
    s_add_u32 s36, s36, s37
    s_add_u32 s36, s36, 0x240000
    s_add_u32 s37, s36, 4096
    v_lshlrev_b32 v52, 4, v0
    v_mov_b32 v56, -1
    v_mov_b32 v57, -1
    v_mov_b32 v58, -1
    v_mov_b32 v59, -1
    buffer_store_dwordx4 v[56:59], v52, s[20:23], s36 offen offset:0
    buffer_store_dwordx4 v[56:59], v52, s[20:23], s36 offen offset:1024
    buffer_store_dwordx4 v[56:59], v52, s[20:23], s36 offen offset:2048
    buffer_store_dwordx4 v[56:59], v52, s[20:23], s36 offen offset:3072
    buffer_store_dwordx4 v[56:59], v52, s[20:23], s37 offen offset:0
    buffer_store_dwordx4 v[56:59], v52, s[20:23], s37 offen offset:1024
    buffer_store_dwordx4 v[56:59], v52, s[20:23], s37 offen offset:2048
    buffer_store_dwordx4 v[56:59], v52, s[20:23], s37 offen offset:3072
    s_branch S0_STAT
S0_W5:
    s_getpc_b64 s[40:41]
S0_PC:
    s_sub_u32 s40, s40, S0_PC-s0_kernel
    s_subb_u32 s41, s41, 0
    s_mov_b32 s42, code_end-s0_kernel
    s_mov_b32 s43, s23
    s_sub_u32 s44, s2, 0
    s_lshr_b32 s44, s44, 3
    s_and_b32 s44, s44, 15
    s_lshl_b32 s44, s44, 12
    v_lshlrev_b32 v1, 6, v0
    buffer_load_dword v60, v1, s[40:43], s44 offen
    s_sub_u32 s28, s45, 120
    s_cmp_lt_u32 s28, 132
    s_cbranch_scc1 S0_E1
S0_WX:
    s_cmp_ge_u32 s2, 66
    s_cbranch_scc1 S0_WY
    s_lshl1_add_u32 s45, s2, s3
    s_add_u32 s45, s45, 116
    s_movk_i32 s2, 200
    s_mov_b32 s43, s23
S0_WY:
    s_cmp_lt_u32 s2, 68
    s_cbranch_scc0 S0_W5B
S0_E1:
    s_endpgm
S0_QP:
    s_cmp_eq_u32 s3, 4
    s_cbranch_scc1 S0_WX
    s_and_b32 s28, s2, 7
    s_lshr_b32 s29, s2, 3
    s_lshl3_add_u32 s28, s28, s29
    s_and_b32 s29, s2, 1
    s_cmp_ge_u32 s2, 64
    s_cselect_b32 s31, s2, s28
    s_cselect_b32 s28, s29, s28
    s_cselect_b32 s29, 5, 10
    s_cselect_b32 s34, s34, 0x3cb8aa3b
    s_lshl_b32 s26, 0x200, s29
    s_lshl_b32 s33, s3, s29
    s_lshl4_add_u32 s28, s28, s33
    s_lshr_b32 s33, s26, 1
    s_add_u32 s29, s29, 2
    v_lshlrev_b32 v4, s29, v0
    s_and_b32 s30, s3, 1
    v_lshl_add_u32 v91, s30, 4, v2
    s_branch S0_J
S0_XP:
    s_lshl_b32 s33, s3, s29
    s_lshl1_add_u32 s28, s33, s28
    s_lshl_b32 s33, 1, s29
    v_lshlrev_b32 v4, 4, v0
    v_mov_b32 v91, v2
S0_J:
    s_add_u32 s33, s33, s28
    v_lshlrev_b32 v6, 3, v91
    v_cvt_f32_u32 v91, v91
    v_cvt_f32_u32 v92, v3
    v_mul_f32 v92, 4.0, v92
    v_mul_f32 v93, 0x3d000000, v91
    v_mul_f32 v94, v92, v93
    v_lshlrev_b32 v95, 31, v0
    v_lshrrev_b32 v96, 16, v95
    v_or_b32 v95, v95, v96
    v_fmamk_f32 v60, v93, 0x00000000, v94
    v_fmamk_f32 v61, v93, 0x3f800000, v94
    v_fmamk_f32 v62, v93, 0x40000000, v94
    v_fmamk_f32 v63, v93, 0x40400000, v94
    v_cos_f32 v64, v60
    v_sin_f32 v68, v60
    v_cos_f32 v65, v61
    v_sin_f32 v69, v61
    v_cos_f32 v66, v62
    v_sin_f32 v70, v62
    v_cos_f32 v67, v63
    v_sin_f32 v71, v63
    v_mul_f32 v93, 0x3d800000, v93
    v_mul_f32 v94, 0x3d800000, v94
    v_cvt_pk_bf16_f32 v8, v64, v65
    v_cvt_pk_bf16_f32 v12, -v68, -v69
    v_cvt_pk_bf16_f32 v9, v66, v67
    v_cvt_pk_bf16_f32 v13, -v70, -v71
    v_fmamk_f32 v60, v93, 0x00000000, v94
    v_fmamk_f32 v61, v93, 0x3f800000, v94
    v_fmamk_f32 v62, v93, 0x40000000, v94
    v_fmamk_f32 v63, v93, 0x40400000, v94
    v_xor_b32 v10, v95, v8
    v_xor_b32 v11, v95, v9
    v_xor_b32 v14, v95, v12
    v_xor_b32 v15, v95, v13
    v_xor_b32 v16, 0x80000000, v8
    v_xor_b32 v17, 0x80000000, v9
    v_xor_b32 v18, 0x80000000, v10
    v_xor_b32 v19, 0x80000000, v11
    v_xor_b32 v20, 0x80000000, v12
    v_xor_b32 v21, 0x80000000, v13
    v_xor_b32 v22, 0x80000000, v14
    s_cmp_lt_u32 s2, 132
    s_waitcnt lgkmcnt(0)
    s_cselect_b64 s[24:25], s[18:19], s[4:5]
    s_cmp_lt_u32 s2, 68
    s_cselect_b64 s[24:25], s[16:17], s[24:25]
    s_cmp_lt_u32 s2, 66
    s_cselect_b64 s[24:25], s[14:15], s[24:25]
    s_cmp_lt_u32 s2, 64
    s_cselect_b64 s[24:25], s[12:13], s[24:25]
    buffer_load_dwordx4 v4, s[24:27], s28 offen lds
    s_add_u32 m0, m0, 1024
    s_nop 0
    buffer_load_dwordx4 v4, s[24:27], s33 offen lds
    v_xor_b32 v23, 0x80000000, v15
    v_fmamk_f32 v94, v92, 0x3d000000, v94
    v_add_f32 v93, 0x3d000000, v93
    v_fmamk_f32 v64, v93, 0x00000000, v94
    v_fmamk_f32 v65, v93, 0x3f800000, v94
    v_fmamk_f32 v66, v93, 0x40000000, v94
    v_fmamk_f32 v67, v93, 0x40400000, v94
    v_cos_f32 v24, v60
    v_sin_f32 v28, v60
    v_cos_f32 v25, v61
    v_sin_f32 v29, v61
    v_cos_f32 v26, v62
    v_sin_f32 v30, v62
    v_cos_f32 v27, v63
    v_sin_f32 v31, v63
    v_cos_f32 v32, v64
    v_sin_f32 v36, v64
    v_cos_f32 v33, v65
    v_sin_f32 v37, v65
    v_cos_f32 v34, v66
    v_sin_f32 v38, v66
    v_cos_f32 v35, v67
    v_sin_f32 v39, v67
    v_lshrrev_b32 v93, 1, v2
    v_cvt_f32_u32 v93, v93
    v_mul_f32 v93, 0x3d800000, v93
    v_ashrrev_i32 v94, 31, v95
    v_and_b32 v94, 0x3e800000, v94
    v_fma_f32 v94, v92, v93, v94
    v_fmamk_f32 v68, v93, 0x00000000, v94
    v_fmamk_f32 v69, v93, 0x3f800000, v94
    v_fmamk_f32 v70, v93, 0x40000000, v94
    v_fmamk_f32 v71, v93, 0x40400000, v94
    v_cos_f32 v72, v68
    v_sin_f32 v76, v68
    v_cos_f32 v73, v69
    v_sin_f32 v77, v69
    v_cos_f32 v74, v70
    v_sin_f32 v78, v70
    v_cos_f32 v75, v71
    v_sin_f32 v79, v71
    v_mul_f32 v24, s34, v24
    v_mul_f32 v25, s34, v25
    v_mul_f32 v26, s34, v26
    v_mul_f32 v27, s34, v27
    v_mul_f32 v28, s34, v28
    v_mul_f32 v29, s34, v29
    v_mul_f32 v30, s34, v30
    v_mul_f32 v31, s34, v31
    v_mul_f32 v32, s34, v32
    v_mul_f32 v33, s34, v33
    v_mul_f32 v34, s34, v34
    v_mul_f32 v35, s34, v35
    v_mul_f32 v36, s34, v36
    v_mul_f32 v37, s34, v37
    v_mul_f32 v38, s34, v38
    v_mul_f32 v39, s34, v39
    v_cvt_pk_bf16_f32 v40, v72, v76
    v_cvt_pk_bf16_f32 v41, v73, v77
    v_cvt_pk_bf16_f32 v42, v74, v78
    v_cvt_pk_bf16_f32 v43, v75, v79
    s_cmp_lt_u32 s2, 68
    s_cbranch_scc1 S0_Q
    v_lshl_add_u32 v5, v0, 3, s32
    s_mul_i32 s32, s3, 5120
    s_add_u32 s32, s32, 8192
    v_mul_u32_u24 v7, 640, v3
    v_add3_u32 v6, v6, v7, s32
    v_add_u32 v7, 2560, v6
    s_mul_i32 s32, s3, 320
    s_add_u32 s32, s32, 8192
    v_lshl_add_u32 v1, v0, 2, s32
    v_cmp_gt_u32 vcc, 8200, v1
    v_add_u32 v107, 256, v1
    s_cmp_lt_u32 s2, 132
    v_cndmask_b32 v107, v1, v107, vcc
    s_cbranch_scc1 S0_AO
    v_lshrrev_b32 v4, 1, v0
    v_mul_u32_u24 v4, 8320, v4
    v_and_b32 v92, 1, v0
    v_lshl_add_u32 v4, v92, 4, v4
    s_mul_i32 s35, s3, 266240
    s_lshl_b32 s32, s30, 5
    s_add_u32 s35, s35, s32
    s_add_u32 s36, s35, 1064960
    s_branch S0_AX
S0_AO:
    v_lshlrev_b32 v4, 4, v2
    v_lshl_add_u32 v4, v3, 11, v4
    s_lshr_b32 s35, s31, 3
    s_lshl_b32 s35, s35, 16
    s_and_b32 s32, s31, 7
    s_lshl_b32 s32, s32, 8
    s_add_u32 s35, s35, s32
    s_lshl_b32 s32, s3, 13
    s_add_u32 s35, s35, s32
    s_add_u32 s35, s35, 0xc00000
    s_add_u32 s36, s35, 0x8000
S0_AX:
    s_waitcnt vmcnt(1)
    ds_read_b64_tr_b16 v[44:45], v5 offset:0
    ds_read_b64_tr_b16 v[46:47], v5 offset:512
    s_waitcnt vmcnt(0)
    ds_read_b64_tr_b16 v[48:49], v5 offset:1024
    ds_read_b64_tr_b16 v[50:51], v5 offset:1536
    s_waitcnt lgkmcnt(2)
    v_mfma_f32_16x16x32_bf16 v[60:63], v[44:47], v[8:11], 0
    v_mfma_f32_16x16x32_bf16 v[64:67], v[44:47], v[12:15], 0
    v_mfma_f32_16x16x32_bf16 v[68:71], v[44:47], v[16:19], 0
    v_mfma_f32_16x16x32_bf16 v[72:75], v[44:47], v[20:23], 0
    s_waitcnt lgkmcnt(0)
    v_mfma_f32_16x16x32_bf16 v[76:79], v[48:51], v[8:11], 0
    v_mfma_f32_16x16x32_bf16 v[80:83], v[48:51], v[12:15], 0
    v_mfma_f32_16x16x32_bf16 v[84:87], v[48:51], v[16:19], 0
    v_mfma_f32_16x16x32_bf16 v[88:91], v[48:51], v[20:23], 0
    v_mul_f32 v92, v60, v24
    v_mul_f32 v93, v64, v24
    v_mul_f32 v94, v61, v25
    v_mul_f32 v95, v65, v25
    v_mul_f32 v96, v62, v26
    v_mul_f32 v97, v66, v26
    v_mul_f32 v98, v63, v27
    v_mul_f32 v99, v67, v27
    v_fmac_f32 v92, v64, v28
    v_fma_f32 v93, -v60, v28, v93
    v_fmac_f32 v94, v65, v29
    v_fma_f32 v95, -v61, v29, v95
    v_fmac_f32 v96, v66, v30
    v_fma_f32 v97, -v62, v30, v97
    v_fmac_f32 v98, v67, v31
    v_fma_f32 v99, -v63, v31, v99
    v_cvt_pk_bf16_f32 v44, v92, v93
    v_cvt_pk_bf16_f32 v45, v94, v95
    v_cvt_pk_bf16_f32 v46, v96, v97
    v_cvt_pk_bf16_f32 v47, v98, v99
    s_nop 1
    v_mfma_f32_16x16x32_bf16 v[60:63], v[40:43], v[44:47], 0
    v_mul_f32 v92, v68, v32
    v_mul_f32 v93, v72, v32
    v_mul_f32 v94, v69, v33
    v_mul_f32 v95, v73, v33
    v_mul_f32 v96, v70, v34
    v_mul_f32 v97, v74, v34
    v_mul_f32 v98, v71, v35
    v_mul_f32 v99, v75, v35
    v_fmac_f32 v92, v72, v36
    v_fma_f32 v93, -v68, v36, v93
    ds_write2_b64 v6, v[60:61], v[62:63] offset0:0 offset1:40
    v_fmac_f32 v94, v73, v37
    v_fma_f32 v95, -v69, v37, v95
    v_fmac_f32 v96, v74, v38
    v_fma_f32 v97, -v70, v38, v97
    v_fmac_f32 v98, v75, v39
    v_fma_f32 v99, -v71, v39, v99
    v_cvt_pk_bf16_f32 v48, v92, v93
    v_cvt_pk_bf16_f32 v49, v94, v95
    v_cvt_pk_bf16_f32 v50, v96, v97
    v_cvt_pk_bf16_f32 v51, v98, v99
    s_nop 1
    v_mfma_f32_16x16x32_bf16 v[68:71], v[40:43], v[48:51], 0
    v_mul_f32 v92, v76, v24
    v_mul_f32 v93, v80, v24
    v_mul_f32 v94, v77, v25
    v_mul_f32 v95, v81, v25
    v_mul_f32 v96, v78, v26
    v_mul_f32 v97, v82, v26
    v_mul_f32 v98, v79, v27
    v_mul_f32 v99, v83, v27
    v_fmac_f32 v92, v80, v28
    v_fma_f32 v93, -v76, v28, v93
    ds_write2_b64 v6, v[68:69], v[70:71] offset0:16 offset1:56
    v_fmac_f32 v94, v81, v29
    v_fma_f32 v95, -v77, v29, v95
    v_fmac_f32 v96, v82, v30
    v_fma_f32 v97, -v78, v30, v97
    v_fmac_f32 v98, v83, v31
    v_fma_f32 v99, -v79, v31, v99
    v_cvt_pk_bf16_f32 v52, v92, v93
    v_cvt_pk_bf16_f32 v53, v94, v95
    v_cvt_pk_bf16_f32 v54, v96, v97
    v_cvt_pk_bf16_f32 v55, v98, v99
    s_nop 1
    v_mfma_f32_16x16x32_bf16 v[76:79], v[40:43], v[52:55], 0
    v_mul_f32 v92, v84, v32
    v_mul_f32 v93, v88, v32
    v_mul_f32 v94, v85, v33
    v_mul_f32 v95, v89, v33
    v_mul_f32 v96, v86, v34
    v_mul_f32 v97, v90, v34
    v_mul_f32 v98, v87, v35
    v_mul_f32 v99, v91, v35
    v_fmac_f32 v92, v88, v36
    v_fma_f32 v93, -v84, v36, v93
    ds_write2_b64 v7, v[76:77], v[78:79] offset0:0 offset1:40
    v_fmac_f32 v94, v89, v37
    v_fma_f32 v95, -v85, v37, v95
    v_fmac_f32 v96, v90, v38
    v_fma_f32 v97, -v86, v38, v97
    v_fmac_f32 v98, v91, v39
    v_fma_f32 v99, -v87, v39, v99
    v_cvt_pk_bf16_f32 v56, v92, v93
    v_cvt_pk_bf16_f32 v57, v94, v95
    v_cvt_pk_bf16_f32 v58, v96, v97
    v_cvt_pk_bf16_f32 v59, v98, v99
    s_nop 1
    v_mfma_f32_16x16x32_bf16 v[84:87], v[40:43], v[56:59], 0
    v_mov_b32 v92, 0
    s_nop 6
    ds_write2_b64 v7, v[84:85], v[86:87] offset0:16 offset1:56
    s_waitcnt lgkmcnt(0)
    s_barrier
    s_cmp_lt_u32 s2, 132
    ds_read_b128 v[44:47], v92 offset:28928
    ds_read_b128 v[48:51], v92 offset:28944
    ds_read2st64_b32 v[60:61], v107 offset0:0 offset1:10
    ds_read2st64_b32 v[62:63], v107 offset0:20 offset1:30
    ds_read2st64_b32 v[64:65], v107 offset0:40 offset1:50
    ds_read2st64_b32 v[66:67], v107 offset0:60 offset1:70
    ds_read2st64_b32 v[68:69], v1 offset0:5 offset1:15
    ds_read2st64_b32 v[70:71], v1 offset0:25 offset1:35
    ds_read2st64_b32 v[72:73], v1 offset0:45 offset1:55
    ds_read2st64_b32 v[74:75], v1 offset0:65 offset1:75
    s_waitcnt lgkmcnt(7)
    v_pk_mul_f32 v[60:61], v[60:61], v[44:45]
    v_cvt_pk_bf16_f32 v76, v60, v61
    s_waitcnt lgkmcnt(6)
    v_pk_mul_f32 v[62:63], v[62:63], v[46:47]
    v_cvt_pk_bf16_f32 v77, v62, v63
    s_waitcnt lgkmcnt(5)
    v_pk_mul_f32 v[64:65], v[64:65], v[48:49]
    v_cvt_pk_bf16_f32 v78, v64, v65
    s_waitcnt lgkmcnt(4)
    v_pk_mul_f32 v[66:67], v[66:67], v[50:51]
    v_cvt_pk_bf16_f32 v79, v66, v67
    buffer_store_dwordx4 v[76:79], v4, s[20:23], s35 offen
    s_waitcnt lgkmcnt(3)
    v_pk_mul_f32 v[68:69], v[68:69], v[44:45]
    v_cvt_pk_bf16_f32 v80, v68, v69
    s_waitcnt lgkmcnt(2)
    v_pk_mul_f32 v[70:71], v[70:71], v[46:47]
    v_cvt_pk_bf16_f32 v81, v70, v71
    s_waitcnt lgkmcnt(1)
    v_pk_mul_f32 v[72:73], v[72:73], v[48:49]
    v_cvt_pk_bf16_f32 v82, v72, v73
    s_waitcnt lgkmcnt(0)
    v_pk_mul_f32 v[74:75], v[74:75], v[50:51]
    v_cvt_pk_bf16_f32 v83, v74, v75
    buffer_store_dwordx4 v[80:83], v4, s[20:23], s36 offen
    s_endpgm
S0_STAT:
    v_lshlrev_b32 v40, 31, v0
    v_or_b32 v40, 0x3f803f80, v40
    v_mov_b32 v41, v40
    v_mov_b32 v42, v40
    v_mov_b32 v43, v40
    v_mul_u32_u24 v6, 2560, v5
    v_lshlrev_b32 v5, 2, v5
    v_mov_b32 v7, 0x3727c5ac
    s_mov_b32 s32, 0xaaaaaaaa
    s_mov_b32 s33, 0xaaaaaaaa
    s_mov_b32 s34, 0xcccccccc
    s_mov_b32 s35, 0xcccccccc
    s_lshl_b32 s39, s30, 5
    s_add_u32 s39, s39, 0xd20000
    s_waitcnt vmcnt(15)
    v_mfma_f32_16x16x32_bf16 v[44:47], v[8:11], v[8:11], 0
    v_mfma_f32_16x16x32_bf16 v[48:51], v[40:43], v[8:11], 0
    s_waitcnt vmcnt(14)
    v_mfma_f32_16x16x32_bf16 v[44:47], v[12:15], v[12:15], v[44:47]
    v_mfma_f32_16x16x32_bf16 v[48:51], v[40:43], v[12:15], v[48:51]
    s_waitcnt vmcnt(13)
    v_mfma_f32_16x16x32_bf16 v[44:47], v[16:19], v[16:19], v[44:47]
    v_mfma_f32_16x16x32_bf16 v[48:51], v[40:43], v[16:19], v[48:51]
    s_waitcnt vmcnt(12)
    v_mfma_f32_16x16x32_bf16 v[44:47], v[20:23], v[20:23], v[44:47]
    v_mfma_f32_16x16x32_bf16 v[48:51], v[40:43], v[20:23], v[48:51]
    s_waitcnt vmcnt(11)
    v_mfma_f32_16x16x32_bf16 v[44:47], v[24:27], v[24:27], v[44:47]
    v_mfma_f32_16x16x32_bf16 v[48:51], v[40:43], v[24:27], v[48:51]
    s_waitcnt vmcnt(10)
    v_mfma_f32_16x16x32_bf16 v[44:47], v[28:31], v[28:31], v[44:47]
    v_mfma_f32_16x16x32_bf16 v[48:51], v[40:43], v[28:31], v[48:51]
    s_waitcnt vmcnt(9)
    v_mfma_f32_16x16x32_bf16 v[44:47], v[32:35], v[32:35], v[44:47]
    v_mfma_f32_16x16x32_bf16 v[48:51], v[40:43], v[32:35], v[48:51]
    s_waitcnt vmcnt(8)
    v_mfma_f32_16x16x32_bf16 v[44:47], v[36:39], v[36:39], v[44:47]
    v_mfma_f32_16x16x32_bf16 v[48:51], v[40:43], v[36:39], v[48:51]
    s_nop 6
    v_cndmask_b32 v44, v44, v45, s[32:33]
    v_cndmask_b32 v46, v46, v47, s[32:33]
    v_cndmask_b32 v44, v44, v46, s[34:35]
    v_add_f32 v48, v48, v48 row_ror:8 row_mask:0xf bank_mask:0xf
    v_add_f32 v49, v49, v49 row_ror:8 row_mask:0xf bank_mask:0xf
    v_mov_b32 v45, v44
    v_mul_f32 v48, 0x3d3504f3, v48
    v_mul_f32 v49, 0x3d3504f3, v49
    v_permlane32_swap_b32 v45, v46
    v_fma_f32 v44, -v48, v48, v44
    s_mov_b64 exec, 0x00f0000f
    ds_write_b64 v6, v[48:49] offset:8448
    s_mov_b64 exec, -1
    s_cmp_lt_u32 s2, 132
    v_add_f32 v44, v46, v44 row_ror:8 row_mask:0xf bank_mask:0xf
    v_fmamk_f32 v44, v44, 0x3b000000, v7
    v_rsq_f32 v45, v44
    s_mov_b64 exec, 0x00f0000f
    s_cbranch_scc0 S0_SX
    v_mov_b32 v45, 1.0
    ds_write_b32 v5, v45 offset:28928
    s_mov_b64 exec, -1
    s_mov_b32 s43, s23
    s_branch S0_SY
S0_SX:
    ds_write_b32 v5, v45 offset:28928
    v_mul_f32 v44, v44, v45
    buffer_store_dword v44, v5, s[20:23], s39 offen
S0_SY:
    s_waitcnt lgkmcnt(0)
    s_barrier
    s_endpgm
S0_W5B:
    s_mov_b32 s55, s23
    s_mov_b32 s50, 0x05040100
    s_mov_b32 s51, 0x07060302
    s_cmp_lt_u32 s2, 132
    s_cbranch_scc1 S0_SO
    v_and_b32 v6, 7, v0
    v_lshrrev_b32 v7, 3, v0
    v_mul_u32_u24 v4, 1028, v6
    v_mul_u32_u24 v57, 32896, v7
    v_add_u32 v57, v57, v4
    v_lshl_add_u32 v4, v7, 4, v4
    v_lshlrev_b32 v5, 4, v6
    v_lshl_add_u32 v58, v7, 2, v5
    v_lshl_add_u32 v5, v7, 16, v5
    s_and_b32 s46, s45, 7
    s_lshr_b32 s47, s45, 6
    s_bfe_u32 s48, s45, 0x10005
    s_bfe_u32 s31, s45, 0x20003
    s_lshl4_add_u32 s32, s46, s47
    s_lshl4_add_u32 s32, s32, s48
    s_mul_i32 s32, s32, 514
    s_add_u32 s49, s32, 512
    s_lshl_b32 s36, s31, 6
    s_add_u32 s36, s36, s48
    s_lshl1_add_u32 s32, s36, s32
    s_add_u32 s33, s32, 32896
    s_add_u32 s34, s32, 65792
    s_add_u32 s35, s32, 98688
    s_lshl3_add_u32 s46, s47, s46
    s_lshl1_add_u32 s46, s46, s48
    s_lshl_b32 s46, s46, 7
    s_add_u32 s46, s46, 0x880000
    s_lshl_b32 s36, s36, 13
    s_add_u32 s36, s36, s46
    s_add_u32 s46, s46, 0x200000
    s_mov_b32 s37, 0x2000
    s_mov_b32 s38, 0x2000
    s_mov_b32 s42, 1052672
    s_mov_b32 s54, s42
    s_waitcnt lgkmcnt(0)
    s_mov_b64 s[40:41], s[6:7]
    s_mov_b64 s[52:53], s[8:9]
    s_and_b32 s31, s45, 0x38
    s_branch S0_SJ
S0_SO:
    v_lshlrev_b32 v4, 4, v0
    v_mov_b32 v57, 0
    v_mov_b32 v58, 0
    s_mov_b32 s46, 0
    s_mov_b32 s49, 0
    v_lshrrev_b32 v5, 2, v0
    v_lshlrev_b32 v5, 12, v5
    v_and_b32 v7, 3, v0
    v_lshl_add_u32 v5, v7, 6, v5
    s_lshl_b32 s32, s31, 13
    s_add_u32 s33, s32, 2048
    s_add_u32 s34, s32, 4096
    s_add_u32 s35, s32, 6144
    s_lshr_b32 s36, s31, 3
    s_lshl_b32 s36, s36, 16
    s_and_b32 s37, s31, 7
    s_lshl_b32 s37, s37, 8
    s_add_u32 s36, s36, s37
    s_add_u32 s36, s36, 0xc80000
    s_mov_b32 s37, 2048
    s_mov_b32 s38, -2032
    s_mov_b32 s42, 524288
    s_mov_b32 s54, 523264
    s_waitcnt lgkmcnt(0)
    s_mov_b64 s[40:41], s[18:19]
    s_add_u32 s52, s18, 1024
    s_addc_u32 s53, s19, 0
    s_mov_b32 s31, 1
S0_SJ:
    buffer_load_dwordx4 v[8:11], v4, s[40:43], s32 offen
    buffer_load_dwordx4 v[12:15], v4, s[52:55], s32 offen
    buffer_load_dwordx4 v[16:19], v4, s[40:43], s33 offen
    buffer_load_dwordx4 v[20:23], v4, s[52:55], s33 offen
    buffer_load_dwordx4 v[24:27], v4, s[40:43], s34 offen
    buffer_load_dwordx4 v[28:31], v4, s[52:55], s34 offen
    buffer_load_dwordx4 v[32:35], v4, s[40:43], s35 offen
    buffer_load_dwordx4 v[36:39], v4, s[52:55], s35 offen
    s_cmp_lg_u32 s31, 0
    s_cbranch_scc1 S0_SZ
    s_mov_b32 exec_hi, 0
    buffer_load_ushort v56, v57, s[40:43], s49 offen
    buffer_load_ushort v59, v57, s[52:55], s49 offen
    s_mov_b64 exec, -1
    s_barrier
    s_mov_b32 exec_hi, 0
    s_waitcnt vmcnt(0)
    v_lshl_or_b32 v56, v59, 16, v56
    buffer_store_dword v56, v58, s[20:23], s46 offen
    s_mov_b64 exec, -1
    s_branch S0_SW
S0_SZ:
    s_barrier
    s_waitcnt vmcnt(0)
S0_SW:
    v_perm_b32 v40, v12, v8, s50
    v_perm_b32 v41, v20, v16, s50
    v_perm_b32 v42, v28, v24, s50
    v_perm_b32 v43, v36, v32, s50
    buffer_store_dwordx4 v[40:43], v5, s[20:23], s36 offen
    s_add_u32 s36, s36, s37
    v_perm_b32 v44, v12, v8, s51
    v_perm_b32 v45, v20, v16, s51
    v_perm_b32 v46, v28, v24, s51
    v_perm_b32 v47, v36, v32, s51
    buffer_store_dwordx4 v[44:47], v5, s[20:23], s36 offen
    s_add_u32 s36, s36, s38
    v_perm_b32 v48, v13, v9, s50
    v_perm_b32 v49, v21, v17, s50
    v_perm_b32 v50, v29, v25, s50
    v_perm_b32 v51, v37, v33, s50
    buffer_store_dwordx4 v[48:51], v5, s[20:23], s36 offen
    s_add_u32 s36, s36, s37
    v_perm_b32 v52, v13, v9, s51
    v_perm_b32 v53, v21, v17, s51
    v_perm_b32 v54, v29, v25, s51
    v_perm_b32 v55, v37, v33, s51
    buffer_store_dwordx4 v[52:55], v5, s[20:23], s36 offen
    s_add_u32 s36, s36, s38
    v_perm_b32 v40, v14, v10, s50
    v_perm_b32 v41, v22, v18, s50
    v_perm_b32 v42, v30, v26, s50
    v_perm_b32 v43, v38, v34, s50
    buffer_store_dwordx4 v[40:43], v5, s[20:23], s36 offen
    s_add_u32 s36, s36, s37
    v_perm_b32 v44, v14, v10, s51
    v_perm_b32 v45, v22, v18, s51
    v_perm_b32 v46, v30, v26, s51
    v_perm_b32 v47, v38, v34, s51
    buffer_store_dwordx4 v[44:47], v5, s[20:23], s36 offen
    s_add_u32 s36, s36, s38
    v_perm_b32 v48, v15, v11, s50
    v_perm_b32 v49, v23, v19, s50
    v_perm_b32 v50, v31, v27, s50
    v_perm_b32 v51, v39, v35, s50
    buffer_store_dwordx4 v[48:51], v5, s[20:23], s36 offen
    s_add_u32 s36, s36, s37
    v_perm_b32 v52, v15, v11, s51
    v_perm_b32 v53, v23, v19, s51
    v_perm_b32 v54, v31, v27, s51
    v_perm_b32 v55, v39, v35, s51
    buffer_store_dwordx4 v[52:55], v5, s[20:23], s36 offen
    s_endpgm
S0_Q:
    s_lshr_b32 s32, s3, 1
    s_lshl_b32 s33, s32, 3
    v_lshl_add_u32 v5, v0, 4, s33
    s_mul_i32 s32, s32, 10368
    v_mul_u32_u24 v7, 640, v3
    v_add3_u32 v6, v6, v7, s32
    v_mov_b32 v7, s32
    v_and_b32 v92, 7, v0
    v_lshrrev_b32 v93, 3, v0
    v_lshlrev_b32 v4, 8, v93
    v_lshl_add_u32 v4, v92, 4, v4
    v_mul_u32_u24 v1, 2592, v92
    v_and_b32 v92, 3, v93
    v_lshl_add_u32 v1, v92, 4, v1
    v_and_b32 v92, 32, v0
    v_lshl_add_u32 v1, v92, 2, v1
    s_mul_i32 s32, s3, 320
    v_add_u32 v1, s32, v1
    s_lshr_b32 s35, s31, 1
    s_lshl_b32 s35, s35, 14
    s_and_b32 s32, s31, 1
    s_lshl_b32 s32, s32, 7
    s_add_u32 s35, s35, s32
    s_lshl_b32 s32, s3, 11
    s_add_u32 s35, s35, s32
    s_add_u32 s35, s35, 0xa90000
    s_add_u32 s36, s35, 0x2000
    v_mov_b32 v107, 0x3f3504f3
    v_mul_f32 v107, s34, v107
    s_xor_b32 s38, s30, 1
    s_mov_b32 s39, 0
    s_waitcnt vmcnt(0)
    s_barrier
    ds_read_b64_tr_b16 v[44:45], v5 offset:0
    ds_read_b64_tr_b16 v[46:47], v5 offset:1024
    ds_read_b64_tr_b16 v[48:49], v5 offset:2048
    ds_read_b64_tr_b16 v[50:51], v5 offset:3072
    ds_read_b64_tr_b16 v[52:53], v5 offset:4096
    ds_read_b64_tr_b16 v[54:55], v5 offset:5120
    ds_read_b64_tr_b16 v[56:57], v5 offset:6144
    ds_read_b64_tr_b16 v[58:59], v5 offset:7168
    s_waitcnt lgkmcnt(6)
    v_mfma_f32_16x16x32_bf16 v[60:63], v[44:47], v[8:11], 0
    v_mfma_f32_16x16x32_bf16 v[64:67], v[44:47], v[12:15], 0
    s_waitcnt lgkmcnt(4)
    v_mfma_f32_16x16x32_bf16 v[68:71], v[48:51], v[8:11], 0
    v_mfma_f32_16x16x32_bf16 v[72:75], v[48:51], v[12:15], 0
    s_waitcnt lgkmcnt(2)
    v_mfma_f32_16x16x32_bf16 v[76:79], v[52:55], v[8:11], 0
    v_mfma_f32_16x16x32_bf16 v[80:83], v[52:55], v[12:15], 0
    s_waitcnt lgkmcnt(0)
    v_mfma_f32_16x16x32_bf16 v[84:87], v[56:59], v[8:11], 0
    v_mfma_f32_16x16x32_bf16 v[88:91], v[56:59], v[12:15], 0
    v_mul_f32 v92, v60, v24
    v_mul_f32 v93, v64, v24
    v_mul_f32 v94, v68, v25
    v_mul_f32 v95, v72, v25
    v_mul_f32 v96, v76, v26
    v_mul_f32 v97, v80, v26
    s_nop 0
    v_mul_f32 v98, v84, v27
    v_mul_f32 v99, v88, v27
    v_fmac_f32 v92, v64, v28
    v_fma_f32 v93, -v60, v28, v93
    v_fmac_f32 v94, v72, v29
    v_fma_f32 v95, -v68, v29, v95
    v_fmac_f32 v96, v80, v30
    v_fma_f32 v97, -v76, v30, v97
    v_fmac_f32 v98, v88, v31
    v_fma_f32 v99, -v84, v31, v99
    v_cvt_pk_bf16_f32 v44, v92, v93
    v_cvt_pk_bf16_f32 v45, v94, v95
    v_cvt_pk_bf16_f32 v46, v96, v97
    v_cvt_pk_bf16_f32 v47, v98, v99
    v_sub_f32 v100, v60, v68
    v_sub_f32 v104, v76, v84
    v_mfma_f32_16x16x32_bf16 v[16:19], v[40:43], v[44:47], 0
    v_add_f32 v100, v100, v104
    v_mul_f32 v100, v107, v100
    v_mul_f32 v92, v61, v24
    v_mul_f32 v93, v65, v24
    v_mul_f32 v94, v69, v25
    v_mul_f32 v95, v73, v25
    v_mul_f32 v96, v77, v26
    v_mul_f32 v97, v81, v26
    v_mul_f32 v98, v85, v27
    v_mul_f32 v99, v89, v27
    v_fmac_f32 v92, v65, v28
    v_fma_f32 v93, -v61, v28, v93
    v_cndmask_b32 v16, v16, 0, s[38:39]
    ds_write_b64 v6, v[16:17] offset:8192
    ds_write_b64 v6, v[18:19] offset:8512
    v_fmac_f32 v94, v73, v29
    v_fma_f32 v95, -v69, v29, v95
    v_fmac_f32 v96, v81, v30
    v_fma_f32 v97, -v77, v30, v97
    v_fmac_f32 v98, v89, v31
    v_fma_f32 v99, -v85, v31, v99
    v_cvt_pk_bf16_f32 v48, v92, v93
    v_cvt_pk_bf16_f32 v49, v94, v95
    v_cvt_pk_bf16_f32 v50, v96, v97
    v_cvt_pk_bf16_f32 v51, v98, v99
    v_sub_f32 v101, v61, v69
    v_sub_f32 v104, v77, v85
    v_mfma_f32_16x16x32_bf16 v[20:23], v[40:43], v[48:51], 0
    v_add_f32 v101, v101, v104
    v_mul_f32 v101, v107, v101
    v_mul_f32 v92, v62, v24
    v_mul_f32 v93, v66, v24
    v_mul_f32 v94, v70, v25
    v_mul_f32 v95, v74, v25
    v_mul_f32 v96, v78, v26
    v_mul_f32 v97, v82, v26
    v_mul_f32 v98, v86, v27
    v_mul_f32 v99, v90, v27
    v_fmac_f32 v92, v66, v28
    v_fma_f32 v93, -v62, v28, v93
    v_cndmask_b32 v20, v20, 0, s[38:39]
    ds_write_b64 v6, v[20:21] offset:10784
    ds_write_b64 v6, v[22:23] offset:11104
    v_fmac_f32 v94, v74, v29
    v_fma_f32 v95, -v70, v29, v95
    v_fmac_f32 v96, v82, v30
    v_fma_f32 v97, -v78, v30, v97
    v_fmac_f32 v98, v90, v31
    v_fma_f32 v99, -v86, v31, v99
    v_cvt_pk_bf16_f32 v52, v92, v93
    v_cvt_pk_bf16_f32 v53, v94, v95
    v_cvt_pk_bf16_f32 v54, v96, v97
    v_cvt_pk_bf16_f32 v55, v98, v99
    v_sub_f32 v102, v62, v70
    v_sub_f32 v104, v78, v86
    v_mfma_f32_16x16x32_bf16 v[16:19], v[40:43], v[52:55], 0
    v_add_f32 v102, v102, v104
    v_mul_f32 v102, v107, v102
    v_mul_f32 v92, v63, v24
    v_mul_f32 v93, v67, v24
    v_mul_f32 v94, v71, v25
    v_mul_f32 v95, v75, v25
    v_mul_f32 v96, v79, v26
    v_mul_f32 v97, v83, v26
    v_mul_f32 v98, v87, v27
    v_mul_f32 v99, v91, v27
    v_fmac_f32 v92, v67, v28
    v_fma_f32 v93, -v63, v28, v93
    v_cndmask_b32 v16, v16, 0, s[38:39]
    ds_write_b64 v6, v[16:17] offset:13376
    ds_write_b64 v6, v[18:19] offset:13696
    v_fmac_f32 v94, v75, v29
    v_fma_f32 v95, -v71, v29, v95
    v_fmac_f32 v96, v83, v30
    v_fma_f32 v97, -v79, v30, v97
    v_fmac_f32 v98, v91, v31
    v_fma_f32 v99, -v87, v31, v99
    v_cvt_pk_bf16_f32 v56, v92, v93
    v_cvt_pk_bf16_f32 v57, v94, v95
    v_cvt_pk_bf16_f32 v58, v96, v97
    v_cvt_pk_bf16_f32 v59, v98, v99
    v_sub_f32 v103, v63, v71
    v_sub_f32 v104, v79, v87
    v_mfma_f32_16x16x32_bf16 v[20:23], v[40:43], v[56:59], 0
    v_add_f32 v103, v103, v104
    v_mul_f32 v103, v107, v103
    s_nop 5
    v_cndmask_b32 v20, v20, 0, s[38:39]
    ds_write_b64 v6, v[20:21] offset:15968
    ds_write_b64 v6, v[22:23] offset:16288
    s_cmp_lg_u32 s30, 0
    s_cbranch_scc1 S0_QB
    s_mov_b32 exec_lo, 0x00010001
    s_mov_b32 exec_hi, 0x00010001
    ds_add_f32 v7, v100 offset:8196
    ds_add_f32 v7, v101 offset:10788
    ds_add_f32 v7, v102 offset:13380
    ds_add_f32 v7, v103 offset:15972
    s_mov_b64 exec, -1
S0_QB:
    s_waitcnt lgkmcnt(0)
    s_barrier
    ds_read_b128 v[60:63], v1 offset:8192
    ds_read_b128 v[64:67], v1 offset:8256
    ds_read_b128 v[68:71], v1 offset:9472
    ds_read_b128 v[72:75], v1 offset:9536
    s_waitcnt lgkmcnt(3)
    v_cvt_pk_bf16_f32 v76, v60, v61
    v_cvt_pk_bf16_f32 v77, v62, v63
    s_waitcnt lgkmcnt(2)
    v_cvt_pk_bf16_f32 v78, v64, v65
    v_cvt_pk_bf16_f32 v79, v66, v67
    buffer_store_dwordx4 v[76:79], v4, s[20:23], s35 offen
    s_waitcnt lgkmcnt(1)
    v_cvt_pk_bf16_f32 v80, v68, v69
    v_cvt_pk_bf16_f32 v81, v70, v71
    s_waitcnt lgkmcnt(0)
    v_cvt_pk_bf16_f32 v82, v72, v73
    v_cvt_pk_bf16_f32 v83, v74, v75
    buffer_store_dwordx4 v[80:83], v4, s[20:23], s36 offen
S0_END:
    s_endpgm
.globl m_kernel
.p2align 12
.type m_kernel,@function
m_kernel:
    s_load_dwordx2 s[20:21], s[0:1], 80
    v_lshrrev_b32 v1, 6, v0
    v_and_b32 v0, 63, v0
    v_readfirstlane_b32 s3, v1
    s_cmp_ge_u32 s2, 256
    s_cbranch_scc1 M_END
    s_mov_b64 exec, -1
    v_and_b32 v2, 15, v0
    v_lshrrev_b32 v3, 4, v0
    s_and_b32 s24, s2, 7
    s_lshl_b32 s24, s24, 5
    s_lshr_b32 s42, s2, 3
    s_add_u32 s42, s42, s24
    s_mov_b32 s22, 0x1d22000
    s_mov_b32 s23, 0x20000
    s_mov_b32 s40, 0
    s_mov_b32 s41, 20000
    s_cmp_lt_u32 s3, 4
    s_cbranch_scc1 CW
    s_setprio 3
    s_sub_u32 s6, s3, 4
    s_lshl_b32 s19, s6, 11
    v_and_b32 v4, 31, v0
    v_lshlrev_b32 v4, 5, v4
    v_lshrrev_b32 v5, 5, v0
    v_lshl_add_u32 v4, v5, 4, v4
    s_mul_i32 s12, s42, 8320
    s_add_u32 s12, s12, s19
    s_add_u32 s13, s19, 0xd20000
    s_mov_b32 m0, s19
    s_add_u32 s14, s19, 8192
    s_waitcnt lgkmcnt(0)
    buffer_load_dwordx4 v4, s[20:23], s12 offen lds
    buffer_load_dwordx4 v4, s[20:23], s12 offen offset:1024 lds
    s_mov_b32 m0, s14
    s_nop 0
    buffer_load_dwordx4 v4, s[20:23], s13 offen lds
    buffer_load_dwordx4 v4, s[20:23], s13 offen offset:1024 lds
    s_branch H1
CW:
    s_setprio 2
    v_and_b32 v10, 31, v0
    v_lshrrev_b32 v212, 5, v0
    v_and_b32 v4, 1, v0
    v_lshlrev_b32 v4, 7, v4
    v_lshl_add_u32 v4, v3, 8, v4
    v_and_b32 v11, 14, v0
    v_lshl_add_u32 v4, v11, 3, v4
    s_lshl_b32 s24, s3, 11
    s_cmp_eq_u32 s42, 0
    s_cselect_b32 s9, 0x100, s42
    s_lshl_b32 s9, s9, 13
    s_add_u32 s9, s9, s24
    s_add_u32 s9, s9, 0x880000
    v_lshlrev_b32 v11, 8, v212
    v_lshl_add_u32 v11, v2, 4, v11
    v_and_b32 v5, 1, v3
    v_lshl_add_u32 v6, v5, 9, v11
    v_lshl_add_u32 v11, v5, 3, v11
    v_lshlrev_b32 v10, 4, v10
    v_lshl_add_u32 v10, v212, 10, v10
    s_lshr_b32 s24, s3, 1
    s_lshl_b32 s24, s24, 2
    s_and_b32 s25, s3, 1
    s_add_u32 s5, s24, s25
    s_lshl_b32 s6, s5, 10
    s_lshl_b32 s24, s3, 4
    v_add_u32 v1, s24, v2
    v_cvt_f32_u32 v1, v1
    v_cvt_f32_u32 v228, v3
    v_and_b32 v7, 1, v2
    v_mul_u32_u24 v7, 0x8000, v7
    v_lshl_or_b32 v7, v7, 16, v7
    v_mul_f32 v220, 0x3c800000, v1
    v_mul_f32 v221, 0x41000000, v228
    v_mul_f32 v221, v221, v220
    v_fmamk_f32 v212, v220, 0x00000000, v221
    v_fmamk_f32 v213, v220, 0x3f800000, v221
    v_fmamk_f32 v214, v220, 0x40000000, v221
    v_fmamk_f32 v215, v220, 0x40400000, v221
    v_fmamk_f32 v216, v220, 0x40800000, v221
    v_fmamk_f32 v217, v220, 0x40a00000, v221
    v_fmamk_f32 v218, v220, 0x40c00000, v221
    v_fmamk_f32 v219, v220, 0x40e00000, v221
    v_cos_f32 v148, v212
    v_sin_f32 v164, v212
    v_cos_f32 v149, v213
    v_sin_f32 v165, v213
    v_cos_f32 v150, v214
    v_sin_f32 v166, v214
    v_cos_f32 v151, v215
    v_sin_f32 v167, v215
    v_cos_f32 v152, v216
    v_sin_f32 v168, v216
    v_cos_f32 v153, v217
    v_sin_f32 v169, v217
    v_cos_f32 v154, v218
    v_sin_f32 v170, v218
    v_cos_f32 v155, v219
    v_sin_f32 v171, v219
    s_waitcnt lgkmcnt(0)
    buffer_load_dwordx4 v[108:111], v4, s[20:23], s9 offen offset:0
    buffer_load_dwordx4 v[112:115], v4, s[20:23], s9 offen offset:1024
    v_cvt_pk_bf16_f32 v44, v148, v149
    v_cvt_pk_bf16_f32 v48, v164, v165
    v_cvt_pk_bf16_f32 v52, -v164, -v165
    v_cvt_pk_bf16_f32 v45, v150, v151
    v_cvt_pk_bf16_f32 v49, v166, v167
    v_cvt_pk_bf16_f32 v53, -v166, -v167
    v_cvt_pk_bf16_f32 v46, v152, v153
    v_cvt_pk_bf16_f32 v50, v168, v169
    v_cvt_pk_bf16_f32 v54, -v168, -v169
    v_cvt_pk_bf16_f32 v47, v154, v155
    v_cvt_pk_bf16_f32 v51, v170, v171
    v_cvt_pk_bf16_f32 v55, -v170, -v171
    v_xor_b32 v56, v7, v44
    v_xor_b32 v57, v7, v45
    v_xor_b32 v58, v7, v46
    v_xor_b32 v59, v7, v47
    v_xor_b32 v60, v7, v48
    v_xor_b32 v61, v7, v49
    v_xor_b32 v62, v7, v50
    v_xor_b32 v63, v7, v51
    v_xor_b32 v64, v7, v52
    v_xor_b32 v65, v7, v53
    v_xor_b32 v66, v7, v54
    v_xor_b32 v67, v7, v55
    v_mul_f32 v220, 0x3a000000, v1
    v_mul_f32 v221, 4.0, v228
    v_mul_f32 v222, v221, v220
    s_mov_b32 s24, 0x3cb504f3
    v_fmamk_f32 v212, v220, 0x00000000, v222
    v_fmamk_f32 v213, v220, 0x3f800000, v222
    v_fmamk_f32 v214, v220, 0x40000000, v222
    v_fmamk_f32 v215, v220, 0x40400000, v222
    v_fmamk_f32 v216, v220, 0x41800000, v222
    v_fmamk_f32 v217, v220, 0x41880000, v222
    v_fmamk_f32 v218, v220, 0x41900000, v222
    v_fmamk_f32 v219, v220, 0x41980000, v222
    v_cos_f32 v92, v212
    v_sin_f32 v100, v212
    v_cos_f32 v93, v213
    v_sin_f32 v101, v213
    v_cos_f32 v94, v214
    v_sin_f32 v102, v214
    v_cos_f32 v95, v215
    v_sin_f32 v103, v215
    v_cos_f32 v96, v216
    v_sin_f32 v104, v216
    v_cos_f32 v97, v217
    v_sin_f32 v105, v217
    v_cos_f32 v98, v218
    v_sin_f32 v106, v218
    v_cos_f32 v99, v219
    v_sin_f32 v107, v219
    v_cvt_f32_u32 v220, v2
    v_mul_f32 v220, 0x3d000000, v220
    v_mul_f32 v221, v221, v220
    v_fmamk_f32 v212, v220, 0x00000000, v221
    v_fmamk_f32 v213, v220, 0x3f800000, v221
    v_fmamk_f32 v214, v220, 0x40000000, v221
    v_fmamk_f32 v215, v220, 0x40400000, v221
    v_cos_f32 v180, v212
    v_sin_f32 v184, v212
    v_cos_f32 v181, v213
    v_sin_f32 v185, v213
    v_cos_f32 v182, v214
    v_sin_f32 v186, v214
    v_cos_f32 v183, v215
    v_sin_f32 v187, v215
    v_pk_mul_f32 v[92:93], v[92:93], s[24:25] op_sel_hi:[1,0]
    v_pk_mul_f32 v[94:95], v[94:95], s[24:25] op_sel_hi:[1,0]
    v_pk_mul_f32 v[96:97], v[96:97], s[24:25] op_sel_hi:[1,0]
    v_pk_mul_f32 v[98:99], v[98:99], s[24:25] op_sel_hi:[1,0]
    v_pk_mul_f32 v[100:101], v[100:101], s[24:25] op_sel_hi:[1,0]
    v_pk_mul_f32 v[102:103], v[102:103], s[24:25] op_sel_hi:[1,0]
    v_pk_mul_f32 v[104:105], v[104:105], s[24:25] op_sel_hi:[1,0]
    v_pk_mul_f32 v[106:107], v[106:107], s[24:25] op_sel_hi:[1,0]
    v_cvt_pk_bf16_f32 v68, v180, v181
    v_cvt_pk_bf16_f32 v72, v184, v185
    v_cvt_pk_bf16_f32 v76, -v184, -v185
    v_cvt_pk_bf16_f32 v69, v182, v183
    v_cvt_pk_bf16_f32 v73, v186, v187
    v_cvt_pk_bf16_f32 v77, -v186, -v187
    v_xor_b32 v70, v7, v68
    v_xor_b32 v71, v7, v69
    v_xor_b32 v74, v7, v72
    v_xor_b32 v75, v7, v73
    v_xor_b32 v78, v7, v76
    v_xor_b32 v79, v7, v77
    v_xor_b32 v80, 0x80000000, v68
    v_xor_b32 v81, 0x80000000, v69
    v_xor_b32 v82, 0x80000000, v70
    v_xor_b32 v83, 0x80000000, v71
    v_xor_b32 v84, 0x80000000, v72
    v_xor_b32 v85, 0x80000000, v73
    v_xor_b32 v86, 0x80000000, v74
    v_xor_b32 v87, 0x80000000, v75
    v_xor_b32 v88, 0x80000000, v76
    v_xor_b32 v89, 0x80000000, v77
    v_xor_b32 v90, 0x80000000, v78
    v_xor_b32 v91, 0x80000000, v79
    s_mul_i32 s24, s3, 1152
    v_mul_u32_u24 v8, 72, v2
    v_lshl_add_u32 v8, v3, 3, v8
    v_add_u32 v8, s24, v8
    v_lshrrev_b32 v9, 2, v2
    v_lshl_add_u32 v9, v3, 3, v9
    v_mul_u32_u24 v9, 72, v9
    v_and_b32 v228, 3, v2
    v_lshl_add_u32 v9, v228, 3, v9
    v_lshrrev_b32 v228, 7, v11
    v_mul_u32_u24 v228, 65792, v228
    v_and_b32 v5, 127, v11
    v_add_u32 v5, v5, v228
    s_mul_i32 s24, s5, 263168
    s_lshl_b32 s10, s42, 8
    s_add_u32 s10, s10, s24
    s_add_u32 s10, s10, 0x240000
    s_add_u32 s10, s10, s40
    s_add_u32 s11, s10, 526336
    v_add_u32 v11, s6, v11
    v_add_u32 v6, s6, v6
    s_barrier
    ds_read_b128 v[12:15], v10 offset:0
    ds_read_b128 v[16:19], v10 offset:512
    ds_read_b128 v[20:23], v10 offset:4096
    ds_read_b128 v[24:27], v10 offset:4608
    ds_read_b128 v[28:31], v10 offset:2048
    ds_read_b128 v[32:35], v10 offset:2560
    ds_read_b128 v[36:39], v10 offset:6144
    ds_read_b128 v[40:43], v10 offset:6656
    ds_read2st64_b64 v[132:135], v11 offset0:0 offset1:1
    ds_read2st64_b64 v[136:139], v11 offset0:4 offset1:5
    ds_read_b128 v[140:143], v6 offset:8192
    ds_read_b128 v[144:147], v6 offset:10240
    s_cmp_lg_u32 s42, 0
    s_cbranch_scc1 C_NZ
    s_waitcnt lgkmcnt(0)
    v_mov_b32 v12, 0
    v_mov_b32 v13, 0
    v_mov_b32 v14, 0
    v_mov_b32 v15, 0
    v_mov_b32 v20, 0
    v_mov_b32 v21, 0
    v_mov_b32 v22, 0
    v_mov_b32 v23, 0
    v_mov_b32 v28, 0
    v_mov_b32 v29, 0
    v_mov_b32 v30, 0
    v_mov_b32 v31, 0
    v_mov_b32 v36, 0
    v_mov_b32 v37, 0
    v_mov_b32 v38, 0
    v_mov_b32 v39, 0
    s_nop 1
C_NZ:
    s_waitcnt lgkmcnt(11)
    v_mfma_f32_16x16x32_bf16 v[148:151], v[12:15], v[44:47], 0
    v_mfma_f32_16x16x32_bf16 v[156:159], v[12:15], v[52:55], 0
    s_waitcnt lgkmcnt(10)
    v_mfma_f32_16x16x32_bf16 v[148:151], v[16:19], v[48:51], v[148:151]
    v_mfma_f32_16x16x32_bf16 v[156:159], v[16:19], v[44:47], v[156:159]
    s_waitcnt lgkmcnt(9)
    v_mfma_f32_16x16x32_bf16 v[148:151], v[20:23], v[56:59], v[148:151]
    v_mfma_f32_16x16x32_bf16 v[156:159], v[20:23], v[64:67], v[156:159]
    s_waitcnt lgkmcnt(8)
    v_mfma_f32_16x16x32_bf16 v[148:151], v[24:27], v[60:63], v[148:151]
    v_mfma_f32_16x16x32_bf16 v[156:159], v[24:27], v[56:59], v[156:159]
    s_waitcnt vmcnt(0)
    s_waitcnt lgkmcnt(7)
    v_mfma_f32_16x16x32_bf16 v[152:155], v[28:31], v[44:47], 0
    v_lshlrev_b32 v116, 16, v108
    v_and_b32 v124, 0xffff0000, v108
    v_mfma_f32_16x16x32_bf16 v[160:163], v[28:31], v[52:55], 0
    v_lshlrev_b32 v117, 16, v109
    v_and_b32 v125, 0xffff0000, v109
    s_waitcnt lgkmcnt(6)
    v_mfma_f32_16x16x32_bf16 v[152:155], v[32:35], v[48:51], v[152:155]
    v_lshlrev_b32 v118, 16, v110
    v_and_b32 v126, 0xffff0000, v110
    v_mfma_f32_16x16x32_bf16 v[160:163], v[32:35], v[44:47], v[160:163]
    v_pk_mul_f32 v[212:213], v[148:149], v[92:93]
    v_pk_mul_f32 v[214:215], v[156:157], v[92:93]
    s_waitcnt lgkmcnt(5)
    v_mfma_f32_16x16x32_bf16 v[152:155], v[36:39], v[56:59], v[152:155]
    v_pk_mul_f32 v[216:217], v[150:151], v[94:95]
    v_pk_mul_f32 v[218:219], v[158:159], v[94:95]
    v_mfma_f32_16x16x32_bf16 v[160:163], v[36:39], v[64:67], v[160:163]
    v_pk_fma_f32 v[212:213], v[156:157], v[100:101], v[212:213]
    v_pk_fma_f32 v[214:215], v[148:149], v[100:101], v[214:215] neg_lo:[1,0,0] neg_hi:[1,0,0]
    s_waitcnt lgkmcnt(4)
    v_mfma_f32_16x16x32_bf16 v[152:155], v[40:43], v[60:63], v[152:155]
    v_pk_fma_f32 v[216:217], v[158:159], v[102:103], v[216:217]
    v_pk_fma_f32 v[218:219], v[150:151], v[102:103], v[218:219] neg_lo:[1,0,0] neg_hi:[1,0,0]
    v_mfma_f32_16x16x32_bf16 v[160:163], v[40:43], v[56:59], v[160:163]
    v_cvt_pk_bf16_f32 v180, v212, v213
    v_cvt_pk_bf16_f32 v184, v214, v215
    v_cvt_pk_bf16_f32 v181, v216, v217
    v_cvt_pk_bf16_f32 v185, v218, v219
    v_lshlrev_b32 v119, 16, v111
    v_and_b32 v127, 0xffff0000, v111
    v_lshlrev_b32 v120, 16, v112
    v_and_b32 v128, 0xffff0000, v112
    v_lshlrev_b32 v121, 16, v113
    v_and_b32 v129, 0xffff0000, v113
    v_pk_mul_f32 v[212:213], v[152:153], v[96:97]
    v_pk_mul_f32 v[214:215], v[160:161], v[96:97]
    v_pk_mul_f32 v[216:217], v[154:155], v[98:99]
    v_pk_mul_f32 v[218:219], v[162:163], v[98:99]
    v_pk_fma_f32 v[212:213], v[160:161], v[104:105], v[212:213]
    v_pk_fma_f32 v[214:215], v[152:153], v[104:105], v[214:215] neg_lo:[1,0,0] neg_hi:[1,0,0]
    v_pk_fma_f32 v[216:217], v[162:163], v[106:107], v[216:217]
    v_pk_fma_f32 v[218:219], v[154:155], v[106:107], v[218:219] neg_lo:[1,0,0] neg_hi:[1,0,0]
    v_cvt_pk_bf16_f32 v182, v212, v213
    v_cvt_pk_bf16_f32 v186, v214, v215
    v_cvt_pk_bf16_f32 v183, v216, v217
    v_cvt_pk_bf16_f32 v187, v218, v219
    s_waitcnt lgkmcnt(0)
    v_mfma_f32_16x16x32_bf16 v[164:167], v[68:71], v[180:183], 0
    v_lshlrev_b32 v122, 16, v114
    v_and_b32 v130, 0xffff0000, v114
    v_mfma_f32_16x16x32_bf16 v[172:175], v[68:71], v[184:187], 0
    v_lshlrev_b32 v123, 16, v115
    v_and_b32 v131, 0xffff0000, v115
    v_mfma_f32_16x16x32_bf16 v[164:167], v[72:75], v[184:187], v[164:167]
    v_lshlrev_b32 v196, 16, v132
    v_and_b32 v197, 0xffff0000, v132
    v_mfma_f32_16x16x32_bf16 v[172:175], v[76:79], v[180:183], v[172:175]
    v_lshlrev_b32 v198, 16, v133
    v_and_b32 v199, 0xffff0000, v133
    v_mfma_f32_16x16x32_bf16 v[168:171], v[80:83], v[180:183], 0
    v_pk_mul_f32 v[196:197], v[196:197], v[140:141]
    v_pk_mul_f32 v[198:199], v[198:199], v[142:143]
    v_mfma_f32_16x16x32_bf16 v[176:179], v[80:83], v[184:187], 0
    v_lshlrev_b32 v200, 16, v136
    v_and_b32 v201, 0xffff0000, v136
    v_mfma_f32_16x16x32_bf16 v[168:171], v[84:87], v[184:187], v[168:171]
    v_lshlrev_b32 v202, 16, v137
    v_and_b32 v203, 0xffff0000, v137
    v_mfma_f32_16x16x32_bf16 v[176:179], v[88:91], v[180:183], v[176:179]
    v_pk_mul_f32 v[200:201], v[200:201], v[144:145]
    v_pk_mul_f32 v[202:203], v[202:203], v[146:147]
    v_pk_mul_f32 v[212:213], v[164:165], v[116:117]
    v_pk_mul_f32 v[214:215], v[172:173], v[116:117]
    v_pk_mul_f32 v[216:217], v[166:167], v[118:119]
    v_pk_mul_f32 v[218:219], v[174:175], v[118:119]
    v_pk_fma_f32 v[212:213], v[172:173], v[124:125], v[212:213] neg_lo:[1,0,0] neg_hi:[1,0,0]
    v_pk_fma_f32 v[214:215], v[164:165], v[124:125], v[214:215]
    v_pk_fma_f32 v[216:217], v[174:175], v[126:127], v[216:217] neg_lo:[1,0,0] neg_hi:[1,0,0]
    v_pk_fma_f32 v[218:219], v[166:167], v[126:127], v[218:219]
    v_cvt_pk_bf16_f32 v188, v212, v213
    v_cvt_pk_bf16_f32 v192, v214, v215
    v_cvt_pk_bf16_f32 v189, v216, v217
    v_cvt_pk_bf16_f32 v193, v218, v219
    v_pk_mul_f32 v[212:213], v[168:169], v[120:121]
    v_pk_mul_f32 v[214:215], v[176:177], v[120:121]
    v_pk_mul_f32 v[216:217], v[170:171], v[122:123]
    v_pk_mul_f32 v[218:219], v[178:179], v[122:123]
    v_pk_fma_f32 v[212:213], v[176:177], v[128:129], v[212:213] neg_lo:[1,0,0] neg_hi:[1,0,0]
    v_pk_fma_f32 v[214:215], v[168:169], v[128:129], v[214:215]
    v_pk_fma_f32 v[216:217], v[178:179], v[130:131], v[216:217] neg_lo:[1,0,0] neg_hi:[1,0,0]
    v_pk_fma_f32 v[218:219], v[170:171], v[130:131], v[218:219]
    v_cvt_pk_bf16_f32 v190, v212, v213
    v_cvt_pk_bf16_f32 v194, v214, v215
    v_cvt_pk_bf16_f32 v191, v216, v217
    v_cvt_pk_bf16_f32 v195, v218, v219
    s_nop 0
    v_mfma_f32_16x16x32_bf16 v[148:151], v[68:71], v[188:191], 0
    v_lshlrev_b32 v204, 16, v134
    v_and_b32 v205, 0xffff0000, v134
    v_mfma_f32_16x16x32_bf16 v[156:159], v[68:71], v[192:195], 0
    v_lshlrev_b32 v206, 16, v135
    v_and_b32 v207, 0xffff0000, v135
    v_mfma_f32_16x16x32_bf16 v[148:151], v[76:79], v[192:195], v[148:151]
    v_pk_mul_f32 v[204:205], v[204:205], v[140:141]
    v_pk_mul_f32 v[206:207], v[206:207], v[142:143]
    v_mfma_f32_16x16x32_bf16 v[156:159], v[72:75], v[188:191], v[156:159]
    v_lshlrev_b32 v208, 16, v138
    v_and_b32 v209, 0xffff0000, v138
    v_mfma_f32_16x16x32_bf16 v[152:155], v[80:83], v[188:191], 0
    v_lshlrev_b32 v210, 16, v139
    v_and_b32 v211, 0xffff0000, v139
    v_mfma_f32_16x16x32_bf16 v[160:163], v[80:83], v[192:195], 0
    v_pk_mul_f32 v[208:209], v[208:209], v[144:145]
    v_pk_mul_f32 v[210:211], v[210:211], v[146:147]
    v_mfma_f32_16x16x32_bf16 v[152:155], v[88:91], v[192:195], v[152:155]
    v_mfma_f32_16x16x32_bf16 v[160:163], v[84:87], v[188:191], v[160:163]
    v_pk_mul_f32 v[212:213], v[148:149], v[92:93]
    v_pk_mul_f32 v[214:215], v[156:157], v[92:93]
    v_pk_mul_f32 v[216:217], v[150:151], v[94:95]
    v_pk_mul_f32 v[218:219], v[158:159], v[94:95]
    v_pk_fma_f32 v[212:213], v[156:157], v[100:101], v[212:213] neg_lo:[1,0,0] neg_hi:[1,0,0]
    v_pk_fma_f32 v[214:215], v[148:149], v[100:101], v[214:215]
    v_pk_fma_f32 v[216:217], v[158:159], v[102:103], v[216:217] neg_lo:[1,0,0] neg_hi:[1,0,0]
    v_pk_fma_f32 v[218:219], v[150:151], v[102:103], v[218:219]
    v_cvt_pk_bf16_f32 v180, v212, v213
    v_cvt_pk_bf16_f32 v184, v214, v215
    v_cvt_pk_bf16_f32 v181, v216, v217
    v_cvt_pk_bf16_f32 v185, v218, v219
    ds_write_b64 v8, v[180:181] offset:16384
    ds_write_b64 v8, v[184:185] offset:20992
    v_pk_mul_f32 v[212:213], v[152:153], v[96:97]
    v_pk_mul_f32 v[214:215], v[160:161], v[96:97]
    v_pk_mul_f32 v[216:217], v[154:155], v[98:99]
    v_pk_mul_f32 v[218:219], v[162:163], v[98:99]
    v_pk_fma_f32 v[212:213], v[160:161], v[104:105], v[212:213] neg_lo:[1,0,0] neg_hi:[1,0,0]
    v_pk_fma_f32 v[214:215], v[152:153], v[104:105], v[214:215]
    v_pk_fma_f32 v[216:217], v[162:163], v[106:107], v[216:217] neg_lo:[1,0,0] neg_hi:[1,0,0]
    v_pk_fma_f32 v[218:219], v[154:155], v[106:107], v[218:219]
    v_cvt_pk_bf16_f32 v182, v212, v213
    v_cvt_pk_bf16_f32 v186, v214, v215
    v_cvt_pk_bf16_f32 v183, v216, v217
    v_cvt_pk_bf16_f32 v187, v218, v219
    ds_write_b64 v8, v[182:183] offset:16416
    ds_write_b64 v8, v[186:187] offset:21024
    s_waitcnt lgkmcnt(0)
    s_barrier
    ds_read_b64_tr_b16 v[12:13], v9 offset:16384
    ds_read_b64_tr_b16 v[14:15], v9 offset:16672
    ds_read_b64_tr_b16 v[16:17], v9 offset:20992
    ds_read_b64_tr_b16 v[18:19], v9 offset:21280
    ds_read_b64_tr_b16 v[20:21], v9 offset:18688
    ds_read_b64_tr_b16 v[22:23], v9 offset:18976
    ds_read_b64_tr_b16 v[24:25], v9 offset:23296
    ds_read_b64_tr_b16 v[26:27], v9 offset:23584
    ds_read_b64_tr_b16 v[28:29], v9 offset:16416
    ds_read_b64_tr_b16 v[30:31], v9 offset:16704
    ds_read_b64_tr_b16 v[32:33], v9 offset:21024
    ds_read_b64_tr_b16 v[34:35], v9 offset:21312
    ds_read_b64_tr_b16 v[36:37], v9 offset:18720
    ds_read_b64_tr_b16 v[38:39], v9 offset:19008
    ds_read_b64_tr_b16 v[40:41], v9 offset:23328
    ds_read_b64_tr_b16 v[42:43], v9 offset:23616
    s_cmp_eq_u32 s42, 0
    s_cbranch_scc1 C_Z
    s_waitcnt lgkmcnt(14)
    v_mfma_f32_16x16x32_bf16 v[196:199], v[44:47], v[12:15], v[196:199]
    v_mfma_f32_16x16x32_bf16 v[204:207], v[48:51], v[12:15], v[204:207]
    s_waitcnt lgkmcnt(12)
    v_mfma_f32_16x16x32_bf16 v[196:199], v[52:55], v[16:19], v[196:199]
    v_mfma_f32_16x16x32_bf16 v[204:207], v[44:47], v[16:19], v[204:207]
    s_waitcnt lgkmcnt(10)
    v_mfma_f32_16x16x32_bf16 v[196:199], v[56:59], v[20:23], v[196:199]
    v_mfma_f32_16x16x32_bf16 v[204:207], v[60:63], v[20:23], v[204:207]
    s_waitcnt lgkmcnt(8)
    v_mfma_f32_16x16x32_bf16 v[196:199], v[64:67], v[24:27], v[196:199]
    v_mfma_f32_16x16x32_bf16 v[204:207], v[56:59], v[24:27], v[204:207]
    s_waitcnt lgkmcnt(6)
    v_mfma_f32_16x16x32_bf16 v[200:203], v[44:47], v[28:31], v[200:203]
    v_mfma_f32_16x16x32_bf16 v[208:211], v[48:51], v[28:31], v[208:211]
    s_waitcnt lgkmcnt(4)
    v_mfma_f32_16x16x32_bf16 v[200:203], v[52:55], v[32:35], v[200:203]
    v_mfma_f32_16x16x32_bf16 v[208:211], v[44:47], v[32:35], v[208:211]
    s_waitcnt lgkmcnt(2)
    v_mfma_f32_16x16x32_bf16 v[200:203], v[56:59], v[36:39], v[200:203]
    v_mfma_f32_16x16x32_bf16 v[208:211], v[60:63], v[36:39], v[208:211]
    v_cvt_pk_bf16_f32 v196, v196, v197
    v_cvt_pk_bf16_f32 v197, v198, v199
    buffer_store_dwordx2 v[196:197], v5, s[20:23], s10 offen offset:0 sc1
    v_cvt_pk_bf16_f32 v204, v204, v205
    v_cvt_pk_bf16_f32 v205, v206, v207
    buffer_store_dwordx2 v[204:205], v5, s[20:23], s10 offen offset:128 sc1
    s_waitcnt lgkmcnt(0)
    v_mfma_f32_16x16x32_bf16 v[200:203], v[64:67], v[40:43], v[200:203]
    v_mfma_f32_16x16x32_bf16 v[208:211], v[56:59], v[40:43], v[208:211]
    s_nop 6
    v_cvt_pk_bf16_f32 v200, v200, v201
    v_cvt_pk_bf16_f32 v201, v202, v203
    buffer_store_dwordx2 v[200:201], v5, s[20:23], s11 offen offset:0 sc1
    v_cvt_pk_bf16_f32 v208, v208, v209
    v_cvt_pk_bf16_f32 v209, v210, v211
    buffer_store_dwordx2 v[208:209], v5, s[20:23], s11 offen offset:128 sc1
C_E:
    s_barrier
    s_and_b32 s6, s3, 1
    v_lshrrev_b32 v12, 5, v0
    v_and_b32 v14, 3, v0
    v_lshlrev_b32 v6, 4, v14
    v_and_b32 v14, 4, v0
    v_lshl_add_u32 v6, v14, 5, v6
    v_and_b32 v14, 8, v0
    v_lshl_add_u32 v6, v14, 3, v6
    v_and_b32 v14, 16, v0
    v_lshl_add_u32 v6, v14, 7, v6
    v_lshl_add_u32 v6, v12, 8, v6
    s_lshl_b32 s24, s6, 12
    s_add_u32 s24, s24, 0x10000
    v_add_u32 v6, s24, v6
    ds_read_b128 v[64:67], v6 offset:0
    ds_read_b128 v[68:71], v6 offset:512
    ds_read_b128 v[72:75], v6 offset:1024
    ds_read_b128 v[76:79], v6 offset:1536
    ds_read_b128 v[80:83], v6 offset:8192
    ds_read_b128 v[84:87], v6 offset:8704
    ds_read_b128 v[88:91], v6 offset:9216
    ds_read_b128 v[92:95], v6 offset:9728
    ds_read_b128 v[96:99], v6 offset:16384
    ds_read_b128 v[100:103], v6 offset:16896
    ds_read_b128 v[104:107], v6 offset:17408
    ds_read_b128 v[108:111], v6 offset:17920
    s_and_b32 s24, s2, 7
    s_lshl_b32 s24, s24, 2
    s_bfe_u32 s25, s2, 0x20003
    s_add_u32 s4, s24, s25
    s_lshr_b32 s5, s2, 5
    s_lshl_b32 s25, s25, 1
    s_xor_b32 s18, s5, s25
    s_waitcnt lgkmcnt(4)
    ds_read_b128 v[112:115], v6 offset:24576
    ds_read_b128 v[116:119], v6 offset:25088
    ds_read_b128 v[120:123], v6 offset:25600
    ds_read_b128 v[124:127], v6 offset:26112
    ds_read_b128 v[128:131], v6 offset:32768
    ds_read_b128 v[132:135], v6 offset:33280
    ds_read_b128 v[136:139], v6 offset:33792
    ds_read_b128 v[140:143], v6 offset:34304
    ds_read_b128 v[144:147], v6 offset:40960
    ds_read_b128 v[148:151], v6 offset:41472
    s_lshr_b32 s7, s3, 1
    v_bfe_u32 v13, v0, 2, 2
    v_lshl_add_u32 v14, v12, 2, v13
    v_lshlrev_b32 v4, 7, v14
    v_and_b32 v14, 3, v0
    v_lshl_add_u32 v4, v14, 3, v4
    v_and_b32 v14, 1, v3
    v_xor_b32 v14, v12, v14
    v_and_b32 v13, 2, v13
    v_or_b32 v14, v13, v14
    s_lshl_b32 s24, s7, 1
    v_xor_b32 v14, s24, v14
    v_lshl_add_u32 v4, v14, 5, v4
    v_xor_b32 v5, 64, v4
    v_and_b32 v14, 31, v0
    s_lshl_b32 s24, s7, 7
    s_add_u32 s24, s24, 0x24000
    v_lshl_add_u32 v7, v14, 2, s24
    v_lshrrev_b32 v14, 3, v14
    v_lshlrev_b32 v8, 13, v14
    v_lshl_add_u32 v8, v12, 9, v8
    v_and_b32 v14, 7, v0
    v_lshl_add_u32 v8, v14, 4, v8
    s_lshl_b32 s10, s4, 16
    s_lshl_b32 s24, s7, 15
    s_add_u32 s10, s10, s24
    s_lshl_b32 s24, s5, 10
    s_add_u32 s10, s10, s24
    s_lshl_b32 s24, s6, 8
    s_add_u32 s10, s10, s24
    s_add_u32 s10, s10, 0x480000
    s_add_u32 s10, s10, s40
    v_lshlrev_b32 v9, 4, v0
    s_waitcnt lgkmcnt(4)
    ds_read_b128 v[152:155], v6 offset:41984
    ds_read_b128 v[156:159], v6 offset:42496
    ds_read_b128 v[160:163], v6 offset:49152
    ds_read_b128 v[164:167], v6 offset:49664
    ds_read_b128 v[168:171], v6 offset:50176
    ds_read_b128 v[172:175], v6 offset:50688
    ds_read_b128 v[176:179], v6 offset:57344
    ds_read_b128 v[180:183], v6 offset:57856
    ds_read_b128 v[184:187], v6 offset:58368
    ds_read_b128 v[188:191], v6 offset:58880
    v_and_b32 v12, 1, v3
    v_xor_b32 v12, s3, v12
    v_and_b32 v12, 1, v12
    v_lshlrev_b32 v12, 6, v12
    v_xor_b32 v15, v12, v9
    v_and_b32 v12, 32, v0
    v_xor_b32 v15, v12, v15
    s_mul_i32 s24, s4, 65792
    s_lshl_b32 s43, s3, 10
    s_add_u32 s24, s24, s43
    s_add_u32 s24, s24, 0x240000
    s_add_u32 s24, s24, s40
    s_lshl_b32 s25, s18, 13
    s_xor_b32 s32, s25, 0
    s_add_u32 s32, s32, s24
    s_xor_b32 s33, s25, 8192
    s_add_u32 s33, s33, s24
    s_xor_b32 s34, s25, 16384
    s_add_u32 s34, s34, s24
    s_xor_b32 s35, s25, 24576
    s_add_u32 s35, s35, s24
    s_xor_b32 s36, s25, 32768
    s_add_u32 s36, s36, s24
    s_xor_b32 s37, s25, 40960
    s_add_u32 s37, s37, s24
    s_xor_b32 s38, s25, 49152
    s_add_u32 s38, s38, s24
    s_xor_b32 s39, s25, 57344
    s_add_u32 s39, s39, s24
    s_waitcnt vmcnt(0)
    s_barrier
    v_add_u32 v9, s43, v9
    s_add_u32 m0, s43, 0
    s_nop 0
    buffer_load_dwordx4 v15, s[20:23], s32 offen sc1 lds
    s_add_u32 m0, s43, 8192
    s_nop 0
    buffer_load_dwordx4 v15, s[20:23], s33 offen sc1 lds
    s_barrier
    s_add_u32 m0, s43, 16384
    s_nop 0
    buffer_load_dwordx4 v15, s[20:23], s34 offen sc1 lds
    s_add_u32 m0, s43, 24576
    s_nop 0
    buffer_load_dwordx4 v15, s[20:23], s35 offen sc1 lds
    s_add_u32 m0, s43, 32768
    s_nop 0
    buffer_load_dwordx4 v15, s[20:23], s36 offen sc1 lds
    s_add_u32 m0, s43, 40960
    s_nop 0
    buffer_load_dwordx4 v15, s[20:23], s37 offen sc1 lds
    s_add_u32 m0, s43, 49152
    s_nop 0
    buffer_load_dwordx4 v15, s[20:23], s38 offen sc1 lds
    s_add_u32 m0, s43, 57344
    s_nop 0
    buffer_load_dwordx4 v15, s[20:23], s39 offen sc1 lds
    s_setprio 2
    s_waitcnt vmcnt(7)
    ds_read_b128 v[192:195], v9 offset:0
    s_waitcnt lgkmcnt(0)
    v_cmp_u_f32 vcc, v192, v194
    s_cbranch_vccnz Q_XR0
Q_XK0:
    s_barrier
    ds_read_b64_tr_b16 v[32:33], v4 offset:0
    ds_read_b64_tr_b16 v[34:35], v4 offset:2048
    ds_read_b64_tr_b16 v[36:37], v5 offset:1024
    ds_read_b64_tr_b16 v[38:39], v5 offset:3072
    ds_read_b64_tr_b16 v[40:41], v4 offset:4096
    ds_read_b64_tr_b16 v[42:43], v4 offset:6144
    ds_read_b64_tr_b16 v[44:45], v5 offset:5120
    ds_read_b64_tr_b16 v[46:47], v5 offset:7168
    s_waitcnt vmcnt(6)
    ds_read_b128 v[196:199], v9 offset:8192
    s_waitcnt vmcnt(5)
    ds_read_b128 v[200:203], v9 offset:16384
    s_waitcnt lgkmcnt(0)
    v_mfma_f32_32x32x16_bf16 v[16:31], v[64:67], v[32:35], 0
    v_max3_u32 v196, v196, v198, v200
    v_cmp_u_f32 vcc, v196, v202
    s_cbranch_vccnz Q_XR1
Q_XK1:
    s_barrier
    ds_read_b64_tr_b16 v[48:49], v4 offset:8192
    ds_read_b64_tr_b16 v[50:51], v4 offset:10240
    ds_read_b64_tr_b16 v[52:53], v5 offset:9216
    ds_read_b64_tr_b16 v[54:55], v5 offset:11264
    v_mfma_f32_32x32x16_bf16 v[16:31], v[68:71], v[36:39], v[16:31]
    ds_read_b64_tr_b16 v[56:57], v4 offset:12288
    ds_read_b64_tr_b16 v[58:59], v4 offset:14336
    ds_read_b64_tr_b16 v[60:61], v5 offset:13312
    ds_read_b64_tr_b16 v[62:63], v5 offset:15360
    v_mfma_f32_32x32x16_bf16 v[16:31], v[72:75], v[40:43], v[16:31]
    s_waitcnt vmcnt(4)
    ds_read_b128 v[204:207], v9 offset:24576
    v_mfma_f32_32x32x16_bf16 v[16:31], v[76:79], v[44:47], v[16:31]
    s_waitcnt vmcnt(3)
    ds_read_b128 v[208:211], v9 offset:32768
    s_waitcnt lgkmcnt(0)
    v_mfma_f32_32x32x16_bf16 v[16:31], v[80:83], v[48:51], v[16:31]
    v_max3_u32 v204, v204, v206, v208
    v_cmp_u_f32 vcc, v204, v210
    s_cbranch_vccnz Q_XR3
Q_XK3:
    ds_read_b64_tr_b16 v[32:33], v4 offset:16384
    ds_read_b64_tr_b16 v[34:35], v4 offset:18432
    ds_read_b64_tr_b16 v[36:37], v5 offset:17408
    ds_read_b64_tr_b16 v[38:39], v5 offset:19456
    v_mfma_f32_32x32x16_bf16 v[16:31], v[84:87], v[52:55], v[16:31]
    ds_read_b64_tr_b16 v[40:41], v4 offset:20480
    ds_read_b64_tr_b16 v[42:43], v4 offset:22528
    ds_read_b64_tr_b16 v[44:45], v5 offset:21504
    ds_read_b64_tr_b16 v[46:47], v5 offset:23552
    v_mfma_f32_32x32x16_bf16 v[16:31], v[88:91], v[56:59], v[16:31]
    s_waitcnt vmcnt(2)
    ds_read_b128 v[212:215], v9 offset:40960
    v_mfma_f32_32x32x16_bf16 v[16:31], v[92:95], v[60:63], v[16:31]
    s_waitcnt vmcnt(1)
    ds_read_b128 v[216:219], v9 offset:49152
    s_waitcnt vmcnt(0)
    ds_read_b128 v[220:223], v9 offset:57344
    s_waitcnt lgkmcnt(0)
    v_mfma_f32_32x32x16_bf16 v[16:31], v[96:99], v[32:35], v[16:31]
    v_max3_u32 v212, v212, v214, v216
    v_max3_u32 v212, v212, v218, v220
    v_cmp_u_f32 vcc, v212, v222
    s_cbranch_vccnz Q_XR5
Q_XK5:
    s_barrier
    ds_read_b64_tr_b16 v[48:49], v4 offset:24576
    ds_read_b64_tr_b16 v[50:51], v4 offset:26624
    ds_read_b64_tr_b16 v[52:53], v5 offset:25600
    ds_read_b64_tr_b16 v[54:55], v5 offset:27648
    v_mfma_f32_32x32x16_bf16 v[16:31], v[100:103], v[36:39], v[16:31]
    ds_read_b64_tr_b16 v[56:57], v4 offset:28672
    ds_read_b64_tr_b16 v[58:59], v4 offset:30720
    ds_read_b64_tr_b16 v[60:61], v5 offset:29696
    ds_read_b64_tr_b16 v[62:63], v5 offset:31744
    v_mfma_f32_32x32x16_bf16 v[16:31], v[104:107], v[40:43], v[16:31]
    v_mfma_f32_32x32x16_bf16 v[16:31], v[108:111], v[44:47], v[16:31]
    s_waitcnt lgkmcnt(0)
    v_mfma_f32_32x32x16_bf16 v[16:31], v[112:115], v[48:51], v[16:31]
    ds_read_b64_tr_b16 v[32:33], v4 offset:32768
    ds_read_b64_tr_b16 v[34:35], v4 offset:34816
    ds_read_b64_tr_b16 v[36:37], v5 offset:33792
    ds_read_b64_tr_b16 v[38:39], v5 offset:35840
    v_mfma_f32_32x32x16_bf16 v[16:31], v[116:119], v[52:55], v[16:31]
    ds_read_b64_tr_b16 v[40:41], v4 offset:36864
    ds_read_b64_tr_b16 v[42:43], v4 offset:38912
    ds_read_b64_tr_b16 v[44:45], v5 offset:37888
    ds_read_b64_tr_b16 v[46:47], v5 offset:39936
    v_mfma_f32_32x32x16_bf16 v[16:31], v[120:123], v[56:59], v[16:31]
    v_mfma_f32_32x32x16_bf16 v[16:31], v[124:127], v[60:63], v[16:31]
    s_waitcnt lgkmcnt(0)
    v_mfma_f32_32x32x16_bf16 v[16:31], v[128:131], v[32:35], v[16:31]
    ds_read_b64_tr_b16 v[48:49], v4 offset:40960
    ds_read_b64_tr_b16 v[50:51], v4 offset:43008
    ds_read_b64_tr_b16 v[52:53], v5 offset:41984
    ds_read_b64_tr_b16 v[54:55], v5 offset:44032
    v_mfma_f32_32x32x16_bf16 v[16:31], v[132:135], v[36:39], v[16:31]
    ds_read_b64_tr_b16 v[56:57], v4 offset:45056
    ds_read_b64_tr_b16 v[58:59], v4 offset:47104
    ds_read_b64_tr_b16 v[60:61], v5 offset:46080
    ds_read_b64_tr_b16 v[62:63], v5 offset:48128
    v_mfma_f32_32x32x16_bf16 v[16:31], v[136:139], v[40:43], v[16:31]
    v_mfma_f32_32x32x16_bf16 v[16:31], v[140:143], v[44:47], v[16:31]
    s_waitcnt lgkmcnt(0)
    v_mfma_f32_32x32x16_bf16 v[16:31], v[144:147], v[48:51], v[16:31]
    ds_read_b64_tr_b16 v[32:33], v4 offset:49152
    ds_read_b64_tr_b16 v[34:35], v4 offset:51200
    ds_read_b64_tr_b16 v[36:37], v5 offset:50176
    ds_read_b64_tr_b16 v[38:39], v5 offset:52224
    v_mfma_f32_32x32x16_bf16 v[16:31], v[148:151], v[52:55], v[16:31]
    ds_read_b64_tr_b16 v[40:41], v4 offset:53248
    ds_read_b64_tr_b16 v[42:43], v4 offset:55296
    ds_read_b64_tr_b16 v[44:45], v5 offset:54272
    ds_read_b64_tr_b16 v[46:47], v5 offset:56320
    v_mfma_f32_32x32x16_bf16 v[16:31], v[152:155], v[56:59], v[16:31]
    v_mfma_f32_32x32x16_bf16 v[16:31], v[156:159], v[60:63], v[16:31]
    s_waitcnt lgkmcnt(0)
    v_mfma_f32_32x32x16_bf16 v[16:31], v[160:163], v[32:35], v[16:31]
    ds_read_b64_tr_b16 v[48:49], v4 offset:57344
    ds_read_b64_tr_b16 v[50:51], v4 offset:59392
    ds_read_b64_tr_b16 v[52:53], v5 offset:58368
    ds_read_b64_tr_b16 v[54:55], v5 offset:60416
    v_mfma_f32_32x32x16_bf16 v[16:31], v[164:167], v[36:39], v[16:31]
    ds_read_b64_tr_b16 v[56:57], v4 offset:61440
    ds_read_b64_tr_b16 v[58:59], v4 offset:63488
    ds_read_b64_tr_b16 v[60:61], v5 offset:62464
    ds_read_b64_tr_b16 v[62:63], v5 offset:64512
    v_mfma_f32_32x32x16_bf16 v[16:31], v[168:171], v[40:43], v[16:31]
    v_mfma_f32_32x32x16_bf16 v[16:31], v[172:175], v[44:47], v[16:31]
    s_waitcnt lgkmcnt(6)
    v_mfma_f32_32x32x16_bf16 v[16:31], v[176:179], v[48:51], v[16:31]
    s_waitcnt lgkmcnt(4)
    v_mfma_f32_32x32x16_bf16 v[16:31], v[180:183], v[52:55], v[16:31]
    s_waitcnt lgkmcnt(2)
    v_mfma_f32_32x32x16_bf16 v[16:31], v[184:187], v[56:59], v[16:31]
    s_waitcnt lgkmcnt(0)
    v_mfma_f32_32x32x16_bf16 v[16:31], v[188:191], v[60:63], v[16:31]
    s_barrier
    ds_read_b32 v10, v7
    s_waitcnt lgkmcnt(0)
    s_nop 8
    v_pk_mul_f32 v[16:17], v[16:17], v[10:11] op_sel_hi:[1,0]
    v_pk_mul_f32 v[18:19], v[18:19], v[10:11] op_sel_hi:[1,0]
    v_pk_mul_f32 v[20:21], v[20:21], v[10:11] op_sel_hi:[1,0]
    v_pk_mul_f32 v[22:23], v[22:23], v[10:11] op_sel_hi:[1,0]
    v_cvt_pk_bf16_f32 v16, v16, v17
    v_cvt_pk_bf16_f32 v17, v18, v19
    v_cvt_pk_bf16_f32 v18, v20, v21
    v_cvt_pk_bf16_f32 v19, v22, v23
    buffer_store_dwordx4 v[16:19], v8, s[20:23], s10 offen offset:0 sc1
    v_pk_mul_f32 v[24:25], v[24:25], v[10:11] op_sel_hi:[1,0]
    v_pk_mul_f32 v[26:27], v[26:27], v[10:11] op_sel_hi:[1,0]
    v_pk_mul_f32 v[28:29], v[28:29], v[10:11] op_sel_hi:[1,0]
    v_pk_mul_f32 v[30:31], v[30:31], v[10:11] op_sel_hi:[1,0]
    v_cvt_pk_bf16_f32 v24, v24, v25
    v_cvt_pk_bf16_f32 v25, v26, v27
    v_cvt_pk_bf16_f32 v26, v28, v29
    v_cvt_pk_bf16_f32 v27, v30, v31
    buffer_store_dwordx4 v[24:27], v8, s[20:23], s10 offen offset:128 sc1
    s_cmp_lg_u32 s40, 0
    s_cbranch_scc1 A2_GO
    s_branch A1_GO
C_Z:
    s_waitcnt lgkmcnt(14)
    v_mfma_f32_16x16x32_bf16 v[204:207], v[48:51], v[12:15], v[204:207]
    s_waitcnt lgkmcnt(12)
    v_mfma_f32_16x16x32_bf16 v[204:207], v[44:47], v[16:19], v[204:207]
    s_waitcnt lgkmcnt(10)
    v_mfma_f32_16x16x32_bf16 v[204:207], v[60:63], v[20:23], v[204:207]
    s_waitcnt lgkmcnt(8)
    v_mfma_f32_16x16x32_bf16 v[204:207], v[56:59], v[24:27], v[204:207]
    s_waitcnt lgkmcnt(6)
    v_mfma_f32_16x16x32_bf16 v[208:211], v[48:51], v[28:31], v[208:211]
    s_waitcnt lgkmcnt(4)
    v_mfma_f32_16x16x32_bf16 v[208:211], v[44:47], v[32:35], v[208:211]
    s_waitcnt lgkmcnt(2)
    v_mfma_f32_16x16x32_bf16 v[208:211], v[60:63], v[36:39], v[208:211]
    v_cvt_pk_bf16_f32 v196, v196, v197
    v_cvt_pk_bf16_f32 v197, v198, v199
    buffer_store_dwordx2 v[196:197], v5, s[20:23], s10 offen offset:0 sc1
    v_cvt_pk_bf16_f32 v204, v204, v205
    v_cvt_pk_bf16_f32 v205, v206, v207
    buffer_store_dwordx2 v[204:205], v5, s[20:23], s10 offen offset:128 sc1
    s_waitcnt lgkmcnt(0)
    v_mfma_f32_16x16x32_bf16 v[208:211], v[56:59], v[40:43], v[208:211]
    v_cvt_pk_bf16_f32 v200, v200, v201
    v_cvt_pk_bf16_f32 v201, v202, v203
    buffer_store_dwordx2 v[200:201], v5, s[20:23], s11 offen offset:0 sc1
    s_nop 4
    v_cvt_pk_bf16_f32 v208, v208, v209
    v_cvt_pk_bf16_f32 v209, v210, v211
    buffer_store_dwordx2 v[208:209], v5, s[20:23], s11 offen offset:128 sc1
    s_branch C_E
Q_XR0:
    s_cmp_eq_u32 s41, 0
    s_cbranch_scc1 Q_XK0
    s_sub_u32 s41, s41, 1
    s_add_u32 m0, s43, 0
    s_nop 0
    buffer_load_dwordx4 v15, s[20:23], s32 offen sc1 lds
    s_add_u32 m0, s43, 8192
    s_nop 0
    buffer_load_dwordx4 v15, s[20:23], s33 offen sc1 lds
    s_add_u32 m0, s43, 16384
    s_nop 0
    buffer_load_dwordx4 v15, s[20:23], s34 offen sc1 lds
    s_add_u32 m0, s43, 24576
    s_nop 0
    buffer_load_dwordx4 v15, s[20:23], s35 offen sc1 lds
    s_add_u32 m0, s43, 32768
    s_nop 0
    buffer_load_dwordx4 v15, s[20:23], s36 offen sc1 lds
    s_add_u32 m0, s43, 40960
    s_nop 0
    buffer_load_dwordx4 v15, s[20:23], s37 offen sc1 lds
    s_add_u32 m0, s43, 49152
    s_nop 0
    buffer_load_dwordx4 v15, s[20:23], s38 offen sc1 lds
    s_add_u32 m0, s43, 57344
    s_nop 0
    buffer_load_dwordx4 v15, s[20:23], s39 offen sc1 lds
    s_waitcnt vmcnt(7)
    ds_read_b128 v[192:195], v9 offset:0
    s_waitcnt lgkmcnt(0)
    v_cmp_u_f32 vcc, v192, v194
    s_cbranch_vccnz Q_XR0
    s_branch Q_XK0
Q_XR1:
    s_cmp_eq_u32 s41, 0
    s_cbranch_scc1 Q_XK1
    s_sub_u32 s41, s41, 1
    s_add_u32 m0, s43, 8192
    s_nop 0
    buffer_load_dwordx4 v15, s[20:23], s33 offen sc1 lds
    s_add_u32 m0, s43, 16384
    s_nop 0
    buffer_load_dwordx4 v15, s[20:23], s34 offen sc1 lds
    s_add_u32 m0, s43, 24576
    s_nop 0
    buffer_load_dwordx4 v15, s[20:23], s35 offen sc1 lds
    s_add_u32 m0, s43, 32768
    s_nop 0
    buffer_load_dwordx4 v15, s[20:23], s36 offen sc1 lds
    s_add_u32 m0, s43, 40960
    s_nop 0
    buffer_load_dwordx4 v15, s[20:23], s37 offen sc1 lds
    s_add_u32 m0, s43, 49152
    s_nop 0
    buffer_load_dwordx4 v15, s[20:23], s38 offen sc1 lds
    s_add_u32 m0, s43, 57344
    s_nop 0
    buffer_load_dwordx4 v15, s[20:23], s39 offen sc1 lds
    s_waitcnt vmcnt(6)
    ds_read_b128 v[196:199], v9 offset:8192
    s_waitcnt vmcnt(5)
    ds_read_b128 v[200:203], v9 offset:16384
    s_waitcnt lgkmcnt(0)
    v_max3_u32 v196, v196, v198, v200
    v_cmp_u_f32 vcc, v196, v202
    s_cbranch_vccnz Q_XR1
    s_branch Q_XK1
Q_XR3:
    s_cmp_eq_u32 s41, 0
    s_cbranch_scc1 Q_XK3
    s_sub_u32 s41, s41, 1
    s_add_u32 m0, s43, 24576
    s_nop 0
    buffer_load_dwordx4 v15, s[20:23], s35 offen sc1 lds
    s_add_u32 m0, s43, 32768
    s_nop 0
    buffer_load_dwordx4 v15, s[20:23], s36 offen sc1 lds
    s_add_u32 m0, s43, 40960
    s_nop 0
    buffer_load_dwordx4 v15, s[20:23], s37 offen sc1 lds
    s_add_u32 m0, s43, 49152
    s_nop 0
    buffer_load_dwordx4 v15, s[20:23], s38 offen sc1 lds
    s_add_u32 m0, s43, 57344
    s_nop 0
    buffer_load_dwordx4 v15, s[20:23], s39 offen sc1 lds
    s_waitcnt vmcnt(4)
    ds_read_b128 v[204:207], v9 offset:24576
    s_waitcnt vmcnt(3)
    ds_read_b128 v[208:211], v9 offset:32768
    s_waitcnt lgkmcnt(0)
    v_max3_u32 v204, v204, v206, v208
    v_cmp_u_f32 vcc, v204, v210
    s_cbranch_vccnz Q_XR3
    s_branch Q_XK3
Q_XR5:
    s_cmp_eq_u32 s41, 0
    s_cbranch_scc1 Q_XK5
    s_sub_u32 s41, s41, 1
    s_add_u32 m0, s43, 40960
    s_nop 0
    buffer_load_dwordx4 v15, s[20:23], s37 offen sc1 lds
    s_add_u32 m0, s43, 49152
    s_nop 0
    buffer_load_dwordx4 v15, s[20:23], s38 offen sc1 lds
    s_add_u32 m0, s43, 57344
    s_nop 0
    buffer_load_dwordx4 v15, s[20:23], s39 offen sc1 lds
    s_waitcnt vmcnt(2)
    ds_read_b128 v[212:215], v9 offset:40960
    s_waitcnt vmcnt(1)
    ds_read_b128 v[216:219], v9 offset:49152
    s_waitcnt vmcnt(0)
    ds_read_b128 v[220:223], v9 offset:57344
    s_waitcnt lgkmcnt(0)
    v_max3_u32 v212, v212, v214, v216
    v_max3_u32 v212, v212, v218, v220
    v_cmp_u_f32 vcc, v212, v222
    s_cbranch_vccnz Q_XR5
    s_branch Q_XK5
M_END:
    s_endpgm
H1:
    v_lshlrev_b32 v238, 4, v0
    s_and_b32 s24, s2, 7
    s_lshl_b32 s24, s24, 2
    s_bfe_u32 s25, s2, 0x20003
    s_add_u32 s4, s24, s25
    s_lshr_b32 s5, s2, 5
    s_lshl_b32 s25, s25, 1
    s_xor_b32 s18, s5, s25
    v_add_u32 v237, 14336, v238
    s_lshl_b32 s24, s18, 11
    s_add_u32 s24, s24, 0xa90000
    s_cmp_eq_u32 s6, 0
    s_cbranch_scc1 H1_F
    s_cmp_eq_u32 s6, 3
    s_cbranch_scc1 H1_WK
    s_and_b32 s7, s6, 1
    s_lshl_b32 s10, s5, 16
    s_add_u32 s10, s10, s24
    s_lshl_b32 s25, s7, 15
    s_add_u32 s10, s10, s25
    s_lshl_b32 s25, s7, 12
    s_add_u32 s7, s25, 0x10000
    s_add_u32 m0, s7, 0
    s_nop 0
    buffer_load_dwordx4 v238, s[20:23], s10 offen offset:0 lds
    buffer_load_dwordx4 v238, s[20:23], s10 offen offset:1024 lds
    buffer_load_dwordx4 v237, s[20:23], s10 offen offset:2048 lds
    buffer_load_dwordx4 v237, s[20:23], s10 offen offset:3072 lds
    s_add_u32 m0, s7, 8192
    s_xor_b32 s10, s10, 2048
    buffer_load_dwordx4 v238, s[20:23], s10 offen offset:0 lds
    buffer_load_dwordx4 v238, s[20:23], s10 offen offset:1024 lds
    buffer_load_dwordx4 v237, s[20:23], s10 offen offset:2048 lds
    buffer_load_dwordx4 v237, s[20:23], s10 offen offset:3072 lds
    s_add_u32 m0, s7, 16384
    s_xor_b32 s10, s10, 6144
    buffer_load_dwordx4 v238, s[20:23], s10 offen offset:0 lds
    buffer_load_dwordx4 v238, s[20:23], s10 offen offset:1024 lds
    buffer_load_dwordx4 v237, s[20:23], s10 offen offset:2048 lds
    buffer_load_dwordx4 v237, s[20:23], s10 offen offset:3072 lds
    s_add_u32 m0, s7, 24576
    s_xor_b32 s10, s10, 2048
    buffer_load_dwordx4 v238, s[20:23], s10 offen offset:0 lds
    buffer_load_dwordx4 v238, s[20:23], s10 offen offset:1024 lds
    buffer_load_dwordx4 v237, s[20:23], s10 offen offset:2048 lds
    buffer_load_dwordx4 v237, s[20:23], s10 offen offset:3072 lds
    s_waitcnt vmcnt(16)
    s_barrier
    s_add_u32 m0, s7, 32768
    s_xor_b32 s10, s10, 14336
    buffer_load_dwordx4 v238, s[20:23], s10 offen offset:0 lds
    buffer_load_dwordx4 v238, s[20:23], s10 offen offset:1024 lds
    buffer_load_dwordx4 v237, s[20:23], s10 offen offset:2048 lds
    buffer_load_dwordx4 v237, s[20:23], s10 offen offset:3072 lds
    s_add_u32 m0, s7, 40960
    s_xor_b32 s10, s10, 2048
    buffer_load_dwordx4 v238, s[20:23], s10 offen offset:0 lds
    buffer_load_dwordx4 v238, s[20:23], s10 offen offset:1024 lds
    buffer_load_dwordx4 v237, s[20:23], s10 offen offset:2048 lds
    buffer_load_dwordx4 v237, s[20:23], s10 offen offset:3072 lds
    s_add_u32 m0, s7, 49152
    s_xor_b32 s10, s10, 6144
    buffer_load_dwordx4 v238, s[20:23], s10 offen offset:0 lds
    buffer_load_dwordx4 v238, s[20:23], s10 offen offset:1024 lds
    buffer_load_dwordx4 v237, s[20:23], s10 offen offset:2048 lds
    buffer_load_dwordx4 v237, s[20:23], s10 offen offset:3072 lds
    s_add_u32 m0, s7, 57344
    s_xor_b32 s10, s10, 2048
    buffer_load_dwordx4 v238, s[20:23], s10 offen offset:0 lds
    buffer_load_dwordx4 v238, s[20:23], s10 offen offset:1024 lds
    buffer_load_dwordx4 v237, s[20:23], s10 offen offset:2048 lds
    buffer_load_dwordx4 v237, s[20:23], s10 offen offset:3072 lds
    s_branch H1_J
H1_WK:
    s_and_b32 s11, s5, 1
    s_lshl_b32 s11, s11, 14
    s_add_u32 s11, s11, s24
    s_add_u32 s11, s11, 0x80000
    s_waitcnt vmcnt(0)
    s_barrier
    s_mov_b32 m0, 0x20000
    s_nop 0
    buffer_load_dwordx4 v238, s[20:23], s11 offen offset:0 lds
    buffer_load_dwordx4 v238, s[20:23], s11 offen offset:1024 lds
    s_mov_b32 m0, 0x20800
    s_xor_b32 s11, s11, 2048
    buffer_load_dwordx4 v238, s[20:23], s11 offen offset:0 lds
    buffer_load_dwordx4 v238, s[20:23], s11 offen offset:1024 lds
    s_mov_b32 m0, 0x21000
    s_xor_b32 s11, s11, 6144
    buffer_load_dwordx4 v238, s[20:23], s11 offen offset:0 lds
    buffer_load_dwordx4 v238, s[20:23], s11 offen offset:1024 lds
    s_mov_b32 m0, 0x21800
    s_xor_b32 s11, s11, 2048
    buffer_load_dwordx4 v238, s[20:23], s11 offen offset:0 lds
    buffer_load_dwordx4 v238, s[20:23], s11 offen offset:1024 lds
    s_mov_b32 m0, 0x22000
    s_xor_b32 s11, s11, 14336
    buffer_load_dwordx4 v238, s[20:23], s11 offen offset:0 lds
    buffer_load_dwordx4 v238, s[20:23], s11 offen offset:1024 lds
    s_mov_b32 m0, 0x22800
    s_xor_b32 s11, s11, 2048
    buffer_load_dwordx4 v238, s[20:23], s11 offen offset:0 lds
    buffer_load_dwordx4 v238, s[20:23], s11 offen offset:1024 lds
    s_mov_b32 m0, 0x23000
    s_xor_b32 s11, s11, 6144
    buffer_load_dwordx4 v238, s[20:23], s11 offen offset:0 lds
    buffer_load_dwordx4 v238, s[20:23], s11 offen offset:1024 lds
    s_mov_b32 m0, 0x23800
    s_xor_b32 s11, s11, 2048
    buffer_load_dwordx4 v238, s[20:23], s11 offen offset:0 lds
    buffer_load_dwordx4 v238, s[20:23], s11 offen offset:1024 lds
    s_branch H1_J
H1_F:
    v_mov_b32 v192, -1
    v_mov_b32 v193, -1
    v_mov_b32 v194, -1
    v_mov_b32 v195, -1
    s_lshl_b32 s24, s2, 13
    s_add_u32 s26, s24, 0x480000
    s_add_u32 s27, s26, 4096
    s_lshr_b32 s24, s24, 4
    s_add_u32 s28, s24, 0xd00000
    s_mov_b32 s24, -1
    s_mov_b32 s25, 0
    buffer_store_dwordx4 v[192:195], v238, s[20:23], s26 offen offset:0 sc1
    buffer_store_dwordx4 v[192:195], v238, s[20:23], s26 offen offset:1024 sc1
    buffer_store_dwordx4 v[192:195], v238, s[20:23], s26 offen offset:2048 sc1
    buffer_store_dwordx4 v[192:195], v238, s[20:23], s26 offen offset:3072 sc1
    buffer_store_dwordx4 v[192:195], v238, s[20:23], s27 offen offset:0 sc1
    buffer_store_dwordx4 v[192:195], v238, s[20:23], s27 offen offset:1024 sc1
    buffer_store_dwordx4 v[192:195], v238, s[20:23], s27 offen offset:2048 sc1
    buffer_store_dwordx4 v[192:195], v238, s[20:23], s27 offen offset:3072 sc1
    s_mov_b64 exec, s[24:25]
    buffer_store_dwordx4 v[192:195], v238, s[20:23], s28 offen sc1
    s_mov_b64 exec, -1
    s_waitcnt vmcnt(9)
    s_barrier
H1_J:
    v_and_b32 v12, 4, v0
    v_lshlrev_b32 v4, 5, v12
    v_bfe_u32 v12, v0, 3, 3
    v_lshl_add_u32 v4, v12, 9, v4
    v_and_b32 v13, 3, v0
    v_lshl_add_u32 v4, v13, 3, v4
    v_and_b32 v12, 3, v12
    v_xor_b32 v12, s6, v12
    v_lshl_add_u32 v4, v12, 5, v4
    v_xor_b32 v5, 64, v4
    v_mov_b32 v11, 0x3727c5ac
    s_lshl_b32 s24, s6, 6
    s_add_u32 s24, s24, 0x24000
    v_lshl_add_u32 v8, v2, 2, s24
    v_mov_b32 v12, -1
    v_mov_b32 v13, 0xffff0000
    s_mov_b64 s[24:25], 0xffff
    v_cndmask_b32 v10, v12, v13, s[24:25]
    v_and_b32 v12, 1, v3
    v_xor_b32 v12, s3, v12
    v_and_b32 v12, 1, v12
    v_lshlrev_b32 v12, 6, v12
    v_xor_b32 v240, v12, v238
    v_and_b32 v12, 32, v0
    v_xor_b32 v240, v12, v240
    s_mul_i32 s24, s4, 65792
    s_lshl_b32 s43, s3, 10
    s_add_u32 s24, s24, s43
    s_add_u32 s24, s24, 0x240000
    s_add_u32 s24, s24, 0x0
    s_lshl_b32 s25, s18, 13
    s_xor_b32 s32, s25, 0
    s_add_u32 s32, s32, s24
    s_xor_b32 s33, s25, 8192
    s_add_u32 s33, s33, s24
    s_xor_b32 s34, s25, 16384
    s_add_u32 s34, s34, s24
    s_xor_b32 s35, s25, 24576
    s_add_u32 s35, s35, s24
    s_xor_b32 s36, s25, 32768
    s_add_u32 s36, s36, s24
    s_xor_b32 s37, s25, 40960
    s_add_u32 s37, s37, s24
    s_xor_b32 s38, s25, 49152
    s_add_u32 s38, s38, s24
    s_xor_b32 s39, s25, 57344
    s_add_u32 s39, s39, s24
    s_lshr_b32 s30, s5, 1
    s_and_b32 s31, s5, 1
    v_and_b32 v12, 1, v3
    v_lshlrev_b32 v225, 9, v12
    v_lshl_add_u32 v225, v2, 4, v225
    v_lshrrev_b32 v12, 5, v0
    v_lshl_add_u32 v225, v12, 3, v225
    v_add_u32 v225, 0x20000, v225
    v_add_u32 v224, 4, v225
    s_lshl_b32 s9, s4, 11
    s_lshr_b32 s24, s30, 1
    s_lshl_b32 s24, s24, 10
    s_add_u32 s9, s9, s24
    s_and_b32 s24, s30, 1
    s_lshl_b32 s24, s24, 8
    s_add_u32 s9, s9, s24
    s_lshl_b32 s24, s31, 16
    s_add_u32 s9, s9, s24
    s_add_u32 s9, s9, 0xd00000
    v_and_b32 v227, 1, v3
    v_lshlrev_b32 v227, 3, v227
    v_lshl_add_u32 v227, v2, 4, v227
    v_lshrrev_b32 v13, 1, v3
    v_lshl_add_u32 v227, v13, 9, v227
    s_lshl_b32 s8, s30, 6
    s_add_u32 s8, s8, 0x24000
    s_cmp_eq_u32 s6, s30
    s_cselect_b32 s31, s31, 2
    s_mov_b32 s12, 0xaaaaaaaa
    s_mov_b32 s13, 0xaaaaaaaa
    s_mov_b32 s14, 0xcccccccc
    s_mov_b32 s15, 0xcccccccc
    s_mov_b32 s16, 0x00f0000f
    s_mov_b32 s17, 0xf0000f00
    s_cmp_lg_u32 s6, 0
    s_cbranch_scc1 H1_J2
    s_waitcnt vmcnt(0)
    s_barrier
    s_mul_i32 s26, s2, 8320
    s_add_u32 s26, s26, 0x1000000
    s_add_u32 s27, s26, 4096
    s_add_u32 s28, s26, 8192
    buffer_store_dwordx4 v[192:195], v238, s[20:23], s26 offen offset:0 sc1
    buffer_store_dwordx4 v[192:195], v238, s[20:23], s26 offen offset:1024 sc1
    buffer_store_dwordx4 v[192:195], v238, s[20:23], s26 offen offset:2048 sc1
    buffer_store_dwordx4 v[192:195], v238, s[20:23], s26 offen offset:3072 sc1
    buffer_store_dwordx4 v[192:195], v238, s[20:23], s27 offen offset:0 sc1
    buffer_store_dwordx4 v[192:195], v238, s[20:23], s27 offen offset:1024 sc1
    buffer_store_dwordx4 v[192:195], v238, s[20:23], s27 offen offset:2048 sc1
    buffer_store_dwordx4 v[192:195], v238, s[20:23], s27 offen offset:3072 sc1
    s_mov_b64 exec, 0xff
    buffer_store_dwordx4 v[192:195], v238, s[20:23], s28 offen sc1
    s_mov_b64 exec, -1
    s_branch H1_J3
H1_J2:
    s_barrier
    s_cmp_lg_u32 s3, 5
    s_cbranch_scc1 TS0
    s_mov_b64 exec, 0
    s_branch TP0
TR0:
    s_mov_b64 exec, -1
TS0:
    s_cmp_lg_u32 s3, 6
    s_cbranch_scc1 TS1
    s_mov_b64 exec, 0
    s_branch TP1
TR1:
    s_mov_b64 exec, -1
TS1:
    s_cmp_lg_u32 s3, 7
    s_cbranch_scc1 TS2
    s_mov_b64 exec, 0
    s_branch TP2
TR2:
    s_mov_b64 exec, -1
TS2:
    s_waitcnt vmcnt(0)
H1_J3:
    s_barrier
    s_cmp_eq_u32 s31, 2
    s_cbranch_scc1 H1_KW
    ds_read2st64_b32 v[128:129], v225 offset0:0 offset1:1
    ds_read2st64_b32 v[130:131], v225 offset0:4 offset1:5
    ds_read2st64_b32 v[132:133], v224 offset0:0 offset1:1
    ds_read2st64_b32 v[134:135], v224 offset0:4 offset1:5
    ds_read2st64_b32 v[136:137], v225 offset0:8 offset1:9
    ds_read2st64_b32 v[138:139], v225 offset0:12 offset1:13
    ds_read2st64_b32 v[140:141], v224 offset0:8 offset1:9
    ds_read2st64_b32 v[142:143], v224 offset0:12 offset1:13
    s_waitcnt lgkmcnt(4)
    ds_read2st64_b32 v[144:145], v225 offset0:16 offset1:17
    ds_read2st64_b32 v[146:147], v225 offset0:20 offset1:21
    ds_read2st64_b32 v[148:149], v224 offset0:16 offset1:17
    ds_read2st64_b32 v[150:151], v224 offset0:20 offset1:21
    s_waitcnt lgkmcnt(4)
    ds_read2st64_b32 v[152:153], v225 offset0:24 offset1:25
    ds_read2st64_b32 v[154:155], v225 offset0:28 offset1:29
    ds_read2st64_b32 v[156:157], v224 offset0:24 offset1:25
    ds_read2st64_b32 v[158:159], v224 offset0:28 offset1:29
    s_waitcnt lgkmcnt(4)
    ds_read2st64_b32 v[160:161], v225 offset0:32 offset1:33
    ds_read2st64_b32 v[162:163], v225 offset0:36 offset1:37
    ds_read2st64_b32 v[164:165], v224 offset0:32 offset1:33
    ds_read2st64_b32 v[166:167], v224 offset0:36 offset1:37
    s_waitcnt lgkmcnt(4)
    ds_read2st64_b32 v[168:169], v225 offset0:40 offset1:41
    ds_read2st64_b32 v[170:171], v225 offset0:44 offset1:45
    ds_read2st64_b32 v[172:173], v224 offset0:40 offset1:41
    ds_read2st64_b32 v[174:175], v224 offset0:44 offset1:45
    s_waitcnt lgkmcnt(4)
    ds_read2st64_b32 v[176:177], v225 offset0:48 offset1:49
    ds_read2st64_b32 v[178:179], v225 offset0:52 offset1:53
    ds_read2st64_b32 v[180:181], v224 offset0:48 offset1:49
    ds_read2st64_b32 v[182:183], v224 offset0:52 offset1:53
    s_waitcnt lgkmcnt(4)
    ds_read2st64_b32 v[184:185], v225 offset0:56 offset1:57
    ds_read2st64_b32 v[186:187], v225 offset0:60 offset1:61
    ds_read2st64_b32 v[188:189], v224 offset0:56 offset1:57
    ds_read2st64_b32 v[190:191], v224 offset0:60 offset1:61
    s_branch H1_KW
H1_N0:
    s_nop 0
    v_and_b32 v32, v10, v32
    s_nop 0
    s_branch H1_M0
H1_N1:
    s_nop 0
    v_and_b32 v48, v10, v48
    s_nop 0
    s_branch H1_M1
H1_N2:
    s_nop 0
    v_and_b32 v32, v10, v32
    s_nop 0
    s_branch H1_M2
H1_N3:
    s_nop 0
    v_and_b32 v48, v10, v48
    s_nop 0
    s_branch H1_M3
H1_N4:
    s_nop 0
    v_and_b32 v32, v10, v32
    s_nop 0
    s_branch H1_M4
H1_N5:
    s_nop 0
    v_and_b32 v48, v10, v48
    s_nop 0
    s_branch H1_M5
H1_N6:
    s_nop 0
    v_and_b32 v32, v10, v32
    s_nop 0
    s_branch H1_M6
H1_N7:
    s_nop 0
    v_and_b32 v48, v10, v48
    s_nop 0
    s_branch H1_M7
H1_KW:
    s_barrier
    v_add_u32 v238, s43, v238
    s_add_u32 m0, s43, 0
    s_nop 0
    buffer_load_dwordx4 v240, s[20:23], s32 offen sc1 lds
    s_add_u32 m0, s43, 8192
    s_nop 0
    buffer_load_dwordx4 v240, s[20:23], s33 offen sc1 lds
    s_barrier
    s_add_u32 m0, s43, 16384
    s_nop 0
    buffer_load_dwordx4 v240, s[20:23], s34 offen sc1 lds
    s_add_u32 m0, s43, 24576
    s_nop 0
    buffer_load_dwordx4 v240, s[20:23], s35 offen sc1 lds
    s_add_u32 m0, s43, 32768
    s_nop 0
    buffer_load_dwordx4 v240, s[20:23], s36 offen sc1 lds
    s_add_u32 m0, s43, 40960
    s_nop 0
    buffer_load_dwordx4 v240, s[20:23], s37 offen sc1 lds
    s_add_u32 m0, s43, 49152
    s_nop 0
    buffer_load_dwordx4 v240, s[20:23], s38 offen sc1 lds
    s_add_u32 m0, s43, 57344
    s_nop 0
    buffer_load_dwordx4 v240, s[20:23], s39 offen sc1 lds
    s_waitcnt vmcnt(7)
    ds_read_b128 v[192:195], v238 offset:0
    s_waitcnt lgkmcnt(0)
    v_cmp_u_f32 vcc, v192, v194
    s_cbranch_vccnz H1_XR0
H1_XK0:
    s_barrier
    ds_read_b64_tr_b16 v[32:33], v4 offset:0
    ds_read_b64_tr_b16 v[34:35], v4 offset:4096
    ds_read_b64_tr_b16 v[36:37], v5 offset:256
    ds_read_b64_tr_b16 v[38:39], v5 offset:4352
    s_waitcnt vmcnt(6)
    ds_read_b128 v[196:199], v238 offset:8192
    s_waitcnt vmcnt(5)
    ds_read_b128 v[200:203], v238 offset:16384
    s_waitcnt lgkmcnt(0)
    v_mfma_f32_16x16x32_bf16 v[12:15], v[36:39], v[36:39], 0
    v_max3_u32 v196, v196, v198, v200
    v_cmp_u_f32 vcc, v196, v202
    s_cbranch_vccnz H1_XR1
H1_XK1:
    s_barrier
    ds_read_b64_tr_b16 v[48:49], v4 offset:8192
    ds_read_b64_tr_b16 v[50:51], v4 offset:12288
    s_cmp_eq_u32 s18, 0
    s_cbranch_scc1 H1_N0
H1_M0:
    v_mfma_f32_16x16x32_bf16 v[12:15], v[32:35], v[32:35], v[12:15]
    ds_read_b64_tr_b16 v[52:53], v5 offset:8448
    ds_read_b64_tr_b16 v[54:55], v5 offset:12544
    s_cmp_eq_u32 s31, 2
    s_cbranch_scc1 H1_KS1
    s_cmp_eq_u32 s31, 1
    s_cbranch_scc1 H1_V0
    v_mfma_f32_16x16x32_bf16 v[232:235], v[128:131], v[32:35], 0
    v_mfma_f32_16x16x32_bf16 v[232:235], v[132:135], v[36:39], v[232:235]
    s_branch H1_KS1
H1_V0:
    v_mfma_f32_16x16x32_bf16 v[232:235], v[32:35], v[128:131], 0
    v_mfma_f32_16x16x32_bf16 v[232:235], v[36:39], v[132:135], v[232:235]
H1_KS1:
    s_waitcnt vmcnt(4)
    ds_read_b128 v[204:207], v238 offset:24576
    s_waitcnt vmcnt(3)
    ds_read_b128 v[208:211], v238 offset:32768
    s_waitcnt lgkmcnt(0)
    v_mfma_f32_16x16x32_bf16 v[12:15], v[52:55], v[52:55], v[12:15]
    v_max3_u32 v204, v204, v206, v208
    v_cmp_u_f32 vcc, v204, v210
    s_cbranch_vccnz H1_XR3
H1_XK3:
    ds_read_b64_tr_b16 v[32:33], v4 offset:16384
    ds_read_b64_tr_b16 v[34:35], v4 offset:20480
    s_cmp_eq_u32 s18, 1
    s_cbranch_scc1 H1_N1
H1_M1:
    v_mfma_f32_16x16x32_bf16 v[12:15], v[48:51], v[48:51], v[12:15]
    ds_read_b64_tr_b16 v[36:37], v5 offset:16640
    ds_read_b64_tr_b16 v[38:39], v5 offset:20736
    s_cmp_eq_u32 s31, 2
    s_cbranch_scc1 H1_KS2
    s_cmp_eq_u32 s31, 1
    s_cbranch_scc1 H1_V1
    v_mfma_f32_16x16x32_bf16 v[232:235], v[136:139], v[48:51], v[232:235]
    v_mfma_f32_16x16x32_bf16 v[232:235], v[140:143], v[52:55], v[232:235]
    s_branch H1_KS2
H1_V1:
    v_mfma_f32_16x16x32_bf16 v[232:235], v[48:51], v[136:139], v[232:235]
    v_mfma_f32_16x16x32_bf16 v[232:235], v[52:55], v[140:143], v[232:235]
H1_KS2:
    s_waitcnt vmcnt(2)
    ds_read_b128 v[212:215], v238 offset:40960
    s_waitcnt vmcnt(1)
    ds_read_b128 v[216:219], v238 offset:49152
    s_waitcnt vmcnt(0)
    ds_read_b128 v[220:223], v238 offset:57344
    s_waitcnt lgkmcnt(0)
    v_mfma_f32_16x16x32_bf16 v[12:15], v[36:39], v[36:39], v[12:15]
    v_max3_u32 v212, v212, v214, v216
    v_max3_u32 v212, v212, v218, v220
    v_cmp_u_f32 vcc, v212, v222
    s_cbranch_vccnz H1_XR5
H1_XK5:
    s_barrier
    ds_read_b64_tr_b16 v[48:49], v4 offset:24576
    ds_read_b64_tr_b16 v[50:51], v4 offset:28672
    s_cmp_eq_u32 s18, 2
    s_cbranch_scc1 H1_N2
H1_M2:
    v_mfma_f32_16x16x32_bf16 v[12:15], v[32:35], v[32:35], v[12:15]
    ds_read_b64_tr_b16 v[52:53], v5 offset:24832
    ds_read_b64_tr_b16 v[54:55], v5 offset:28928
    s_cmp_eq_u32 s31, 2
    s_cbranch_scc1 H1_KS3
    s_cmp_eq_u32 s31, 1
    s_cbranch_scc1 H1_V2
    v_mfma_f32_16x16x32_bf16 v[232:235], v[144:147], v[32:35], v[232:235]
    v_mfma_f32_16x16x32_bf16 v[232:235], v[148:151], v[36:39], v[232:235]
    s_branch H1_KS3
H1_V2:
    v_mfma_f32_16x16x32_bf16 v[232:235], v[32:35], v[144:147], v[232:235]
    v_mfma_f32_16x16x32_bf16 v[232:235], v[36:39], v[148:151], v[232:235]
H1_KS3:
    s_waitcnt lgkmcnt(0)
    v_mfma_f32_16x16x32_bf16 v[12:15], v[52:55], v[52:55], v[12:15]
    ds_read_b64_tr_b16 v[32:33], v4 offset:32768
    ds_read_b64_tr_b16 v[34:35], v4 offset:36864
    s_cmp_eq_u32 s18, 3
    s_cbranch_scc1 H1_N3
H1_M3:
    v_mfma_f32_16x16x32_bf16 v[12:15], v[48:51], v[48:51], v[12:15]
    ds_read_b64_tr_b16 v[36:37], v5 offset:33024
    ds_read_b64_tr_b16 v[38:39], v5 offset:37120
    s_cmp_eq_u32 s31, 2
    s_cbranch_scc1 H1_KS4
    s_cmp_eq_u32 s31, 1
    s_cbranch_scc1 H1_V3
    v_mfma_f32_16x16x32_bf16 v[232:235], v[152:155], v[48:51], v[232:235]
    v_mfma_f32_16x16x32_bf16 v[232:235], v[156:159], v[52:55], v[232:235]
    s_branch H1_KS4
H1_V3:
    v_mfma_f32_16x16x32_bf16 v[232:235], v[48:51], v[152:155], v[232:235]
    v_mfma_f32_16x16x32_bf16 v[232:235], v[52:55], v[156:159], v[232:235]
H1_KS4:
    s_waitcnt lgkmcnt(0)
    v_mfma_f32_16x16x32_bf16 v[12:15], v[36:39], v[36:39], v[12:15]
    ds_read_b64_tr_b16 v[48:49], v4 offset:40960
    ds_read_b64_tr_b16 v[50:51], v4 offset:45056
    s_cmp_eq_u32 s18, 4
    s_cbranch_scc1 H1_N4
H1_M4:
    v_mfma_f32_16x16x32_bf16 v[12:15], v[32:35], v[32:35], v[12:15]
    ds_read_b64_tr_b16 v[52:53], v5 offset:41216
    ds_read_b64_tr_b16 v[54:55], v5 offset:45312
    s_cmp_eq_u32 s31, 2
    s_cbranch_scc1 H1_KS5
    s_cmp_eq_u32 s31, 1
    s_cbranch_scc1 H1_V4
    v_mfma_f32_16x16x32_bf16 v[232:235], v[160:163], v[32:35], v[232:235]
    v_mfma_f32_16x16x32_bf16 v[232:235], v[164:167], v[36:39], v[232:235]
    s_branch H1_KS5
H1_V4:
    v_mfma_f32_16x16x32_bf16 v[232:235], v[32:35], v[160:163], v[232:235]
    v_mfma_f32_16x16x32_bf16 v[232:235], v[36:39], v[164:167], v[232:235]
H1_KS5:
    s_waitcnt lgkmcnt(0)
    v_mfma_f32_16x16x32_bf16 v[12:15], v[52:55], v[52:55], v[12:15]
    ds_read_b64_tr_b16 v[32:33], v4 offset:49152
    ds_read_b64_tr_b16 v[34:35], v4 offset:53248
    s_cmp_eq_u32 s18, 5
    s_cbranch_scc1 H1_N5
H1_M5:
    v_mfma_f32_16x16x32_bf16 v[12:15], v[48:51], v[48:51], v[12:15]
    ds_read_b64_tr_b16 v[36:37], v5 offset:49408
    ds_read_b64_tr_b16 v[38:39], v5 offset:53504
    s_cmp_eq_u32 s31, 2
    s_cbranch_scc1 H1_KS6
    s_cmp_eq_u32 s31, 1
    s_cbranch_scc1 H1_V5
    v_mfma_f32_16x16x32_bf16 v[232:235], v[168:171], v[48:51], v[232:235]
    v_mfma_f32_16x16x32_bf16 v[232:235], v[172:175], v[52:55], v[232:235]
    s_branch H1_KS6
H1_V5:
    v_mfma_f32_16x16x32_bf16 v[232:235], v[48:51], v[168:171], v[232:235]
    v_mfma_f32_16x16x32_bf16 v[232:235], v[52:55], v[172:175], v[232:235]
H1_KS6:
    s_waitcnt lgkmcnt(0)
    v_mfma_f32_16x16x32_bf16 v[12:15], v[36:39], v[36:39], v[12:15]
    ds_read_b64_tr_b16 v[48:49], v4 offset:57344
    ds_read_b64_tr_b16 v[50:51], v4 offset:61440
    s_cmp_eq_u32 s18, 6
    s_cbranch_scc1 H1_N6
H1_M6:
    v_mfma_f32_16x16x32_bf16 v[12:15], v[32:35], v[32:35], v[12:15]
    ds_read_b64_tr_b16 v[52:53], v5 offset:57600
    ds_read_b64_tr_b16 v[54:55], v5 offset:61696
    s_cmp_eq_u32 s31, 2
    s_cbranch_scc1 H1_KS7
    s_cmp_eq_u32 s31, 1
    s_cbranch_scc1 H1_V6
    v_mfma_f32_16x16x32_bf16 v[232:235], v[176:179], v[32:35], v[232:235]
    v_mfma_f32_16x16x32_bf16 v[232:235], v[180:183], v[36:39], v[232:235]
    s_branch H1_KS7
H1_V6:
    v_mfma_f32_16x16x32_bf16 v[232:235], v[32:35], v[176:179], v[232:235]
    v_mfma_f32_16x16x32_bf16 v[232:235], v[36:39], v[180:183], v[232:235]
H1_KS7:
    s_waitcnt lgkmcnt(0)
    v_mfma_f32_16x16x32_bf16 v[12:15], v[52:55], v[52:55], v[12:15]
    s_cmp_eq_u32 s18, 7
    s_cbranch_scc1 H1_N7
H1_M7:
    v_mfma_f32_16x16x32_bf16 v[12:15], v[48:51], v[48:51], v[12:15]
    s_nop 7
    v_cndmask_b32 v12, v12, v13, s[12:13]
    v_cndmask_b32 v14, v14, v15, s[12:13]
    v_cndmask_b32 v12, v12, v14, s[14:15]
    v_fmamk_f32 v12, v12, 0x3b000000, v11
    v_rsq_f32 v12, v12
    s_mov_b64 exec, s[16:17]
    ds_write_b32 v8, v12
    s_mov_b64 exec, -1
    s_cmp_eq_u32 s31, 2
    s_cbranch_scc1 H1_KS8
    s_cmp_eq_u32 s31, 1
    s_cbranch_scc1 H1_V7
    v_mfma_f32_16x16x32_bf16 v[232:235], v[184:187], v[48:51], v[232:235]
    v_mfma_f32_16x16x32_bf16 v[232:235], v[188:191], v[52:55], v[232:235]
    s_branch H1_KS8
H1_V7:
    v_mfma_f32_16x16x32_bf16 v[232:235], v[48:51], v[184:187], v[232:235]
    v_mfma_f32_16x16x32_bf16 v[232:235], v[52:55], v[188:191], v[232:235]
H1_KS8:
    s_waitcnt lgkmcnt(0)
    s_barrier
    s_cmp_eq_u32 s31, 2
    s_cbranch_scc1 H1_KS9
    v_lshl_add_u32 v226, v3, 4, s8
    ds_read_b128 v[228:231], v226
    v_lshl_add_u32 v226, v2, 2, s8
    s_cmp_eq_u32 s31, 1
    s_cbranch_scc1 H1_KV1
    ds_read_b32 v228, v226
    ds_read_b32 v229, v226
    ds_read_b32 v230, v226
    ds_read_b32 v231, v226
H1_KV1:
    s_waitcnt lgkmcnt(0)
    v_pk_mul_f32 v[232:233], v[232:233], v[228:229]
    v_pk_mul_f32 v[234:235], v[234:235], v[230:231]
    v_cvt_pk_bf16_f32 v232, v232, v233
    v_cvt_pk_bf16_f32 v233, v234, v235
    buffer_store_dwordx2 v[232:233], v227, s[20:23], s9 offen sc1
H1_KS9:
A1_GO:
    s_setprio 3
TP0:
    s_cbranch_execz TR0
    v_mov_b32 v160, 0
    v_mov_b32 v161, 0
    v_mov_b32 v162, 0
    v_mov_b32 v163, 0
    v_lshlrev_b32 v1, 4, v0
    v_mov_b32 v11, 0
    v_mfma_f32_32x32x16_bf16 v[144:159], v[160:163], v[160:163], 0
    ds_write_b64 v11, v[160:161] offset:60416
    v_and_b32 v14, 59, v0
    v_cmp_eq_u32 vcc, 16, v14
    v_mov_b32 v15, 0xbf80bf80
    v_mov_b32 v220, 0xbafebf80
    v_mov_b32 v221, v220
    v_cndmask_b32 v224, 0, v15, vcc
    v_mov_b32 v222, v220
    v_mov_b32 v223, v220
    v_mov_b32 v225, 0
    v_mov_b32 v226, 0
    v_mov_b32 v227, 0
    s_and_b32 s24, s2, 7
    s_lshl_b32 s24, s24, 5
    v_mfma_f32_32x32x16_bf16 v[48:63], v[220:223], v[224:227], 0
    s_lshr_b32 s25, s2, 3
    s_add_u32 s4, s24, s25
    s_lshl_b32 s24, s4, 13
    s_add_u32 s5, s24, 0x480000
    s_lshl_b32 s25, s3, 13
    s_add_u32 s6, s25, 0xd00000
    s_add_u32 s8, s6, 0x10000
    s_mov_b32 s22, 0x1d22000
    s_mov_b32 s23, 0x20000
    s_add_u32 s7, s6, 4096
    s_add_u32 s9, s8, 4096
    s_add_u32 s10, s25, 0xc00000
    s_add_u32 s11, s10, 4096
    s_lshl_b32 s25, s3, 10
    s_mov_b32 m0, s25
    v_mfma_f32_32x32x16_bf16 v[240:255], v[160:163], v[160:163], 0
    s_add_u32 s14, s5, s25
    v_add_u32 v14, s25, v1
    ds_write_b128 v14, v[220:223] offset:49152
    s_mov_b32 s32, 0xffff
    s_mov_b32 s33, 0xffff
    v_mov_b32 v164, 0x4444dddd
    v_and_b32 v2, 15, v0
    v_lshrrev_b32 v3, 4, v0
    v_mfma_f32_32x32x16_bf16 v[64:79], v[220:223], v[224:227], 0
    s_add_u32 s30, s10, 0x70000
    s_add_u32 s31, s10, 0x71000
    s_lshr_b32 s15, s4, 3
    s_mul_i32 s15, s15, 65792
    s_and_b32 s24, s4, 7
    s_lshl_b32 s24, s24, 4
    s_add_u32 s15, s15, s24
    s_add_u32 s15, s15, s6
    s_add_u32 s15, s15, 0xff540000
    s_waitcnt lgkmcnt(0)
    v_lshrrev_b32 v14, 5, v0
    v_lshl_add_u32 v9, v14, 5, v2
    v_lshlrev_b32 v9, 7, v9
    v_and_b32 v14, 1, v3
    v_lshl_add_u32 v9, v14, 3, v9
    v_and_b32 v12, 31, v0
    v_lshrrev_b32 v13, 5, v0
    s_mul_i32 s24, s3, 2560
    v_mul_u32_u24 v4, 80, v12
    v_add_u32 v4, s24, v4
    s_mul_i32 s24, s3, 36
    v_xor_b32 v5, s24, v12
    v_lshlrev_b32 v5, 2, v5
    v_lshl_add_u32 v4, v13, 4, v4
    s_lshl_b32 s24, s3, 2
    v_add_u32 v14, s24, v3
    v_mfma_f32_32x32x16_bf16 v[80:95], v[220:223], v[224:227], 0
    v_and_b32 v15, 7, v0
    v_mul_u32_u24 v239, 36, v15
    v_xor_b32 v239, v239, v14
    v_lshlrev_b32 v239, 2, v239
    v_mul_u32_u24 v14, 80, v14
    v_lshl_add_u32 v6, v2, 2, v14
    v_add_u32 v6, 8192, v6
    v_mul_u32_u24 v237, 160, v15
    v_lshl_add_u32 v237, v3, 5, v237
    v_mfma_f32_32x32x16_bf16 v[96:111], v[220:223], v[224:227], 0
    v_and_b32 v14, 8, v0
    v_lshl_add_u32 v237, v14, 1, v237
    v_mul_u32_u24 v14, 0x1555, v14
    v_lshl_or_b32 v164, v14, 16, v164
    v_lshl_or_b32 v164, v14, 14, v164
    s_and_b32 s24, s3, 1
    s_mul_i32 s24, s24, 640
    s_lshr_b32 s25, s3, 1
    s_lshl_b32 s25, s25, 5
    s_add_u32 s24, s24, s25
    v_mfma_f32_32x32x16_bf16 v[204:219], v[160:163], v[160:163], 0
    v_mul_u32_u24 v236, 160, v3
    v_and_b32 v14, 12, v0
    v_add_u32 v236, v14, v236
    v_and_b32 v14, 2, v0
    v_lshl_add_u32 v236, v14, 3, v236
    v_and_b32 v14, 1, v0
    v_lshl_add_u32 v236, v14, 1, v236
    v_add_u32 v236, s24, v236
    v_mov_b32 v238, 0
    s_lshl_b32 s25, s3, 10
    v_add_u32 v8, s25, v1
    s_lshr_b32 s34, s2, 3
    s_mul_i32 s34, s34, 65792
    s_and_b32 s24, s2, 7
    s_lshl_b32 s24, s24, 13
    s_add_u32 s34, s34, s24
    s_add_u32 s34, s34, s25
    s_add_u32 s34, s34, 0x1240000
    s_lshl_b32 s24, s2, 13
    s_add_u32 s24, s24, s25
    s_add_u32 s35, s24, 0x1480000
    s_add_u32 s36, s24, 0x680000
    s_lshr_b32 s24, s24, 4
    s_add_u32 s37, s24, 0x1d00000
    v_mov_b32 v12, -1
    v_mov_b32 v13, -1
    v_mov_b32 v14, -1
    v_mov_b32 v15, -1
    s_waitcnt vmcnt(0) lgkmcnt(0)
    s_barrier
    buffer_load_dwordx4 v[168:171], v1, s[20:23], s5 offen sc1
    buffer_load_dwordx4 v[16:19], v1, s[20:23], s6 offen offset:0 sc1
    s_barrier
    buffer_load_dwordx4 v[228:231], v1, s[20:23], s5 offen offset:1024 sc1
    s_mov_b64 exec, s[32:33]
    buffer_load_dwordx4 v[48:51], v1, s[20:23], s8 offen offset:0 sc1
    buffer_load_dwordx4 v[52:55], v1, s[20:23], s8 offen offset:256 sc1
    s_mov_b64 exec, -1
    buffer_load_dwordx4 v[20:23], v1, s[20:23], s6 offen offset:1024 sc1
    s_setprio 3
    s_waitcnt vmcnt(4)
    v_cmp_u_f32 vcc, v168, v170
    s_cbranch_vccnz A1_CKq0_R
    v_cmp_u_f32 vcc, v16, v18
    s_cbranch_vccnz A1_CKq0_R
A1_CKq0_K:
    v_mfma_f32_32x32x16_bf16 v[112:127], v[16:19], v[168:171], 0
    s_nop 7
    s_nop 3
    v_exp_f32 v112, v112
    s_mov_b64 exec, s[32:33]
    buffer_load_dwordx4 v[56:59], v1, s[20:23], s8 offen offset:1024 sc1
    buffer_load_dwordx4 v[60:63], v1, s[20:23], s8 offen offset:1280 sc1
    s_mov_b64 exec, -1
    v_exp_f32 v113, v113
    v_exp_f32 v114, v114
    v_exp_f32 v115, v115
    s_waitcnt vmcnt(5)
    v_cmp_u_f32 vcc, v228, v230
    s_cbranch_vccnz A1_CKq1_R
A1_CKq1_K:
    v_mfma_f32_32x32x16_bf16 v[128:143], v[16:19], v[228:231], 0
    v_exp_f32 v116, v116
    v_exp_f32 v117, v117
    v_exp_f32 v118, v118
    v_exp_f32 v119, v119
    v_exp_f32 v120, v120
    buffer_load_dwordx4 v[24:27], v1, s[20:23], s6 offen offset:2048 sc1
    v_exp_f32 v121, v121
    s_waitcnt vmcnt(4)
    v_cmp_u_f32 vcc, v48, v50
    s_cbranch_vccnz A1_CKv0_R
    v_cmp_u_f32 vcc, v52, v54
    s_cbranch_vccnz A1_CKv0_R
A1_CKv0_K:
    v_smfmac_f32_32x32x32_bf16 v[144:159], v[48:51], v[112:119], v164
    v_exp_f32 v122, v122
    v_exp_f32 v123, v123
    v_exp_f32 v124, v124
    v_exp_f32 v125, v125
    v_exp_f32 v126, v126
    v_exp_f32 v127, v127
    v_exp_f32 v128, v128
    s_mov_b64 exec, s[32:33]
    buffer_load_dwordx4 v[64:67], v1, s[20:23], s8 offen offset:2048 sc1
    buffer_load_dwordx4 v[68:71], v1, s[20:23], s8 offen offset:2304 sc1
    s_mov_b64 exec, -1
    v_exp_f32 v129, v129
    v_smfmac_f32_32x32x32_bf16 v[144:159], v[52:55], v[120:127], v164
    v_exp_f32 v130, v130
    v_exp_f32 v131, v131
    s_waitcnt vmcnt(5)
    v_cmp_u_f32 vcc, v20, v22
    s_cbranch_vccnz A1_CKk1_R
A1_CKk1_K:
    v_mfma_f32_32x32x16_bf16 v[112:127], v[20:23], v[168:171], 0
    v_exp_f32 v132, v132
    v_exp_f32 v133, v133
    v_exp_f32 v134, v134
    v_exp_f32 v135, v135
    v_exp_f32 v136, v136
    v_exp_f32 v137, v137
    v_smfmac_f32_32x32x32_bf16 v[240:255], v[48:51], v[128:135], v164
    v_exp_f32 v138, v138
    v_exp_f32 v139, v139
    v_exp_f32 v140, v140
    v_exp_f32 v141, v141
    v_exp_f32 v142, v142
    v_exp_f32 v143, v143
    v_exp_f32 v112, v112
    buffer_load_dwordx4 v[28:31], v1, s[20:23], s6 offen offset:3072 sc1
    v_exp_f32 v113, v113
    v_smfmac_f32_32x32x32_bf16 v[240:255], v[52:55], v[136:143], v164
    v_exp_f32 v114, v114
    v_exp_f32 v115, v115
    v_mfma_f32_32x32x16_bf16 v[128:143], v[20:23], v[228:231], 0
    v_exp_f32 v116, v116
    v_exp_f32 v117, v117
    v_exp_f32 v118, v118
    v_exp_f32 v119, v119
    v_exp_f32 v120, v120
    s_mov_b64 exec, s[32:33]
    buffer_load_dwordx4 v[72:75], v1, s[20:23], s8 offen offset:3072 sc1
    buffer_load_dwordx4 v[76:79], v1, s[20:23], s8 offen offset:3328 sc1
    s_mov_b64 exec, -1
    v_exp_f32 v121, v121
    s_waitcnt vmcnt(6)
    v_cmp_u_f32 vcc, v56, v58
    s_cbranch_vccnz A1_CKv1_R
    v_cmp_u_f32 vcc, v60, v62
    s_cbranch_vccnz A1_CKv1_R
A1_CKv1_K:
    v_smfmac_f32_32x32x32_bf16 v[144:159], v[56:59], v[112:119], v164
    v_exp_f32 v122, v122
    v_exp_f32 v123, v123
    v_exp_f32 v124, v124
    v_exp_f32 v125, v125
    v_exp_f32 v126, v126
    v_exp_f32 v127, v127
    v_exp_f32 v128, v128
    buffer_load_dwordx4 v[32:35], v1, s[20:23], s7 offen offset:0 sc1
    v_exp_f32 v129, v129
    v_smfmac_f32_32x32x32_bf16 v[144:159], v[60:63], v[120:127], v164
    v_exp_f32 v130, v130
    v_exp_f32 v131, v131
    s_waitcnt vmcnt(6)
    v_cmp_u_f32 vcc, v24, v26
    s_cbranch_vccnz A1_CKk2_R
A1_CKk2_K:
    v_mfma_f32_32x32x16_bf16 v[112:127], v[24:27], v[168:171], 0
    v_exp_f32 v132, v132
    v_exp_f32 v133, v133
    v_exp_f32 v134, v134
    v_exp_f32 v135, v135
    v_exp_f32 v136, v136
    s_setprio 2
    v_exp_f32 v137, v137
    v_smfmac_f32_32x32x32_bf16 v[240:255], v[56:59], v[128:135], v164
    v_exp_f32 v138, v138
    v_exp_f32 v139, v139
    v_exp_f32 v140, v140
    v_exp_f32 v141, v141
    v_exp_f32 v142, v142
    v_exp_f32 v143, v143
    v_exp_f32 v112, v112
    s_mov_b64 exec, s[32:33]
    buffer_load_dwordx4 v[80:83], v1, s[20:23], s9 offen offset:0 sc1
    buffer_load_dwordx4 v[84:87], v1, s[20:23], s9 offen offset:256 sc1
    s_mov_b64 exec, -1
    v_exp_f32 v113, v113
    v_smfmac_f32_32x32x32_bf16 v[240:255], v[60:63], v[136:143], v164
    v_exp_f32 v114, v114
    v_exp_f32 v115, v115
    v_mfma_f32_32x32x16_bf16 v[128:143], v[24:27], v[228:231], 0
    v_exp_f32 v116, v116
    v_exp_f32 v117, v117
    v_exp_f32 v118, v118
    v_exp_f32 v119, v119
    v_exp_f32 v120, v120
    buffer_load_dwordx4 v[36:39], v1, s[20:23], s7 offen offset:1024 sc1
    v_exp_f32 v121, v121
    s_waitcnt vmcnt(7)
    v_cmp_u_f32 vcc, v64, v66
    s_cbranch_vccnz A1_CKv2_R
    v_cmp_u_f32 vcc, v68, v70
    s_cbranch_vccnz A1_CKv2_R
A1_CKv2_K:
    v_smfmac_f32_32x32x32_bf16 v[144:159], v[64:67], v[112:119], v164
    v_exp_f32 v122, v122
    v_exp_f32 v123, v123
    v_exp_f32 v124, v124
    v_exp_f32 v125, v125
    s_setprio 1
    v_exp_f32 v126, v126
    v_exp_f32 v127, v127
    v_exp_f32 v128, v128
    s_mov_b64 exec, s[32:33]
    buffer_load_dwordx4 v[88:91], v1, s[20:23], s9 offen offset:1024 sc1
    buffer_load_dwordx4 v[92:95], v1, s[20:23], s9 offen offset:1280 sc1
    s_mov_b64 exec, -1
    v_exp_f32 v129, v129
    v_smfmac_f32_32x32x32_bf16 v[144:159], v[68:71], v[120:127], v164
    v_exp_f32 v130, v130
    v_exp_f32 v131, v131
    s_waitcnt vmcnt(8)
    v_cmp_u_f32 vcc, v28, v30
    s_cbranch_vccnz A1_CKk3_R
A1_CKk3_K:
    v_mfma_f32_32x32x16_bf16 v[112:127], v[28:31], v[168:171], 0
    v_exp_f32 v132, v132
    v_exp_f32 v133, v133
    v_exp_f32 v134, v134
    v_exp_f32 v135, v135
    v_exp_f32 v136, v136
    v_exp_f32 v137, v137
    v_smfmac_f32_32x32x32_bf16 v[240:255], v[64:67], v[128:135], v164
    s_setprio 0
    v_exp_f32 v138, v138
    v_exp_f32 v139, v139
    v_exp_f32 v140, v140
    v_exp_f32 v141, v141
    v_exp_f32 v142, v142
    v_exp_f32 v143, v143
    s_setprio 3
    v_exp_f32 v112, v112
    buffer_load_dwordx4 v[40:43], v1, s[20:23], s7 offen offset:2048 sc1
    v_exp_f32 v113, v113
    v_smfmac_f32_32x32x32_bf16 v[240:255], v[68:71], v[136:143], v164
    v_exp_f32 v114, v114
    v_exp_f32 v115, v115
    v_mfma_f32_32x32x16_bf16 v[128:143], v[28:31], v[228:231], 0
    v_exp_f32 v116, v116
    v_exp_f32 v117, v117
    v_exp_f32 v118, v118
    v_exp_f32 v119, v119
    v_exp_f32 v120, v120
    s_mov_b64 exec, s[32:33]
    buffer_load_dwordx4 v[96:99], v1, s[20:23], s9 offen offset:2048 sc1
    buffer_load_dwordx4 v[100:103], v1, s[20:23], s9 offen offset:2304 sc1
    s_mov_b64 exec, -1
    v_exp_f32 v121, v121
    s_waitcnt vmcnt(9)
    v_cmp_u_f32 vcc, v72, v74
    s_cbranch_vccnz A1_CKv3_R
    v_cmp_u_f32 vcc, v76, v78
    s_cbranch_vccnz A1_CKv3_R
A1_CKv3_K:
    v_smfmac_f32_32x32x32_bf16 v[144:159], v[72:75], v[112:119], v164
    v_exp_f32 v122, v122
    v_exp_f32 v123, v123
    v_exp_f32 v124, v124
    v_exp_f32 v125, v125
    v_exp_f32 v126, v126
    v_exp_f32 v127, v127
    v_exp_f32 v128, v128
    buffer_load_dwordx4 v[44:47], v1, s[20:23], s7 offen offset:3072 sc1
    v_exp_f32 v129, v129
    v_smfmac_f32_32x32x32_bf16 v[144:159], v[76:79], v[120:127], v164
    v_exp_f32 v130, v130
    v_exp_f32 v131, v131
    s_waitcnt vmcnt(9)
    v_cmp_u_f32 vcc, v32, v34
    s_cbranch_vccnz A1_CKk4_R
A1_CKk4_K:
    v_mfma_f32_32x32x16_bf16 v[112:127], v[32:35], v[168:171], 0
    v_exp_f32 v132, v132
    v_exp_f32 v133, v133
    v_exp_f32 v134, v134
    v_exp_f32 v135, v135
    v_exp_f32 v136, v136
    s_setprio 2
    s_mov_b64 exec, s[32:33]
    buffer_load_dwordx4 v[104:107], v1, s[20:23], s9 offen offset:3072 sc1
    buffer_load_dwordx4 v[108:111], v1, s[20:23], s9 offen offset:3328 sc1
    s_mov_b64 exec, -1
    v_exp_f32 v137, v137
    v_smfmac_f32_32x32x32_bf16 v[240:255], v[72:75], v[128:135], v164
    v_exp_f32 v138, v138
    v_exp_f32 v139, v139
    v_exp_f32 v140, v140
    v_exp_f32 v141, v141
    v_exp_f32 v142, v142
    v_exp_f32 v143, v143
    v_exp_f32 v112, v112
    buffer_load_dwordx4 v[220:223], v1, s[20:23], s14 offen sc1
    v_exp_f32 v113, v113
    v_smfmac_f32_32x32x32_bf16 v[240:255], v[76:79], v[136:143], v164
    v_exp_f32 v114, v114
    v_exp_f32 v115, v115
    s_waitcnt vmcnt(9)
    v_cmp_u_f32 vcc, v36, v38
    s_cbranch_vccnz A1_CKk5_R
A1_CKk5_K:
    v_mfma_f32_32x32x16_bf16 v[128:143], v[36:39], v[168:171], 0
    v_exp_f32 v116, v116
    v_exp_f32 v117, v117
    v_exp_f32 v118, v118
    v_exp_f32 v119, v119
    v_exp_f32 v120, v120
    v_exp_f32 v121, v121
    s_waitcnt vmcnt(10)
    v_cmp_u_f32 vcc, v80, v82
    s_cbranch_vccnz A1_CKv4_R
    v_cmp_u_f32 vcc, v84, v86
    s_cbranch_vccnz A1_CKv4_R
A1_CKv4_K:
    v_smfmac_f32_32x32x32_bf16 v[144:159], v[80:83], v[112:119], v164
    v_exp_f32 v122, v122
    v_exp_f32 v123, v123
    v_exp_f32 v124, v124
    v_exp_f32 v125, v125
    s_setprio 1
    v_exp_f32 v126, v126
    v_exp_f32 v127, v127
    v_exp_f32 v128, v128
    v_exp_f32 v129, v129
    v_smfmac_f32_32x32x32_bf16 v[144:159], v[84:87], v[120:127], v164
    v_exp_f32 v130, v130
    v_exp_f32 v131, v131
    s_waitcnt vmcnt(6)
    v_cmp_u_f32 vcc, v40, v42
    s_cbranch_vccnz A1_CKk6_R
A1_CKk6_K:
    v_mfma_f32_32x32x16_bf16 v[112:127], v[40:43], v[168:171], 0
    v_exp_f32 v132, v132
    v_exp_f32 v133, v133
    v_exp_f32 v134, v134
    v_exp_f32 v135, v135
    v_exp_f32 v136, v136
    v_exp_f32 v137, v137
    s_waitcnt vmcnt(7)
    v_cmp_u_f32 vcc, v88, v90
    s_cbranch_vccnz A1_CKv5_R
    v_cmp_u_f32 vcc, v92, v94
    s_cbranch_vccnz A1_CKv5_R
A1_CKv5_K:
    v_smfmac_f32_32x32x32_bf16 v[144:159], v[88:91], v[128:135], v164
    s_setprio 0
    v_exp_f32 v138, v138
    v_exp_f32 v139, v139
    v_exp_f32 v140, v140
    v_exp_f32 v141, v141
    v_exp_f32 v142, v142
    v_exp_f32 v143, v143
    s_setprio 3
    v_exp_f32 v112, v112
    buffer_load_dwordx4 v[172:175], v1, s[20:23], s10 offen offset:0
    v_exp_f32 v113, v113
    v_smfmac_f32_32x32x32_bf16 v[144:159], v[92:95], v[136:143], v164
    v_exp_f32 v114, v114
    v_exp_f32 v115, v115
    s_waitcnt vmcnt(4)
    v_cmp_u_f32 vcc, v44, v46
    s_cbranch_vccnz A1_CKk7_R
A1_CKk7_K:
    v_mfma_f32_32x32x16_bf16 v[128:143], v[44:47], v[168:171], 0
    v_exp_f32 v116, v116
    v_exp_f32 v117, v117
    v_exp_f32 v118, v118
    v_exp_f32 v119, v119
    v_exp_f32 v120, v120
    v_exp_f32 v121, v121
    s_waitcnt vmcnt(5)
    v_cmp_u_f32 vcc, v96, v98
    s_cbranch_vccnz A1_CKv6_R
    v_cmp_u_f32 vcc, v100, v102
    s_cbranch_vccnz A1_CKv6_R
A1_CKv6_K:
    v_smfmac_f32_32x32x32_bf16 v[144:159], v[96:99], v[112:119], v164
    v_exp_f32 v122, v122
    v_exp_f32 v123, v123
    v_exp_f32 v124, v124
    v_exp_f32 v125, v125
    v_exp_f32 v126, v126
    v_exp_f32 v127, v127
    v_exp_f32 v128, v128
    buffer_load_dwordx4 v[176:179], v1, s[20:23], s10 offen offset:1024
    v_exp_f32 v129, v129
    v_smfmac_f32_32x32x32_bf16 v[144:159], v[100:103], v[120:127], v164
    v_exp_f32 v130, v130
    v_exp_f32 v131, v131
    v_mfma_f32_32x32x16_bf16 v[112:127], v[32:35], v[228:231], 0
    v_exp_f32 v132, v132
    v_exp_f32 v133, v133
    v_exp_f32 v134, v134
    v_exp_f32 v135, v135
    v_exp_f32 v136, v136
    s_setprio 2
    v_exp_f32 v137, v137
    s_waitcnt vmcnt(3)
    v_cmp_u_f32 vcc, v104, v106
    s_cbranch_vccnz A1_CKv7_R
    v_cmp_u_f32 vcc, v108, v110
    s_cbranch_vccnz A1_CKv7_R
A1_CKv7_K:
    v_smfmac_f32_32x32x32_bf16 v[144:159], v[104:107], v[128:135], v164
    v_exp_f32 v138, v138
    v_exp_f32 v139, v139
    v_exp_f32 v140, v140
    v_exp_f32 v141, v141
    v_exp_f32 v142, v142
    v_exp_f32 v143, v143
    v_exp_f32 v112, v112
    v_exp_f32 v113, v113
    v_smfmac_f32_32x32x32_bf16 v[144:159], v[108:111], v[136:143], v164
    v_exp_f32 v114, v114
    v_exp_f32 v115, v115
    v_mfma_f32_32x32x16_bf16 v[128:143], v[36:39], v[228:231], 0
    v_exp_f32 v116, v116
    v_exp_f32 v117, v117
    v_exp_f32 v118, v118
    buffer_load_dwordx4 v[180:183], v1, s[20:23], s10 offen offset:2048
    v_exp_f32 v119, v119
    v_exp_f32 v120, v120
    v_exp_f32 v121, v121
    v_smfmac_f32_32x32x32_bf16 v[240:255], v[80:83], v[112:119], v164
    s_waitcnt vmcnt(3)
    v_cmp_u_f32 vcc, v220, v222
    s_cbranch_vccnz A1_CKqd_R
A1_CKqd_K:
    ds_write_b128 v8, v[220:223] offset:0
    v_exp_f32 v122, v122
    v_exp_f32 v123, v123
    ds_write_b128 v4, v[144:147] offset:8192
    v_exp_f32 v124, v124
    ds_write_b128 v4, v[148:151] offset:8224
    v_exp_f32 v125, v125
    s_setprio 1
    ds_write_b32 v5, v152 offset:49152
    v_exp_f32 v126, v126
    v_exp_f32 v127, v127
    v_exp_f32 v128, v128
    v_exp_f32 v129, v129
    v_smfmac_f32_32x32x32_bf16 v[240:255], v[84:87], v[120:127], v164
    v_exp_f32 v130, v130
    v_exp_f32 v131, v131
    v_mfma_f32_32x32x16_bf16 v[112:127], v[40:43], v[228:231], 0
    v_exp_f32 v132, v132
    v_exp_f32 v133, v133
    v_exp_f32 v134, v134
    buffer_load_dwordx4 v[184:187], v1, s[20:23], s10 offen offset:3072
    s_add_u32 s10, s10, 0x10000
    v_exp_f32 v135, v135
    v_exp_f32 v136, v136
    v_exp_f32 v137, v137
    v_smfmac_f32_32x32x32_bf16 v[240:255], v[88:91], v[128:135], v164
    s_setprio 0
    v_exp_f32 v138, v138
    v_exp_f32 v139, v139
    v_exp_f32 v140, v140
    v_exp_f32 v141, v141
    v_exp_f32 v142, v142
    v_exp_f32 v143, v143
    s_setprio 3
    v_exp_f32 v112, v112
    v_exp_f32 v113, v113
    v_smfmac_f32_32x32x32_bf16 v[240:255], v[92:95], v[136:143], v164
    v_exp_f32 v114, v114
    ds_read_b32 v10, v239 offset:49152
    ds_read2st64_b32 v[220:221], v6 offset0:0 offset1:10
    ds_read2st64_b32 v[222:223], v6 offset0:20 offset1:30
    ds_read2st64_b32 v[224:225], v6 offset0:40 offset1:50
    ds_read2st64_b32 v[226:227], v6 offset0:60 offset1:70
    ds_read_b128 v[168:171], v1 offset:2048
    v_exp_f32 v115, v115
    v_mfma_f32_32x32x16_bf16 v[128:143], v[44:47], v[228:231], 0
    v_exp_f32 v116, v116
    v_exp_f32 v117, v117
    v_exp_f32 v118, v118
    buffer_load_dwordx4 v[188:191], v1, s[20:23], s11 offen offset:0
    v_exp_f32 v119, v119
    v_exp_f32 v120, v120
    v_exp_f32 v121, v121
    v_smfmac_f32_32x32x32_bf16 v[240:255], v[96:99], v[112:119], v164
    v_exp_f32 v122, v122
    s_waitcnt lgkmcnt(0)
    v_cmp_gt_f32 vcc, 0, v10
    s_cbranch_vccnz A1_SP0
A1_OK0:
    v_add_f32 v10, v10, v10 quad_perm:[1,0,3,2] row_mask:0xf bank_mask:0xf
    v_pk_add_f32 v[220:221], v[220:221], v[222:223]
    v_pk_add_f32 v[224:225], v[224:225], v[226:227]
    v_add_f32 v10, v10, v10 quad_perm:[2,3,0,1] row_mask:0xf bank_mask:0xf
    v_pk_add_f32 v[220:221], v[220:221], v[224:225]
    v_add_f32 v220, v220, v221
    v_add_f32 v10, v10, v10 row_half_mirror row_mask:0xf bank_mask:0xf
    v_rcp_f32 v221, v10
    v_exp_f32 v123, v123
    v_exp_f32 v124, v124
    v_mul_f32 v220, v220, v221
    v_max3_f32 v238, v238, v10, v221
    v_cvt_pk_bf16_f32 v220, v220, v220
    ds_write_b16 v236, v220 offset:57344
    v_exp_f32 v125, v125
    v_exp_f32 v126, v126
    v_exp_f32 v127, v127
    v_exp_f32 v128, v128
    v_exp_f32 v129, v129
    v_smfmac_f32_32x32x32_bf16 v[240:255], v[100:103], v[120:127], v164
TP1:
    s_cbranch_execz TR1
    v_exp_f32 v130, v130
    v_exp_f32 v131, v131
    v_mfma_f32_32x32x16_bf16 v[112:127], v[16:19], v[168:171], 0
    v_exp_f32 v132, v132
    v_exp_f32 v133, v133
    v_exp_f32 v134, v134
    v_mfma_f32_32x32x16_bf16 v[144:159], v[160:163], v[160:163], 0
    buffer_load_dwordx4 v[192:195], v1, s[20:23], s11 offen offset:1024
    v_exp_f32 v135, v135
    v_exp_f32 v136, v136
    s_setprio 2
    v_exp_f32 v137, v137
    v_smfmac_f32_32x32x32_bf16 v[240:255], v[104:107], v[128:135], v164
    v_exp_f32 v138, v138
    v_exp_f32 v139, v139
    v_exp_f32 v140, v140
    v_exp_f32 v141, v141
    v_exp_f32 v142, v142
    v_exp_f32 v143, v143
    v_exp_f32 v112, v112
    v_exp_f32 v113, v113
    v_smfmac_f32_32x32x32_bf16 v[240:255], v[108:111], v[136:143], v164
    v_exp_f32 v114, v114
    v_exp_f32 v115, v115
    v_mfma_f32_32x32x16_bf16 v[128:143], v[20:23], v[168:171], 0
    v_exp_f32 v116, v116
    v_exp_f32 v117, v117
    v_exp_f32 v118, v118
    buffer_load_dwordx4 v[196:199], v1, s[20:23], s11 offen offset:2048
    v_exp_f32 v119, v119
    v_exp_f32 v120, v120
    v_exp_f32 v121, v121
    v_smfmac_f32_32x32x32_bf16 v[144:159], v[48:51], v[112:119], v164
    v_exp_f32 v122, v122
    v_exp_f32 v123, v123
    ds_write_b128 v4, v[240:243] offset:28672
    v_exp_f32 v124, v124
    ds_write_b128 v4, v[244:247] offset:28704
    v_exp_f32 v125, v125
    s_setprio 1
    ds_write_b32 v5, v248 offset:50176
    v_exp_f32 v126, v126
    v_exp_f32 v127, v127
    v_exp_f32 v128, v128
    v_exp_f32 v129, v129
    v_smfmac_f32_32x32x32_bf16 v[144:159], v[52:55], v[120:127], v164
    v_exp_f32 v130, v130
    v_exp_f32 v131, v131
    v_mfma_f32_32x32x16_bf16 v[112:127], v[24:27], v[168:171], 0
    v_exp_f32 v132, v132
    v_exp_f32 v133, v133
    v_exp_f32 v134, v134
    buffer_load_dwordx4 v[200:203], v1, s[20:23], s11 offen offset:3072
    s_add_u32 s11, s11, 0x10000
    v_mfma_f32_32x32x16_bf16 v[240:255], v[160:163], v[160:163], 0
    v_exp_f32 v135, v135
    v_exp_f32 v136, v136
    v_exp_f32 v137, v137
    v_smfmac_f32_32x32x32_bf16 v[144:159], v[56:59], v[128:135], v164
    s_setprio 0
    v_exp_f32 v138, v138
    v_exp_f32 v139, v139
    v_exp_f32 v140, v140
    v_exp_f32 v141, v141
    v_exp_f32 v142, v142
    v_exp_f32 v143, v143
    s_setprio 3
    v_exp_f32 v112, v112
    v_exp_f32 v113, v113
    v_smfmac_f32_32x32x32_bf16 v[144:159], v[60:63], v[136:143], v164
    v_exp_f32 v114, v114
    v_exp_f32 v115, v115
    v_mfma_f32_32x32x16_bf16 v[128:143], v[28:31], v[168:171], 0
    v_exp_f32 v116, v116
    v_exp_f32 v117, v117
    v_exp_f32 v118, v118
    buffer_store_dwordx4 v[12:15], v1, s[20:23], s34 offen sc1
    ds_read_b32 v10, v239 offset:50176
    ds_read2st64_b32 v[220:221], v6 offset0:80 offset1:90
    ds_read2st64_b32 v[222:223], v6 offset0:100 offset1:110
    ds_read2st64_b32 v[224:225], v6 offset0:120 offset1:130
    ds_read2st64_b32 v[226:227], v6 offset0:140 offset1:150
    ds_read_b128 v[228:231], v237 offset:57344
    v_exp_f32 v119, v119
    v_exp_f32 v120, v120
    v_exp_f32 v121, v121
    v_smfmac_f32_32x32x32_bf16 v[144:159], v[64:67], v[112:119], v164
    v_exp_f32 v122, v122
    v_exp_f32 v123, v123
    v_exp_f32 v124, v124
    v_exp_f32 v125, v125
    v_exp_f32 v126, v126
    v_exp_f32 v127, v127
    v_exp_f32 v128, v128
    v_exp_f32 v129, v129
    s_waitcnt lgkmcnt(0)
    v_cmp_gt_f32 vcc, 0, v10
    s_cbranch_vccnz A1_SP1
A1_OK1:
    v_add_f32 v10, v10, v10 quad_perm:[1,0,3,2] row_mask:0xf bank_mask:0xf
    v_pk_add_f32 v[220:221], v[220:221], v[222:223]
    v_pk_add_f32 v[224:225], v[224:225], v[226:227]
    v_add_f32 v10, v10, v10 quad_perm:[2,3,0,1] row_mask:0xf bank_mask:0xf
    v_pk_add_f32 v[220:221], v[220:221], v[224:225]
    v_add_f32 v220, v220, v221
    v_add_f32 v10, v10, v10 row_half_mirror row_mask:0xf bank_mask:0xf
    v_rcp_f32 v221, v10
    v_smfmac_f32_32x32x32_bf16 v[144:159], v[68:71], v[120:127], v164
    v_exp_f32 v130, v130
    v_mul_f32 v220, v220, v221
    v_max3_f32 v238, v238, v10, v221
    v_cvt_pk_bf16_f32 v220, v220, v220
    ds_write_b16 v236, v220 offset:58624
    v_exp_f32 v131, v131
    v_mfma_f32_32x32x16_bf16 v[112:127], v[32:35], v[168:171], 0
    v_exp_f32 v132, v132
    v_exp_f32 v133, v133
    v_exp_f32 v134, v134
    v_exp_f32 v135, v135
    v_exp_f32 v136, v136
    s_setprio 2
    v_exp_f32 v137, v137
    s_waitcnt vmcnt(7)
    v_smfmac_f32_16x16x64_bf16 v[204:207], v[228:231], v[172:179], v164 abid:1
    v_smfmac_f32_32x32x32_bf16 v[144:159], v[72:75], v[128:135], v164
    v_exp_f32 v138, v138
    v_exp_f32 v139, v139
    v_exp_f32 v140, v140
    v_exp_f32 v141, v141
    v_exp_f32 v142, v142
    v_exp_f32 v143, v143
    v_exp_f32 v112, v112
    s_waitcnt vmcnt(5)
    v_smfmac_f32_16x16x64_bf16 v[208:211], v[228:231], v[180:187], v164 abid:1
    v_exp_f32 v113, v113
    v_smfmac_f32_32x32x32_bf16 v[144:159], v[76:79], v[136:143], v164
    v_exp_f32 v114, v114
    v_exp_f32 v115, v115
    v_mfma_f32_32x32x16_bf16 v[128:143], v[36:39], v[168:171], 0
    buffer_load_dwordx4 v[172:175], v1, s[20:23], s10 offen offset:0
    v_exp_f32 v116, v116
    v_exp_f32 v117, v117
    v_exp_f32 v118, v118
    v_exp_f32 v119, v119
    v_exp_f32 v120, v120
    s_waitcnt vmcnt(4)
    v_smfmac_f32_16x16x64_bf16 v[212:215], v[228:231], v[188:195], v164 abid:1
    v_exp_f32 v121, v121
    v_smfmac_f32_32x32x32_bf16 v[144:159], v[80:83], v[112:119], v164
    v_exp_f32 v122, v122
    v_exp_f32 v123, v123
    v_exp_f32 v124, v124
    v_exp_f32 v125, v125
    s_setprio 1
    v_exp_f32 v126, v126
    v_exp_f32 v127, v127
    s_cmp_lg_u32 s3, 1
    s_cbranch_scc1 TS3
    s_mov_b64 exec, 0
    s_branch TP3
TR3:
    s_mov_b64 exec, -1
TS3:
    v_exp_f32 v128, v128
    s_waitcnt vmcnt(2)
    v_smfmac_f32_16x16x64_bf16 v[216:219], v[228:231], v[196:203], v164 abid:1
    v_exp_f32 v129, v129
    v_smfmac_f32_32x32x32_bf16 v[144:159], v[84:87], v[120:127], v164
    v_exp_f32 v130, v130
    v_exp_f32 v131, v131
    v_mfma_f32_32x32x16_bf16 v[112:127], v[40:43], v[168:171], 0
    buffer_load_dwordx4 v[176:179], v1, s[20:23], s10 offen offset:1024
    v_exp_f32 v132, v132
    v_exp_f32 v133, v133
    v_exp_f32 v134, v134
    v_exp_f32 v135, v135
    v_exp_f32 v136, v136
    v_exp_f32 v137, v137
    v_smfmac_f32_32x32x32_bf16 v[144:159], v[88:91], v[128:135], v164
    s_setprio 0
    v_exp_f32 v138, v138
    v_exp_f32 v139, v139
    v_exp_f32 v140, v140
    v_exp_f32 v141, v141
    v_exp_f32 v142, v142
    v_exp_f32 v143, v143
    s_setprio 3
    v_exp_f32 v112, v112
    v_exp_f32 v113, v113
    v_smfmac_f32_32x32x32_bf16 v[144:159], v[92:95], v[136:143], v164
    v_exp_f32 v114, v114
    v_exp_f32 v115, v115
    v_mfma_f32_32x32x16_bf16 v[128:143], v[44:47], v[168:171], 0
    v_exp_f32 v116, v116
    ds_read_b128 v[168:171], v1 offset:3072
    v_exp_f32 v117, v117
    v_exp_f32 v118, v118
    v_exp_f32 v119, v119
    v_exp_f32 v120, v120
    buffer_load_dwordx4 v[180:183], v1, s[20:23], s10 offen offset:2048
    v_exp_f32 v121, v121
    v_smfmac_f32_32x32x32_bf16 v[144:159], v[96:99], v[112:119], v164
    v_exp_f32 v122, v122
    v_exp_f32 v123, v123
    v_exp_f32 v124, v124
    v_exp_f32 v125, v125
    v_exp_f32 v126, v126
    v_exp_f32 v127, v127
    v_exp_f32 v128, v128
    v_exp_f32 v129, v129
    v_smfmac_f32_32x32x32_bf16 v[144:159], v[100:103], v[120:127], v164
    v_exp_f32 v130, v130
    v_exp_f32 v131, v131
    s_waitcnt lgkmcnt(0)
    v_mfma_f32_32x32x16_bf16 v[112:127], v[16:19], v[168:171], 0
    v_exp_f32 v132, v132
    v_exp_f32 v133, v133
    v_exp_f32 v134, v134
    v_exp_f32 v135, v135
    v_exp_f32 v136, v136
    s_setprio 2
    buffer_load_dwordx4 v[184:187], v1, s[20:23], s10 offen offset:3072
    s_add_u32 s10, s10, 0x10000
    v_exp_f32 v137, v137
    v_smfmac_f32_32x32x32_bf16 v[144:159], v[104:107], v[128:135], v164
    v_exp_f32 v138, v138
    v_exp_f32 v139, v139
    v_exp_f32 v140, v140
    v_exp_f32 v141, v141
    v_exp_f32 v142, v142
    v_exp_f32 v143, v143
    v_exp_f32 v112, v112
    v_exp_f32 v113, v113
    v_smfmac_f32_32x32x32_bf16 v[144:159], v[108:111], v[136:143], v164
    v_exp_f32 v114, v114
    buffer_load_dwordx4 v[188:191], v1, s[20:23], s11 offen offset:0
    v_exp_f32 v115, v115
    v_mfma_f32_32x32x16_bf16 v[128:143], v[20:23], v[168:171], 0
    v_exp_f32 v116, v116
    v_exp_f32 v117, v117
    v_exp_f32 v118, v118
    v_exp_f32 v119, v119
    v_exp_f32 v120, v120
    v_exp_f32 v121, v121
    v_smfmac_f32_32x32x32_bf16 v[240:255], v[48:51], v[112:119], v164
    v_exp_f32 v122, v122
    v_exp_f32 v123, v123
    ds_write_b128 v4, v[144:147] offset:8192
    v_exp_f32 v124, v124
    ds_write_b128 v4, v[148:151] offset:8224
    v_exp_f32 v125, v125
    s_setprio 1
    ds_write_b32 v5, v152 offset:51200
    v_exp_f32 v126, v126
    v_exp_f32 v127, v127
    v_exp_f32 v128, v128
    buffer_load_dwordx4 v[192:195], v1, s[20:23], s11 offen offset:1024
    v_exp_f32 v129, v129
    v_smfmac_f32_32x32x32_bf16 v[240:255], v[52:55], v[120:127], v164
    v_exp_f32 v130, v130
    v_exp_f32 v131, v131
    v_mfma_f32_32x32x16_bf16 v[112:127], v[24:27], v[168:171], 0
    v_exp_f32 v132, v132
    v_exp_f32 v133, v133
    v_exp_f32 v134, v134
    v_mfma_f32_32x32x16_bf16 v[144:159], v[160:163], v[160:163], 0
    v_exp_f32 v135, v135
    v_exp_f32 v136, v136
    v_exp_f32 v137, v137
    v_smfmac_f32_32x32x32_bf16 v[240:255], v[56:59], v[128:135], v164
    s_setprio 0
    v_exp_f32 v138, v138
    buffer_load_dwordx4 v[196:199], v1, s[20:23], s11 offen offset:2048
    v_exp_f32 v139, v139
    v_exp_f32 v140, v140
    v_exp_f32 v141, v141
    v_exp_f32 v142, v142
    v_exp_f32 v143, v143
    s_setprio 3
    v_exp_f32 v112, v112
    buffer_load_dwordx4 v[200:203], v1, s[20:23], s11 offen offset:3072
    s_add_u32 s11, s11, 0x10000
    v_exp_f32 v113, v113
    v_smfmac_f32_32x32x32_bf16 v[240:255], v[60:63], v[136:143], v164
    v_exp_f32 v114, v114
    v_exp_f32 v115, v115
    v_mfma_f32_32x32x16_bf16 v[128:143], v[28:31], v[168:171], 0
    v_exp_f32 v116, v116
    v_exp_f32 v117, v117
    v_exp_f32 v118, v118
    buffer_store_dwordx4 v[12:15], v1, s[20:23], s35 offen sc1
    ds_read_b32 v10, v239 offset:51200
    ds_read2st64_b32 v[220:221], v6 offset0:0 offset1:10
    ds_read2st64_b32 v[222:223], v6 offset0:20 offset1:30
    ds_read2st64_b32 v[224:225], v6 offset0:40 offset1:50
    ds_read2st64_b32 v[226:227], v6 offset0:60 offset1:70
    ds_read_b128 v[228:231], v237 offset:58624
    v_exp_f32 v119, v119
    v_exp_f32 v120, v120
    v_exp_f32 v121, v121
    v_smfmac_f32_32x32x32_bf16 v[240:255], v[64:67], v[112:119], v164
    v_exp_f32 v122, v122
    v_exp_f32 v123, v123
    v_exp_f32 v124, v124
    v_exp_f32 v125, v125
    v_exp_f32 v126, v126
    v_exp_f32 v127, v127
    v_exp_f32 v128, v128
    v_exp_f32 v129, v129
    s_waitcnt lgkmcnt(0)
    v_cmp_gt_f32 vcc, 0, v10
    s_cbranch_vccnz A1_SP2
A1_OK2:
    v_add_f32 v10, v10, v10 quad_perm:[1,0,3,2] row_mask:0xf bank_mask:0xf
    v_pk_add_f32 v[220:221], v[220:221], v[222:223]
    v_pk_add_f32 v[224:225], v[224:225], v[226:227]
    v_add_f32 v10, v10, v10 quad_perm:[2,3,0,1] row_mask:0xf bank_mask:0xf
    v_pk_add_f32 v[220:221], v[220:221], v[224:225]
    v_add_f32 v220, v220, v221
    v_add_f32 v10, v10, v10 row_half_mirror row_mask:0xf bank_mask:0xf
    v_rcp_f32 v221, v10
    v_smfmac_f32_32x32x32_bf16 v[240:255], v[68:71], v[120:127], v164
    v_exp_f32 v130, v130
    v_mul_f32 v220, v220, v221
    v_max3_f32 v238, v238, v10, v221
    v_cvt_pk_bf16_f32 v220, v220, v220
    ds_write_b16 v236, v220 offset:57344
    v_exp_f32 v131, v131
    v_mfma_f32_32x32x16_bf16 v[112:127], v[32:35], v[168:171], 0
    v_exp_f32 v132, v132
    v_exp_f32 v133, v133
    v_exp_f32 v134, v134
    v_exp_f32 v135, v135
    v_exp_f32 v136, v136
    s_setprio 2
    v_exp_f32 v137, v137
    s_waitcnt vmcnt(7)
    v_smfmac_f32_16x16x64_bf16 v[204:207], v[228:231], v[172:179], v164 abid:1
    v_smfmac_f32_32x32x32_bf16 v[240:255], v[72:75], v[128:135], v164
    v_exp_f32 v138, v138
    v_exp_f32 v139, v139
    v_exp_f32 v140, v140
    v_exp_f32 v141, v141
    v_exp_f32 v142, v142
    v_exp_f32 v143, v143
    v_exp_f32 v112, v112
    s_waitcnt vmcnt(5)
    v_smfmac_f32_16x16x64_bf16 v[208:211], v[228:231], v[180:187], v164 abid:1
    v_exp_f32 v113, v113
    v_smfmac_f32_32x32x32_bf16 v[240:255], v[76:79], v[136:143], v164
    v_exp_f32 v114, v114
    v_exp_f32 v115, v115
    v_mfma_f32_32x32x16_bf16 v[128:143], v[36:39], v[168:171], 0
    buffer_load_dwordx4 v[172:175], v1, s[20:23], s10 offen offset:0
    v_exp_f32 v116, v116
    v_exp_f32 v117, v117
    v_exp_f32 v118, v118
    v_exp_f32 v119, v119
    v_exp_f32 v120, v120
    s_waitcnt vmcnt(4)
    v_smfmac_f32_16x16x64_bf16 v[212:215], v[228:231], v[188:195], v164 abid:1
    v_exp_f32 v121, v121
    v_smfmac_f32_32x32x32_bf16 v[240:255], v[80:83], v[112:119], v164
    v_exp_f32 v122, v122
    v_exp_f32 v123, v123
    v_exp_f32 v124, v124
    v_exp_f32 v125, v125
    s_setprio 1
    v_exp_f32 v126, v126
    v_exp_f32 v127, v127
    s_cmp_lg_u32 s3, 2
    s_cbranch_scc1 TS4
    s_mov_b64 exec, 0
    s_branch TP4
TR4:
    s_mov_b64 exec, -1
TS4:
    v_exp_f32 v128, v128
    s_waitcnt vmcnt(2)
    v_smfmac_f32_16x16x64_bf16 v[216:219], v[228:231], v[196:203], v164 abid:1
    v_exp_f32 v129, v129
    v_smfmac_f32_32x32x32_bf16 v[240:255], v[84:87], v[120:127], v164
    v_exp_f32 v130, v130
    v_exp_f32 v131, v131
    v_mfma_f32_32x32x16_bf16 v[112:127], v[40:43], v[168:171], 0
    buffer_load_dwordx4 v[176:179], v1, s[20:23], s10 offen offset:1024
    v_exp_f32 v132, v132
    v_exp_f32 v133, v133
    v_exp_f32 v134, v134
    v_exp_f32 v135, v135
    v_exp_f32 v136, v136
    v_exp_f32 v137, v137
    v_smfmac_f32_32x32x32_bf16 v[240:255], v[88:91], v[128:135], v164
    s_setprio 0
    v_exp_f32 v138, v138
    v_exp_f32 v139, v139
    v_exp_f32 v140, v140
    v_exp_f32 v141, v141
    v_exp_f32 v142, v142
    v_exp_f32 v143, v143
    s_setprio 3
    v_exp_f32 v112, v112
    v_exp_f32 v113, v113
    v_smfmac_f32_32x32x32_bf16 v[240:255], v[92:95], v[136:143], v164
    v_exp_f32 v114, v114
    v_exp_f32 v115, v115
    v_mfma_f32_32x32x16_bf16 v[128:143], v[44:47], v[168:171], 0
    v_exp_f32 v116, v116
    ds_read_b128 v[168:171], v1 offset:4096
    v_exp_f32 v117, v117
    v_exp_f32 v118, v118
    v_exp_f32 v119, v119
    v_exp_f32 v120, v120
    buffer_load_dwordx4 v[180:183], v1, s[20:23], s10 offen offset:2048
    v_exp_f32 v121, v121
    v_smfmac_f32_32x32x32_bf16 v[240:255], v[96:99], v[112:119], v164
    v_exp_f32 v122, v122
    v_exp_f32 v123, v123
    v_exp_f32 v124, v124
    v_exp_f32 v125, v125
    v_exp_f32 v126, v126
    v_exp_f32 v127, v127
    v_exp_f32 v128, v128
    v_exp_f32 v129, v129
    v_smfmac_f32_32x32x32_bf16 v[240:255], v[100:103], v[120:127], v164
    v_exp_f32 v130, v130
    v_exp_f32 v131, v131
    s_waitcnt lgkmcnt(0)
    v_mfma_f32_32x32x16_bf16 v[112:127], v[16:19], v[168:171], 0
    v_exp_f32 v132, v132
    v_exp_f32 v133, v133
    v_exp_f32 v134, v134
    v_exp_f32 v135, v135
    v_exp_f32 v136, v136
    s_setprio 2
    buffer_load_dwordx4 v[184:187], v1, s[20:23], s10 offen offset:3072
    s_add_u32 s10, s10, 0x10000
    v_exp_f32 v137, v137
    v_smfmac_f32_32x32x32_bf16 v[240:255], v[104:107], v[128:135], v164
    v_exp_f32 v138, v138
    v_exp_f32 v139, v139
    v_exp_f32 v140, v140
    v_exp_f32 v141, v141
    v_exp_f32 v142, v142
    v_exp_f32 v143, v143
    v_exp_f32 v112, v112
    v_exp_f32 v113, v113
    v_smfmac_f32_32x32x32_bf16 v[240:255], v[108:111], v[136:143], v164
    v_exp_f32 v114, v114
    buffer_load_dwordx4 v[188:191], v1, s[20:23], s11 offen offset:0
    v_exp_f32 v115, v115
    v_mfma_f32_32x32x16_bf16 v[128:143], v[20:23], v[168:171], 0
    v_exp_f32 v116, v116
    v_exp_f32 v117, v117
    v_exp_f32 v118, v118
    v_exp_f32 v119, v119
    v_exp_f32 v120, v120
    v_exp_f32 v121, v121
    v_smfmac_f32_32x32x32_bf16 v[144:159], v[48:51], v[112:119], v164
    v_exp_f32 v122, v122
    v_exp_f32 v123, v123
    ds_write_b128 v4, v[240:243] offset:28672
    v_exp_f32 v124, v124
    ds_write_b128 v4, v[244:247] offset:28704
    v_exp_f32 v125, v125
    s_setprio 1
    ds_write_b32 v5, v248 offset:52224
    v_exp_f32 v126, v126
    v_exp_f32 v127, v127
    v_exp_f32 v128, v128
    buffer_load_dwordx4 v[192:195], v1, s[20:23], s11 offen offset:1024
    v_exp_f32 v129, v129
    v_smfmac_f32_32x32x32_bf16 v[144:159], v[52:55], v[120:127], v164
    v_exp_f32 v130, v130
    v_exp_f32 v131, v131
    v_mfma_f32_32x32x16_bf16 v[112:127], v[24:27], v[168:171], 0
    v_exp_f32 v132, v132
    v_exp_f32 v133, v133
    v_exp_f32 v134, v134
    v_mfma_f32_32x32x16_bf16 v[240:255], v[160:163], v[160:163], 0
    v_exp_f32 v135, v135
    v_exp_f32 v136, v136
    v_exp_f32 v137, v137
    v_smfmac_f32_32x32x32_bf16 v[144:159], v[56:59], v[128:135], v164
    s_setprio 0
    v_exp_f32 v138, v138
    buffer_load_dwordx4 v[196:199], v1, s[20:23], s11 offen offset:2048
    v_exp_f32 v139, v139
    v_exp_f32 v140, v140
    v_exp_f32 v141, v141
    v_exp_f32 v142, v142
    v_exp_f32 v143, v143
    s_setprio 3
    v_exp_f32 v112, v112
    buffer_load_dwordx4 v[200:203], v1, s[20:23], s11 offen offset:3072
    s_add_u32 s11, s11, 0x10000
    v_exp_f32 v113, v113
    v_smfmac_f32_32x32x32_bf16 v[144:159], v[60:63], v[136:143], v164
    v_exp_f32 v114, v114
    v_exp_f32 v115, v115
    buffer_load_dwordx2 v[232:233], v9, s[20:23], s15 offen offset:0 sc1
    v_mfma_f32_32x32x16_bf16 v[128:143], v[28:31], v[168:171], 0
    v_exp_f32 v116, v116
    v_exp_f32 v117, v117
    v_exp_f32 v118, v118
    buffer_store_dwordx4 v[12:15], v1, s[20:23], s36 offen sc1
    ds_read_b32 v10, v239 offset:52224
    ds_read2st64_b32 v[220:221], v6 offset0:80 offset1:90
    ds_read2st64_b32 v[222:223], v6 offset0:100 offset1:110
    ds_read2st64_b32 v[224:225], v6 offset0:120 offset1:130
    ds_read2st64_b32 v[226:227], v6 offset0:140 offset1:150
    ds_read_b128 v[228:231], v237 offset:57344
    v_exp_f32 v119, v119
    v_exp_f32 v120, v120
    v_exp_f32 v121, v121
    v_smfmac_f32_32x32x32_bf16 v[144:159], v[64:67], v[112:119], v164
    v_exp_f32 v122, v122
    v_exp_f32 v123, v123
    v_exp_f32 v124, v124
    v_exp_f32 v125, v125
    v_exp_f32 v126, v126
    v_exp_f32 v127, v127
    v_exp_f32 v128, v128
    v_exp_f32 v129, v129
    s_waitcnt lgkmcnt(0)
    v_cmp_gt_f32 vcc, 0, v10
    s_cbranch_vccnz A1_SP3
A1_OK3:
    v_add_f32 v10, v10, v10 quad_perm:[1,0,3,2] row_mask:0xf bank_mask:0xf
    v_pk_add_f32 v[220:221], v[220:221], v[222:223]
    v_pk_add_f32 v[224:225], v[224:225], v[226:227]
    v_add_f32 v10, v10, v10 quad_perm:[2,3,0,1] row_mask:0xf bank_mask:0xf
    v_pk_add_f32 v[220:221], v[220:221], v[224:225]
    v_add_f32 v220, v220, v221
    v_add_f32 v10, v10, v10 row_half_mirror row_mask:0xf bank_mask:0xf
    v_rcp_f32 v221, v10
    v_smfmac_f32_32x32x32_bf16 v[144:159], v[68:71], v[120:127], v164
    v_exp_f32 v130, v130
    v_mul_f32 v220, v220, v221
    v_max3_f32 v238, v238, v10, v221
    v_cvt_pk_bf16_f32 v220, v220, v220
    ds_write_b16 v236, v220 offset:58624
    v_exp_f32 v131, v131
    v_mfma_f32_32x32x16_bf16 v[112:127], v[32:35], v[168:171], 0
    v_exp_f32 v132, v132
    v_exp_f32 v133, v133
    v_exp_f32 v134, v134
    v_exp_f32 v135, v135
    v_exp_f32 v136, v136
    s_setprio 2
    v_exp_f32 v137, v137
    s_waitcnt vmcnt(8)
    v_smfmac_f32_16x16x64_bf16 v[204:207], v[228:231], v[172:179], v164 abid:1
    v_smfmac_f32_32x32x32_bf16 v[144:159], v[72:75], v[128:135], v164
    v_exp_f32 v138, v138
    v_exp_f32 v139, v139
    v_exp_f32 v140, v140
    v_exp_f32 v141, v141
    v_exp_f32 v142, v142
    v_exp_f32 v143, v143
    v_exp_f32 v112, v112
    s_waitcnt vmcnt(6)
    v_smfmac_f32_16x16x64_bf16 v[208:211], v[228:231], v[180:187], v164 abid:1
    v_exp_f32 v113, v113
    v_smfmac_f32_32x32x32_bf16 v[144:159], v[76:79], v[136:143], v164
    v_exp_f32 v114, v114
    v_exp_f32 v115, v115
    v_mfma_f32_32x32x16_bf16 v[128:143], v[36:39], v[168:171], 0
    buffer_load_dwordx4 v[172:175], v1, s[20:23], s10 offen offset:0
    v_exp_f32 v116, v116
    v_exp_f32 v117, v117
    v_exp_f32 v118, v118
    v_exp_f32 v119, v119
    v_exp_f32 v120, v120
    s_waitcnt vmcnt(5)
    v_smfmac_f32_16x16x64_bf16 v[212:215], v[228:231], v[188:195], v164 abid:1
    v_exp_f32 v121, v121
    v_smfmac_f32_32x32x32_bf16 v[144:159], v[80:83], v[112:119], v164
    v_exp_f32 v122, v122
    v_exp_f32 v123, v123
    v_exp_f32 v124, v124
    v_exp_f32 v125, v125
    s_setprio 1
    v_exp_f32 v126, v126
    v_exp_f32 v127, v127
    s_cmp_lg_u32 s3, 3
    s_cbranch_scc1 TS5
    s_mov_b64 exec, 0
    s_branch TP5
TR5:
    s_mov_b64 exec, -1
TS5:
    v_exp_f32 v128, v128
    s_waitcnt vmcnt(3)
    v_smfmac_f32_16x16x64_bf16 v[216:219], v[228:231], v[196:203], v164 abid:1
    v_exp_f32 v129, v129
    v_smfmac_f32_32x32x32_bf16 v[144:159], v[84:87], v[120:127], v164
    v_exp_f32 v130, v130
    v_exp_f32 v131, v131
    v_mfma_f32_32x32x16_bf16 v[112:127], v[40:43], v[168:171], 0
    buffer_load_dwordx4 v[176:179], v1, s[20:23], s10 offen offset:1024
    v_exp_f32 v132, v132
    v_exp_f32 v133, v133
    v_exp_f32 v134, v134
    v_exp_f32 v135, v135
    v_exp_f32 v136, v136
    v_exp_f32 v137, v137
    v_smfmac_f32_32x32x32_bf16 v[144:159], v[88:91], v[128:135], v164
    s_setprio 0
    v_exp_f32 v138, v138
    v_exp_f32 v139, v139
    v_exp_f32 v140, v140
    v_exp_f32 v141, v141
    v_exp_f32 v142, v142
    v_exp_f32 v143, v143
    s_setprio 3
    v_exp_f32 v112, v112
    v_exp_f32 v113, v113
    v_smfmac_f32_32x32x32_bf16 v[144:159], v[92:95], v[136:143], v164
    v_exp_f32 v114, v114
    v_exp_f32 v115, v115
    v_mfma_f32_32x32x16_bf16 v[128:143], v[44:47], v[168:171], 0
    v_exp_f32 v116, v116
    ds_read_b128 v[168:171], v1 offset:5120
    v_exp_f32 v117, v117
    v_exp_f32 v118, v118
    v_exp_f32 v119, v119
    v_exp_f32 v120, v120
    buffer_load_dwordx4 v[180:183], v1, s[20:23], s10 offen offset:2048
    v_exp_f32 v121, v121
    v_smfmac_f32_32x32x32_bf16 v[144:159], v[96:99], v[112:119], v164
    v_exp_f32 v122, v122
    v_exp_f32 v123, v123
    v_exp_f32 v124, v124
    v_exp_f32 v125, v125
    v_exp_f32 v126, v126
    v_exp_f32 v127, v127
    v_exp_f32 v128, v128
    v_exp_f32 v129, v129
    v_smfmac_f32_32x32x32_bf16 v[144:159], v[100:103], v[120:127], v164
    v_exp_f32 v130, v130
    v_exp_f32 v131, v131
    s_waitcnt lgkmcnt(0)
    v_mfma_f32_32x32x16_bf16 v[112:127], v[16:19], v[168:171], 0
    v_exp_f32 v132, v132
    v_exp_f32 v133, v133
    v_exp_f32 v134, v134
    v_exp_f32 v135, v135
    v_exp_f32 v136, v136
    s_setprio 2
    buffer_load_dwordx4 v[184:187], v1, s[20:23], s10 offen offset:3072
    s_add_u32 s10, s10, 0x10000
    v_exp_f32 v137, v137
    v_smfmac_f32_32x32x32_bf16 v[144:159], v[104:107], v[128:135], v164
    v_exp_f32 v138, v138
    v_exp_f32 v139, v139
    v_exp_f32 v140, v140
    v_exp_f32 v141, v141
    v_exp_f32 v142, v142
    v_exp_f32 v143, v143
    v_exp_f32 v112, v112
    v_exp_f32 v113, v113
    v_smfmac_f32_32x32x32_bf16 v[144:159], v[108:111], v[136:143], v164
    v_exp_f32 v114, v114
    buffer_load_dwordx4 v[188:191], v1, s[20:23], s11 offen offset:0
    v_exp_f32 v115, v115
    v_mfma_f32_32x32x16_bf16 v[128:143], v[20:23], v[168:171], 0
    v_exp_f32 v116, v116
    v_exp_f32 v117, v117
    v_exp_f32 v118, v118
    v_exp_f32 v119, v119
    v_exp_f32 v120, v120
    v_exp_f32 v121, v121
    v_smfmac_f32_32x32x32_bf16 v[240:255], v[48:51], v[112:119], v164
    v_exp_f32 v122, v122
    v_exp_f32 v123, v123
    ds_write_b128 v4, v[144:147] offset:8192
    v_exp_f32 v124, v124
    ds_write_b128 v4, v[148:151] offset:8224
    v_exp_f32 v125, v125
    s_setprio 1
    ds_write_b32 v5, v152 offset:53248
    v_exp_f32 v126, v126
    v_exp_f32 v127, v127
    v_exp_f32 v128, v128
    buffer_load_dwordx4 v[192:195], v1, s[20:23], s11 offen offset:1024
    v_exp_f32 v129, v129
    v_smfmac_f32_32x32x32_bf16 v[240:255], v[52:55], v[120:127], v164
    v_exp_f32 v130, v130
    v_exp_f32 v131, v131
    v_mfma_f32_32x32x16_bf16 v[112:127], v[24:27], v[168:171], 0
    v_exp_f32 v132, v132
    v_exp_f32 v133, v133
    v_exp_f32 v134, v134
    v_mfma_f32_32x32x16_bf16 v[144:159], v[160:163], v[160:163], 0
    v_exp_f32 v135, v135
    v_exp_f32 v136, v136
    v_exp_f32 v137, v137
    v_smfmac_f32_32x32x32_bf16 v[240:255], v[56:59], v[128:135], v164
    s_setprio 0
    v_exp_f32 v138, v138
    buffer_load_dwordx4 v[196:199], v1, s[20:23], s11 offen offset:2048
    v_exp_f32 v139, v139
    v_exp_f32 v140, v140
    v_exp_f32 v141, v141
    v_exp_f32 v142, v142
    v_exp_f32 v143, v143
    s_setprio 3
    v_exp_f32 v112, v112
    buffer_load_dwordx4 v[200:203], v1, s[20:23], s11 offen offset:3072
    s_add_u32 s11, s11, 0x10000
    v_exp_f32 v113, v113
    v_smfmac_f32_32x32x32_bf16 v[240:255], v[60:63], v[136:143], v164
    v_exp_f32 v114, v114
    v_exp_f32 v115, v115
    buffer_load_dwordx2 v[234:235], v9, s[20:23], s15 offen offset:2048 sc1
    v_mfma_f32_32x32x16_bf16 v[128:143], v[28:31], v[168:171], 0
    v_exp_f32 v116, v116
    v_exp_f32 v117, v117
    v_exp_f32 v118, v118
    s_mov_b64 exec, 15
    buffer_store_dwordx4 v[12:15], v1, s[20:23], s37 offen sc1
    s_mov_b64 exec, -1
    ds_read_b32 v10, v239 offset:53248
    ds_read2st64_b32 v[220:221], v6 offset0:0 offset1:10
    ds_read2st64_b32 v[222:223], v6 offset0:20 offset1:30
    ds_read2st64_b32 v[224:225], v6 offset0:40 offset1:50
    ds_read2st64_b32 v[226:227], v6 offset0:60 offset1:70
    ds_read_b128 v[228:231], v237 offset:58624
    v_exp_f32 v119, v119
    v_exp_f32 v120, v120
    v_exp_f32 v121, v121
    v_smfmac_f32_32x32x32_bf16 v[240:255], v[64:67], v[112:119], v164
    v_exp_f32 v122, v122
    v_exp_f32 v123, v123
    v_exp_f32 v124, v124
    v_exp_f32 v125, v125
    v_exp_f32 v126, v126
    v_exp_f32 v127, v127
    v_exp_f32 v128, v128
    v_exp_f32 v129, v129
    s_waitcnt lgkmcnt(0)
    v_cmp_gt_f32 vcc, 0, v10
    s_cbranch_vccnz A1_SP4
A1_OK4:
    v_add_f32 v10, v10, v10 quad_perm:[1,0,3,2] row_mask:0xf bank_mask:0xf
    v_pk_add_f32 v[220:221], v[220:221], v[222:223]
    v_pk_add_f32 v[224:225], v[224:225], v[226:227]
    v_add_f32 v10, v10, v10 quad_perm:[2,3,0,1] row_mask:0xf bank_mask:0xf
    v_pk_add_f32 v[220:221], v[220:221], v[224:225]
    v_add_f32 v220, v220, v221
    v_add_f32 v10, v10, v10 row_half_mirror row_mask:0xf bank_mask:0xf
    v_rcp_f32 v221, v10
    v_smfmac_f32_32x32x32_bf16 v[240:255], v[68:71], v[120:127], v164
    v_exp_f32 v130, v130
    v_mul_f32 v220, v220, v221
    v_max3_f32 v238, v238, v10, v221
    v_cvt_pk_bf16_f32 v220, v220, v220
    ds_write_b16 v236, v220 offset:57344
    v_exp_f32 v131, v131
    v_mfma_f32_32x32x16_bf16 v[112:127], v[32:35], v[168:171], 0
    v_exp_f32 v132, v132
    v_exp_f32 v133, v133
    v_exp_f32 v134, v134
    v_exp_f32 v135, v135
    v_exp_f32 v136, v136
    s_setprio 2
    v_exp_f32 v137, v137
    s_waitcnt vmcnt(8)
    v_smfmac_f32_16x16x64_bf16 v[204:207], v[228:231], v[172:179], v164 abid:1
    v_smfmac_f32_32x32x32_bf16 v[240:255], v[72:75], v[128:135], v164
    v_exp_f32 v138, v138
    v_exp_f32 v139, v139
    v_exp_f32 v140, v140
    v_exp_f32 v141, v141
    v_exp_f32 v142, v142
    v_exp_f32 v143, v143
    v_exp_f32 v112, v112
    s_waitcnt vmcnt(6)
    v_smfmac_f32_16x16x64_bf16 v[208:211], v[228:231], v[180:187], v164 abid:1
    v_exp_f32 v113, v113
    v_smfmac_f32_32x32x32_bf16 v[240:255], v[76:79], v[136:143], v164
    v_exp_f32 v114, v114
    v_exp_f32 v115, v115
    v_mfma_f32_32x32x16_bf16 v[128:143], v[36:39], v[168:171], 0
    buffer_load_dwordx4 v[172:175], v1, s[20:23], s10 offen offset:0
    v_exp_f32 v116, v116
    v_exp_f32 v117, v117
    v_exp_f32 v118, v118
    v_exp_f32 v119, v119
    v_exp_f32 v120, v120
    s_waitcnt vmcnt(5)
    v_smfmac_f32_16x16x64_bf16 v[212:215], v[228:231], v[188:195], v164 abid:1
    v_exp_f32 v121, v121
    v_smfmac_f32_32x32x32_bf16 v[240:255], v[80:83], v[112:119], v164
    v_exp_f32 v122, v122
    v_exp_f32 v123, v123
    v_exp_f32 v124, v124
    v_exp_f32 v125, v125
    s_setprio 1
    v_exp_f32 v126, v126
    v_exp_f32 v127, v127
    v_exp_f32 v128, v128
    s_waitcnt vmcnt(3)
    v_smfmac_f32_16x16x64_bf16 v[216:219], v[228:231], v[196:203], v164 abid:1
    v_exp_f32 v129, v129
    v_smfmac_f32_32x32x32_bf16 v[240:255], v[84:87], v[120:127], v164
TP2:
    s_cbranch_execz TR2
    v_exp_f32 v130, v130
    v_exp_f32 v131, v131
    v_mfma_f32_32x32x16_bf16 v[112:127], v[40:43], v[168:171], 0
    buffer_load_dwordx4 v[176:179], v1, s[20:23], s10 offen offset:1024
    v_exp_f32 v132, v132
    v_exp_f32 v133, v133
    v_exp_f32 v134, v134
    v_exp_f32 v135, v135
    v_exp_f32 v136, v136
    v_exp_f32 v137, v137
    v_smfmac_f32_32x32x32_bf16 v[240:255], v[88:91], v[128:135], v164
    s_setprio 0
    v_exp_f32 v138, v138
    v_exp_f32 v139, v139
    v_exp_f32 v140, v140
    v_exp_f32 v141, v141
    v_exp_f32 v142, v142
    v_exp_f32 v143, v143
    s_setprio 3
    v_exp_f32 v112, v112
    v_exp_f32 v113, v113
    v_smfmac_f32_32x32x32_bf16 v[240:255], v[92:95], v[136:143], v164
    v_exp_f32 v114, v114
    v_exp_f32 v115, v115
    v_mfma_f32_32x32x16_bf16 v[128:143], v[44:47], v[168:171], 0
    v_exp_f32 v116, v116
    ds_read_b128 v[168:171], v1 offset:6144
    v_exp_f32 v117, v117
    v_exp_f32 v118, v118
    v_exp_f32 v119, v119
    v_exp_f32 v120, v120
    buffer_load_dwordx4 v[180:183], v1, s[20:23], s10 offen offset:2048
    v_exp_f32 v121, v121
    v_smfmac_f32_32x32x32_bf16 v[240:255], v[96:99], v[112:119], v164
    v_exp_f32 v122, v122
    v_exp_f32 v123, v123
    v_exp_f32 v124, v124
    v_exp_f32 v125, v125
    v_exp_f32 v126, v126
    v_exp_f32 v127, v127
    v_exp_f32 v128, v128
    v_exp_f32 v129, v129
    v_smfmac_f32_32x32x32_bf16 v[240:255], v[100:103], v[120:127], v164
    v_exp_f32 v130, v130
    v_exp_f32 v131, v131
    s_waitcnt lgkmcnt(0)
    v_mfma_f32_32x32x16_bf16 v[112:127], v[16:19], v[168:171], 0
    v_exp_f32 v132, v132
    v_exp_f32 v133, v133
    v_exp_f32 v134, v134
    v_exp_f32 v135, v135
    v_exp_f32 v136, v136
    s_setprio 2
    buffer_load_dwordx4 v[184:187], v1, s[20:23], s10 offen offset:3072
    s_add_u32 s10, s10, 0x10000
    v_exp_f32 v137, v137
    v_smfmac_f32_32x32x32_bf16 v[240:255], v[104:107], v[128:135], v164
    v_exp_f32 v138, v138
    v_exp_f32 v139, v139
    v_exp_f32 v140, v140
    v_exp_f32 v141, v141
    v_exp_f32 v142, v142
    v_exp_f32 v143, v143
    v_exp_f32 v112, v112
    v_exp_f32 v113, v113
    v_smfmac_f32_32x32x32_bf16 v[240:255], v[108:111], v[136:143], v164
    v_exp_f32 v114, v114
    buffer_load_dwordx4 v[188:191], v1, s[20:23], s11 offen offset:0
    v_exp_f32 v115, v115
    v_mfma_f32_32x32x16_bf16 v[128:143], v[20:23], v[168:171], 0
    v_exp_f32 v116, v116
    v_exp_f32 v117, v117
    v_exp_f32 v118, v118
    v_exp_f32 v119, v119
    v_exp_f32 v120, v120
    v_exp_f32 v121, v121
    v_smfmac_f32_32x32x32_bf16 v[144:159], v[48:51], v[112:119], v164
    v_exp_f32 v122, v122
    v_exp_f32 v123, v123
    ds_write_b128 v4, v[240:243] offset:28672
    v_exp_f32 v124, v124
    ds_write_b128 v4, v[244:247] offset:28704
    v_exp_f32 v125, v125
    s_setprio 1
    ds_write_b32 v5, v248 offset:54272
    v_exp_f32 v126, v126
    v_exp_f32 v127, v127
    v_exp_f32 v128, v128
    buffer_load_dwordx4 v[192:195], v1, s[20:23], s11 offen offset:1024
    v_exp_f32 v129, v129
    v_smfmac_f32_32x32x32_bf16 v[144:159], v[52:55], v[120:127], v164
    v_exp_f32 v130, v130
    v_exp_f32 v131, v131
    v_mfma_f32_32x32x16_bf16 v[112:127], v[24:27], v[168:171], 0
    v_exp_f32 v132, v132
    v_exp_f32 v133, v133
    v_exp_f32 v134, v134
    v_mfma_f32_32x32x16_bf16 v[240:255], v[160:163], v[160:163], 0
    v_exp_f32 v135, v135
    v_exp_f32 v136, v136
    v_exp_f32 v137, v137
    v_smfmac_f32_32x32x32_bf16 v[144:159], v[56:59], v[128:135], v164
    s_setprio 0
    v_exp_f32 v138, v138
    buffer_load_dwordx4 v[196:199], v1, s[20:23], s11 offen offset:2048
    v_exp_f32 v139, v139
    v_exp_f32 v140, v140
    v_exp_f32 v141, v141
    v_exp_f32 v142, v142
    v_exp_f32 v143, v143
    s_setprio 3
    v_exp_f32 v112, v112
    buffer_load_dwordx4 v[200:203], v1, s[20:23], s11 offen offset:3072
    s_add_u32 s11, s11, 0x10000
    v_exp_f32 v113, v113
    v_smfmac_f32_32x32x32_bf16 v[144:159], v[60:63], v[136:143], v164
    v_exp_f32 v114, v114
    v_exp_f32 v115, v115
    v_mfma_f32_32x32x16_bf16 v[128:143], v[28:31], v[168:171], 0
    v_exp_f32 v116, v116
    v_exp_f32 v117, v117
    v_exp_f32 v118, v118
    ds_read_b32 v10, v239 offset:54272
    ds_read2st64_b32 v[220:221], v6 offset0:80 offset1:90
    ds_read2st64_b32 v[222:223], v6 offset0:100 offset1:110
    ds_read2st64_b32 v[224:225], v6 offset0:120 offset1:130
    ds_read2st64_b32 v[226:227], v6 offset0:140 offset1:150
    ds_read_b128 v[228:231], v237 offset:57344
    v_exp_f32 v119, v119
    v_exp_f32 v120, v120
    v_exp_f32 v121, v121
    v_smfmac_f32_32x32x32_bf16 v[144:159], v[64:67], v[112:119], v164
    v_exp_f32 v122, v122
    v_exp_f32 v123, v123
    v_exp_f32 v124, v124
    v_exp_f32 v125, v125
    v_exp_f32 v126, v126
    v_exp_f32 v127, v127
    v_exp_f32 v128, v128
    v_exp_f32 v129, v129
    s_waitcnt lgkmcnt(0)
    v_cmp_gt_f32 vcc, 0, v10
    s_cbranch_vccnz A1_SP5
A1_OK5:
    v_add_f32 v10, v10, v10 quad_perm:[1,0,3,2] row_mask:0xf bank_mask:0xf
    v_pk_add_f32 v[220:221], v[220:221], v[222:223]
    v_pk_add_f32 v[224:225], v[224:225], v[226:227]
    v_add_f32 v10, v10, v10 quad_perm:[2,3,0,1] row_mask:0xf bank_mask:0xf
    v_pk_add_f32 v[220:221], v[220:221], v[224:225]
    v_add_f32 v220, v220, v221
    v_add_f32 v10, v10, v10 row_half_mirror row_mask:0xf bank_mask:0xf
    v_rcp_f32 v221, v10
    v_smfmac_f32_32x32x32_bf16 v[144:159], v[68:71], v[120:127], v164
    v_exp_f32 v130, v130
    v_mul_f32 v220, v220, v221
    v_max3_f32 v238, v238, v10, v221
    v_cvt_pk_bf16_f32 v220, v220, v220
    ds_write_b16 v236, v220 offset:58624
    v_exp_f32 v131, v131
    v_mfma_f32_32x32x16_bf16 v[112:127], v[32:35], v[168:171], 0
    v_exp_f32 v132, v132
    v_exp_f32 v133, v133
    v_exp_f32 v134, v134
    v_exp_f32 v135, v135
    v_exp_f32 v136, v136
    s_setprio 2
    v_exp_f32 v137, v137
    s_waitcnt vmcnt(6)
    v_smfmac_f32_16x16x64_bf16 v[204:207], v[228:231], v[172:179], v164 abid:1
    v_smfmac_f32_32x32x32_bf16 v[144:159], v[72:75], v[128:135], v164
    v_exp_f32 v138, v138
    v_exp_f32 v139, v139
    v_exp_f32 v140, v140
    v_exp_f32 v141, v141
    v_exp_f32 v142, v142
    v_exp_f32 v143, v143
    v_exp_f32 v112, v112
    s_waitcnt vmcnt(4)
    v_smfmac_f32_16x16x64_bf16 v[208:211], v[228:231], v[180:187], v164 abid:1
    v_exp_f32 v113, v113
    v_smfmac_f32_32x32x32_bf16 v[144:159], v[76:79], v[136:143], v164
    v_exp_f32 v114, v114
    v_exp_f32 v115, v115
    v_mfma_f32_32x32x16_bf16 v[128:143], v[36:39], v[168:171], 0
    buffer_load_dwordx4 v[172:175], v1, s[20:23], s10 offen offset:0
    v_exp_f32 v116, v116
    v_exp_f32 v117, v117
    v_exp_f32 v118, v118
    v_exp_f32 v119, v119
    v_exp_f32 v120, v120
    s_waitcnt vmcnt(3)
    v_smfmac_f32_16x16x64_bf16 v[212:215], v[228:231], v[188:195], v164 abid:1
    v_exp_f32 v121, v121
    v_smfmac_f32_32x32x32_bf16 v[144:159], v[80:83], v[112:119], v164
    v_exp_f32 v122, v122
    v_exp_f32 v123, v123
    buffer_load_dwordx4 v[176:179], v1, s[20:23], s10 offen offset:1024
    v_exp_f32 v124, v124
    v_exp_f32 v125, v125
    s_setprio 1
    v_exp_f32 v126, v126
    v_exp_f32 v127, v127
    v_exp_f32 v128, v128
    s_waitcnt vmcnt(2)
    v_smfmac_f32_16x16x64_bf16 v[216:219], v[228:231], v[196:203], v164 abid:1
    v_exp_f32 v129, v129
    v_smfmac_f32_32x32x32_bf16 v[144:159], v[84:87], v[120:127], v164
    v_exp_f32 v130, v130
    v_exp_f32 v131, v131
    v_mfma_f32_32x32x16_bf16 v[112:127], v[40:43], v[168:171], 0
    buffer_load_dwordx4 v[180:183], v1, s[20:23], s10 offen offset:2048
    v_exp_f32 v132, v132
    v_exp_f32 v133, v133
    v_exp_f32 v134, v134
    v_exp_f32 v135, v135
    v_exp_f32 v136, v136
    v_exp_f32 v137, v137
    v_smfmac_f32_32x32x32_bf16 v[144:159], v[88:91], v[128:135], v164
    s_setprio 0
    v_exp_f32 v138, v138
    v_exp_f32 v139, v139
    buffer_load_dwordx4 v[184:187], v1, s[20:23], s10 offen offset:3072
    s_add_u32 s10, s10, 0x10000
    v_exp_f32 v140, v140
    v_exp_f32 v141, v141
    v_exp_f32 v142, v142
    v_exp_f32 v143, v143
    s_setprio 3
    v_exp_f32 v112, v112
    v_exp_f32 v113, v113
    v_smfmac_f32_32x32x32_bf16 v[144:159], v[92:95], v[136:143], v164
    v_exp_f32 v114, v114
    buffer_load_dwordx4 v[188:191], v1, s[20:23], s11 offen offset:0
    v_exp_f32 v115, v115
    v_mfma_f32_32x32x16_bf16 v[128:143], v[44:47], v[168:171], 0
    v_exp_f32 v116, v116
    ds_read_b128 v[168:171], v1 offset:7168
    v_exp_f32 v117, v117
    v_exp_f32 v118, v118
    v_exp_f32 v119, v119
    v_exp_f32 v120, v120
    v_exp_f32 v121, v121
    v_smfmac_f32_32x32x32_bf16 v[144:159], v[96:99], v[112:119], v164
    v_exp_f32 v122, v122
    buffer_load_dwordx4 v[192:195], v1, s[20:23], s11 offen offset:1024
    v_exp_f32 v123, v123
    v_exp_f32 v124, v124
    v_exp_f32 v125, v125
    v_exp_f32 v126, v126
    v_exp_f32 v127, v127
    v_exp_f32 v128, v128
    buffer_load_dwordx4 v[196:199], v1, s[20:23], s11 offen offset:2048
    v_exp_f32 v129, v129
    v_smfmac_f32_32x32x32_bf16 v[144:159], v[100:103], v[120:127], v164
    v_exp_f32 v130, v130
    v_exp_f32 v131, v131
    s_waitcnt lgkmcnt(0)
    v_mfma_f32_32x32x16_bf16 v[112:127], v[16:19], v[168:171], 0
    v_exp_f32 v132, v132
    v_exp_f32 v133, v133
    v_exp_f32 v134, v134
    v_exp_f32 v135, v135
    v_exp_f32 v136, v136
    s_setprio 2
    buffer_load_dwordx4 v[200:203], v1, s[20:23], s11 offen offset:3072
    s_add_u32 s11, s11, 0x10000
    v_exp_f32 v137, v137
    v_smfmac_f32_32x32x32_bf16 v[144:159], v[104:107], v[128:135], v164
    v_exp_f32 v138, v138
    v_exp_f32 v139, v139
    v_exp_f32 v140, v140
    v_exp_f32 v141, v141
    v_exp_f32 v142, v142
    s_waitcnt vmcnt(17)
    v_cmp_u_f32 vcc, v232, v234
    s_cbranch_vccnz A1_CKres_R
A1_CKres_K:
    v_exp_f32 v143, v143
    v_exp_f32 v112, v112
    v_exp_f32 v113, v113
    v_smfmac_f32_32x32x32_bf16 v[144:159], v[108:111], v[136:143], v164
    v_exp_f32 v114, v114
    v_exp_f32 v115, v115
    v_mfma_f32_32x32x16_bf16 v[128:143], v[20:23], v[168:171], 0
    v_exp_f32 v116, v116
    buffer_load_dwordx4 v[16:19], v1, s[20:23], s10 offen offset:0
    v_exp_f32 v117, v117
    v_exp_f32 v118, v118
    v_exp_f32 v119, v119
    v_exp_f32 v120, v120
    v_exp_f32 v121, v121
    buffer_load_dwordx4 v[20:23], v1, s[20:23], s10 offen offset:1024
    v_smfmac_f32_32x32x32_bf16 v[240:255], v[48:51], v[112:119], v164
    v_exp_f32 v122, v122
    v_exp_f32 v123, v123
    ds_write_b128 v4, v[144:147] offset:8192
    v_exp_f32 v124, v124
    ds_write_b128 v4, v[148:151] offset:8224
    v_exp_f32 v125, v125
    s_setprio 1
    ds_write_b32 v5, v152 offset:55296
    v_exp_f32 v126, v126
    v_exp_f32 v127, v127
    v_exp_f32 v128, v128
    v_exp_f32 v129, v129
    v_smfmac_f32_32x32x32_bf16 v[240:255], v[52:55], v[120:127], v164
    v_exp_f32 v130, v130
    v_exp_f32 v131, v131
    buffer_load_dwordx4 v[48:51], v1, s[20:23], s10 offen offset:2048
    v_mfma_f32_32x32x16_bf16 v[112:127], v[24:27], v[168:171], 0
    v_exp_f32 v132, v132
    v_exp_f32 v133, v133
    v_exp_f32 v134, v134
    v_exp_f32 v135, v135
    v_exp_f32 v136, v136
    v_exp_f32 v137, v137
    v_smfmac_f32_32x32x32_bf16 v[240:255], v[56:59], v[128:135], v164
    s_setprio 0
    v_exp_f32 v138, v138
    buffer_load_dwordx4 v[52:55], v1, s[20:23], s10 offen offset:3072
    s_add_u32 s10, s10, 0x10000
    v_exp_f32 v139, v139
    v_exp_f32 v140, v140
    v_exp_f32 v141, v141
    v_exp_f32 v142, v142
    v_exp_f32 v143, v143
    s_setprio 3
    v_exp_f32 v112, v112
    v_exp_f32 v113, v113
    v_smfmac_f32_32x32x32_bf16 v[240:255], v[60:63], v[136:143], v164
    v_exp_f32 v114, v114
    v_exp_f32 v115, v115
    buffer_load_dwordx4 v[56:59], v1, s[20:23], s11 offen offset:0
    v_mfma_f32_32x32x16_bf16 v[128:143], v[28:31], v[168:171], 0
    v_exp_f32 v116, v116
    v_exp_f32 v117, v117
    v_exp_f32 v118, v118
    ds_read_b32 v10, v239 offset:55296
    ds_read2st64_b32 v[220:221], v6 offset0:0 offset1:10
    ds_read2st64_b32 v[222:223], v6 offset0:20 offset1:30
    ds_read2st64_b32 v[224:225], v6 offset0:40 offset1:50
    ds_read2st64_b32 v[226:227], v6 offset0:60 offset1:70
    ds_read_b128 v[228:231], v237 offset:58624
    v_exp_f32 v119, v119
    v_exp_f32 v120, v120
    v_exp_f32 v121, v121
    v_smfmac_f32_32x32x32_bf16 v[240:255], v[64:67], v[112:119], v164
    v_exp_f32 v122, v122
    buffer_load_dwordx4 v[60:63], v1, s[20:23], s11 offen offset:1024
    v_exp_f32 v123, v123
    v_exp_f32 v124, v124
    v_exp_f32 v125, v125
    v_exp_f32 v126, v126
    v_exp_f32 v127, v127
    v_exp_f32 v128, v128
    v_exp_f32 v129, v129
    s_waitcnt lgkmcnt(0)
    v_cmp_gt_f32 vcc, 0, v10
    s_cbranch_vccnz A1_SP6
A1_OK6:
    v_add_f32 v10, v10, v10 quad_perm:[1,0,3,2] row_mask:0xf bank_mask:0xf
    v_pk_add_f32 v[220:221], v[220:221], v[222:223]
    v_pk_add_f32 v[224:225], v[224:225], v[226:227]
    v_add_f32 v10, v10, v10 quad_perm:[2,3,0,1] row_mask:0xf bank_mask:0xf
    v_pk_add_f32 v[220:221], v[220:221], v[224:225]
    v_add_f32 v220, v220, v221
    v_add_f32 v10, v10, v10 row_half_mirror row_mask:0xf bank_mask:0xf
    v_rcp_f32 v221, v10
    v_smfmac_f32_32x32x32_bf16 v[240:255], v[68:71], v[120:127], v164
    v_exp_f32 v130, v130
    v_mul_f32 v220, v220, v221
    v_max3_f32 v238, v238, v10, v221
    v_cvt_pk_bf16_f32 v220, v220, v220
    ds_write_b16 v236, v220 offset:57344
    v_exp_f32 v131, v131
    v_mfma_f32_32x32x16_bf16 v[112:127], v[32:35], v[168:171], 0
    v_exp_f32 v132, v132
    v_exp_f32 v133, v133
    buffer_load_dwordx4 v[24:27], v1, s[20:23], s11 offen offset:2048
    v_exp_f32 v134, v134
    v_exp_f32 v135, v135
    v_exp_f32 v136, v136
    s_setprio 2
    v_exp_f32 v137, v137
    s_waitcnt vmcnt(13)
    v_smfmac_f32_16x16x64_bf16 v[204:207], v[228:231], v[172:179], v164 abid:1
    v_smfmac_f32_32x32x32_bf16 v[240:255], v[72:75], v[128:135], v164
    v_exp_f32 v138, v138
    v_exp_f32 v139, v139
    v_exp_f32 v140, v140
    buffer_load_dwordx4 v[28:31], v1, s[20:23], s11 offen offset:3072
    s_add_u32 s11, s11, 0x10000
    v_exp_f32 v141, v141
    v_exp_f32 v142, v142
    v_exp_f32 v143, v143
    v_exp_f32 v112, v112
    s_waitcnt vmcnt(12)
    v_smfmac_f32_16x16x64_bf16 v[208:211], v[228:231], v[180:187], v164 abid:1
    v_exp_f32 v113, v113
    v_smfmac_f32_32x32x32_bf16 v[240:255], v[76:79], v[136:143], v164
    v_exp_f32 v114, v114
    v_exp_f32 v115, v115
    v_mfma_f32_32x32x16_bf16 v[128:143], v[36:39], v[168:171], 0
    buffer_load_dwordx4 v[172:175], v1, s[20:23], s30 offen offset:0
    v_exp_f32 v116, v116
    v_exp_f32 v117, v117
    v_exp_f32 v118, v118
    v_exp_f32 v119, v119
    v_exp_f32 v120, v120
    s_waitcnt vmcnt(11)
    v_smfmac_f32_16x16x64_bf16 v[212:215], v[228:231], v[188:195], v164 abid:1
    v_exp_f32 v121, v121
    v_smfmac_f32_32x32x32_bf16 v[240:255], v[80:83], v[112:119], v164
    v_exp_f32 v122, v122
    v_exp_f32 v123, v123
    buffer_load_dwordx4 v[176:179], v1, s[20:23], s30 offen offset:1024
    v_exp_f32 v124, v124
    v_exp_f32 v125, v125
    s_setprio 1
    v_exp_f32 v126, v126
    v_exp_f32 v127, v127
    v_exp_f32 v128, v128
    s_waitcnt vmcnt(10)
    v_smfmac_f32_16x16x64_bf16 v[216:219], v[228:231], v[196:203], v164 abid:1
    v_exp_f32 v129, v129
    v_smfmac_f32_32x32x32_bf16 v[240:255], v[84:87], v[120:127], v164
    v_exp_f32 v130, v130
    v_exp_f32 v131, v131
    v_mfma_f32_32x32x16_bf16 v[112:127], v[40:43], v[168:171], 0
    buffer_load_dwordx4 v[180:183], v1, s[20:23], s30 offen offset:2048
    v_exp_f32 v132, v132
    v_exp_f32 v133, v133
    v_exp_f32 v134, v134
    v_exp_f32 v135, v135
    v_exp_f32 v136, v136
    v_exp_f32 v137, v137
    v_smfmac_f32_32x32x32_bf16 v[240:255], v[88:91], v[128:135], v164
    s_setprio 0
    v_exp_f32 v138, v138
    v_exp_f32 v139, v139
    buffer_load_dwordx4 v[184:187], v1, s[20:23], s30 offen offset:3072
    v_exp_f32 v140, v140
    v_exp_f32 v141, v141
    v_exp_f32 v142, v142
    v_exp_f32 v143, v143
    s_setprio 3
    v_exp_f32 v112, v112
    v_exp_f32 v113, v113
    v_smfmac_f32_32x32x32_bf16 v[240:255], v[92:95], v[136:143], v164
    v_exp_f32 v114, v114
    buffer_load_dwordx4 v[188:191], v1, s[20:23], s31 offen offset:0
    v_exp_f32 v115, v115
    v_mfma_f32_32x32x16_bf16 v[128:143], v[44:47], v[168:171], 0
    v_exp_f32 v116, v116
    v_exp_f32 v117, v117
    v_exp_f32 v118, v118
    v_exp_f32 v119, v119
    v_exp_f32 v120, v120
    v_exp_f32 v121, v121
    v_smfmac_f32_32x32x32_bf16 v[240:255], v[96:99], v[112:119], v164
    v_exp_f32 v122, v122
    buffer_load_dwordx4 v[192:195], v1, s[20:23], s31 offen offset:1024
    v_exp_f32 v123, v123
    v_exp_f32 v124, v124
    v_exp_f32 v125, v125
    v_exp_f32 v126, v126
    v_exp_f32 v127, v127
    v_exp_f32 v128, v128
    v_exp_f32 v129, v129
    v_smfmac_f32_32x32x32_bf16 v[240:255], v[100:103], v[120:127], v164
    v_exp_f32 v130, v130
    buffer_load_dwordx4 v[196:199], v1, s[20:23], s31 offen offset:2048
    v_exp_f32 v131, v131
    v_exp_f32 v132, v132
    v_exp_f32 v133, v133
    v_exp_f32 v134, v134
    v_exp_f32 v135, v135
    v_exp_f32 v136, v136
    s_setprio 2
    v_exp_f32 v137, v137
    v_smfmac_f32_32x32x32_bf16 v[240:255], v[104:107], v[128:135], v164
    v_exp_f32 v138, v138
    buffer_load_dwordx4 v[200:203], v1, s[20:23], s31 offen offset:3072
    v_exp_f32 v139, v139
    v_exp_f32 v140, v140
    v_exp_f32 v141, v141
    v_exp_f32 v142, v142
    v_exp_f32 v143, v143
    s_nop 1
    v_smfmac_f32_32x32x32_bf16 v[240:255], v[108:111], v[136:143], v164
    s_mov_b32 s29, 0x67800000
    v_mov_b32 v12, 1
    v_mov_b32 v9, v1
    s_mul_i32 s24, s4, 8320
    s_add_u32 s28, s24, 0x1002000
    s_lshl_b32 s13, s3, 10
    s_add_u32 s13, s13, s24
    s_add_u32 s13, s13, 0x1000000
    v_or_b32 v166, s3, v0
    v_and_b32 v166, 47, v166
    v_cmp_ne_u32 vcc, 0, v166
    v_and_b32 v8, 31, v0
    v_lshlrev_b32 v8, 4, v8
    ds_write_b128 v4, v[240:243] offset:28672
    ds_write_b128 v4, v[244:247] offset:28704
    ds_write_b32 v5, v248 offset:56320
    v_lshlrev_b32 v112, 16, v232
    v_and_b32 v113, 0xffff0000, v232
    v_lshlrev_b32 v114, 16, v233
    v_and_b32 v115, 0xffff0000, v233
    v_lshlrev_b32 v116, 16, v234
    v_and_b32 v117, 0xffff0000, v234
    v_lshlrev_b32 v118, 16, v235
    v_and_b32 v119, 0xffff0000, v235
    s_waitcnt lgkmcnt(0)
    s_barrier
    ds_read_b32 v10, v239 offset:56320
    ds_read2st64_b32 v[220:221], v6 offset0:80 offset1:90
    ds_read2st64_b32 v[222:223], v6 offset0:100 offset1:110
    ds_read2st64_b32 v[224:225], v6 offset0:120 offset1:130
    ds_read2st64_b32 v[226:227], v6 offset0:140 offset1:150
    ds_read_b128 v[228:231], v237 offset:57344
    v_cndmask_b32 v166, 0, 1.0, vcc
    v_and_b32 v165, 0x1c0, v8
    v_lshrrev_b32 v167, 5, v0
    v_lshl_add_u32 v165, v167, 2, v165
    s_lshl_b32 s24, s3, 3
    v_add_u32 v165, s24, v165
    v_mov_b32 v167, 0x3727c5ac
    s_waitcnt vmcnt(8)
    s_waitcnt lgkmcnt(1)
    v_add_f32 v10, v10, v10 quad_perm:[1,0,3,2] row_mask:0xf bank_mask:0xf
    v_pk_add_f32 v[220:221], v[220:221], v[222:223]
    v_pk_add_f32 v[224:225], v[224:225], v[226:227]
    s_waitcnt lgkmcnt(0)
    v_smfmac_f32_16x16x64_bf16 v[204:207], v[228:231], v[16:23], v164 abid:1
    v_add_f32 v10, v10, v10 quad_perm:[2,3,0,1] row_mask:0xf bank_mask:0xf
    v_pk_add_f32 v[220:221], v[220:221], v[224:225]
    v_add_f32 v220, v220, v221
    v_smfmac_f32_16x16x64_bf16 v[208:211], v[228:231], v[48:55], v164 abid:1
    v_add_f32 v10, v10, v10 row_half_mirror row_mask:0xf bank_mask:0xf
    v_rcp_f32 v221, v10
    v_smfmac_f32_16x16x64_bf16 v[212:215], v[228:231], v[56:63], v164 abid:1
    v_mul_f32 v220, v220, v221
    v_max3_f32 v238, v238, v10, v221
    v_cvt_pk_bf16_f32 v220, v220, v220
    ds_write_b16 v236, v220 offset:58624
    v_smfmac_f32_16x16x64_bf16 v[216:219], v[228:231], v[24:31], v164 abid:1
    v_cmp_lt_f32 vcc, s29, v238
    s_and_saveexec_b64 s[24:25], vcc
    ds_write_b32 v11, v12 offset:60416
    s_mov_b64 exec, -1
    s_waitcnt lgkmcnt(0)
    s_barrier
    ds_read_b32 v12, v11 offset:60416
    ds_read_b128 v[228:231], v237 offset:58624
    s_waitcnt vmcnt(0)
    s_waitcnt lgkmcnt(0)
    v_cmp_ne_u32 vcc, 0, v12
    v_smfmac_f32_16x16x64_bf16 v[204:207], v[228:231], v[172:179], v164 abid:1
    v_smfmac_f32_16x16x64_bf16 v[208:211], v[228:231], v[180:187], v164 abid:1
    v_smfmac_f32_16x16x64_bf16 v[212:215], v[228:231], v[188:195], v164 abid:1
    v_smfmac_f32_16x16x64_bf16 v[216:219], v[228:231], v[196:203], v164 abid:1
    s_cbranch_vccnz A1_SLOW
A1_FIN:
    s_nop 5
    v_permlane32_swap_b32 v204, v212
    v_permlane32_swap_b32 v205, v213
    v_permlane32_swap_b32 v206, v214
    v_permlane32_swap_b32 v207, v215
    v_permlane32_swap_b32 v208, v216
    v_permlane32_swap_b32 v209, v217
    v_permlane32_swap_b32 v210, v218
    v_permlane32_swap_b32 v211, v219
    v_pk_add_f32 v[112:113], v[112:113], v[204:205]
    v_pk_add_f32 v[114:115], v[114:115], v[206:207]
    v_pk_add_f32 v[116:117], v[116:117], v[208:209]
    v_pk_add_f32 v[118:119], v[118:119], v[210:211]
    v_pk_add_f32 v[112:113], v[112:113], v[212:213]
    v_pk_add_f32 v[114:115], v[114:115], v[214:215]
    v_pk_add_f32 v[116:117], v[116:117], v[216:217]
    v_pk_add_f32 v[118:119], v[118:119], v[218:219]
    v_pk_mul_f32 v[132:133], v[112:113], v[166:167] op_sel_hi:[1,0]
    v_pk_mul_f32 v[134:135], v[114:115], v[166:167] op_sel_hi:[1,0]
    v_pk_mul_f32 v[128:129], v[116:117], v[116:117]
    v_pk_mul_f32 v[130:131], v[118:119], v[118:119]
    v_pk_fma_f32 v[128:129], v[132:133], v[112:113], v[128:129]
    v_pk_fma_f32 v[130:131], v[134:135], v[114:115], v[130:131]
    s_nop 0
    v_add_f32 v132, v128, v128 row_ror:8 row_mask:0xf bank_mask:0x3
    v_add_f32 v132, v129, v129 row_ror:8 row_mask:0xf bank_mask:0xc
    v_add_f32 v133, v130, v130 row_ror:8 row_mask:0xf bank_mask:0x3
    v_add_f32 v133, v131, v131 row_ror:8 row_mask:0xf bank_mask:0xc
    v_add_f32 v128, v132, v132 row_half_mirror row_mask:0xf bank_mask:0x5
    s_nop 0
    v_add_f32 v128, v133, v133 row_half_mirror row_mask:0xf bank_mask:0xa
    s_nop 1
    v_add_f32 v128, v128, v128 quad_perm:[1,0,3,2] row_mask:0xf bank_mask:0xf
    s_nop 1
    v_add_f32 v128, v128, v128 quad_perm:[2,3,0,1] row_mask:0xf bank_mask:0xf
    ds_write_b32 v165, v128 offset:59904
    s_waitcnt lgkmcnt(0)
    s_barrier
    ds_read_b128 v[128:131], v8 offset:59904
    s_waitcnt lgkmcnt(0)
    v_pk_add_f32 v[128:129], v[128:129], v[130:131]
    v_add_f32 v128, v128, v129
    s_nop 1
    v_add_f32 v128, v128, v128 quad_perm:[1,0,3,2] row_mask:0xf bank_mask:0xf
    s_nop 1
    v_add_f32 v128, v128, v128 quad_perm:[2,3,0,1] row_mask:0xf bank_mask:0xf
    v_fmamk_f32 v128, v128, 0x3b000000, v167
    v_rsq_f32 v129, v128
    s_nop 1
    v_mul_f32 v112, v129, v112 row_newbcast:0 row_mask:0xf bank_mask:0xf
    v_mul_f32 v113, v129, v113 row_newbcast:8 row_mask:0xf bank_mask:0xf
    v_mul_f32 v114, v129, v114 row_newbcast:4 row_mask:0xf bank_mask:0xf
    v_mul_f32 v115, v129, v115 row_newbcast:12 row_mask:0xf bank_mask:0xf
    v_mul_f32 v116, v129, v116 row_newbcast:0 row_mask:0xf bank_mask:0xf
    v_mul_f32 v117, v129, v117 row_newbcast:8 row_mask:0xf bank_mask:0xf
    v_mul_f32 v118, v129, v118 row_newbcast:4 row_mask:0xf bank_mask:0xf
    v_mul_f32 v119, v129, v119 row_newbcast:12 row_mask:0xf bank_mask:0xf
    v_cvt_pk_bf16_f32 v120, v112, v113
    v_cvt_pk_bf16_f32 v121, v114, v115
    v_cvt_pk_bf16_f32 v122, v116, v117
    v_cvt_pk_bf16_f32 v123, v118, v119
    s_nop 0
    v_permlane16_swap_b32 v120, v122
    v_permlane16_swap_b32 v121, v123
    buffer_store_dwordx4 v[120:123], v9, s[20:23], s13 offen sc1
    s_mov_b32 s40, 0x1000000
    s_cmp_lt_u32 s3, 4
    s_cbranch_scc1 CW
    s_cmp_lg_u32 s3, 4
    s_cbranch_scc1 H2
    v_mul_f32 v128, v128, v129
    v_and_b32 v130, 16, v0
    v_and_b32 v131, 4, v0
    v_lshl_add_u32 v130, v131, 1, v130
    v_bfe_u32 v131, v0, 3, 1
    v_lshl_add_u32 v130, v131, 2, v130
    s_mov_b64 exec, 0x11111111
    buffer_store_dword v128, v130, s[20:23], s28 offen sc1
    s_mov_b64 exec, -1
    s_branch H2
A1_SP0:
    ds_read_b32 v10, v239 offset:49152
    ds_read2st64_b32 v[220:221], v6 offset0:0 offset1:10
    ds_read2st64_b32 v[222:223], v6 offset0:20 offset1:30
    ds_read2st64_b32 v[224:225], v6 offset0:40 offset1:50
    ds_read2st64_b32 v[226:227], v6 offset0:60 offset1:70
    ds_read_b128 v[168:171], v1 offset:2048
    s_waitcnt lgkmcnt(0)
    v_cmp_gt_f32 vcc, 0, v10
    s_cbranch_vccnz A1_SP0
    s_branch A1_OK0
A1_SP1:
    ds_read_b32 v10, v239 offset:50176
    ds_read2st64_b32 v[220:221], v6 offset0:80 offset1:90
    ds_read2st64_b32 v[222:223], v6 offset0:100 offset1:110
    ds_read2st64_b32 v[224:225], v6 offset0:120 offset1:130
    ds_read2st64_b32 v[226:227], v6 offset0:140 offset1:150
    ds_read_b128 v[228:231], v237 offset:57344
    s_waitcnt lgkmcnt(0)
    v_cmp_gt_f32 vcc, 0, v10
    s_cbranch_vccnz A1_SP1
    s_branch A1_OK1
A1_SP2:
    ds_read_b32 v10, v239 offset:51200
    ds_read2st64_b32 v[220:221], v6 offset0:0 offset1:10
    ds_read2st64_b32 v[222:223], v6 offset0:20 offset1:30
    ds_read2st64_b32 v[224:225], v6 offset0:40 offset1:50
    ds_read2st64_b32 v[226:227], v6 offset0:60 offset1:70
    ds_read_b128 v[228:231], v237 offset:58624
    s_waitcnt lgkmcnt(0)
    v_cmp_gt_f32 vcc, 0, v10
    s_cbranch_vccnz A1_SP2
    s_branch A1_OK2
A1_SP3:
    ds_read_b32 v10, v239 offset:52224
    ds_read2st64_b32 v[220:221], v6 offset0:80 offset1:90
    ds_read2st64_b32 v[222:223], v6 offset0:100 offset1:110
    ds_read2st64_b32 v[224:225], v6 offset0:120 offset1:130
    ds_read2st64_b32 v[226:227], v6 offset0:140 offset1:150
    ds_read_b128 v[228:231], v237 offset:57344
    s_waitcnt lgkmcnt(0)
    v_cmp_gt_f32 vcc, 0, v10
    s_cbranch_vccnz A1_SP3
    s_branch A1_OK3
A1_SP4:
    ds_read_b32 v10, v239 offset:53248
    ds_read2st64_b32 v[220:221], v6 offset0:0 offset1:10
    ds_read2st64_b32 v[222:223], v6 offset0:20 offset1:30
    ds_read2st64_b32 v[224:225], v6 offset0:40 offset1:50
    ds_read2st64_b32 v[226:227], v6 offset0:60 offset1:70
    ds_read_b128 v[228:231], v237 offset:58624
    s_waitcnt lgkmcnt(0)
    v_cmp_gt_f32 vcc, 0, v10
    s_cbranch_vccnz A1_SP4
    s_branch A1_OK4
A1_SP5:
    ds_read_b32 v10, v239 offset:54272
    ds_read2st64_b32 v[220:221], v6 offset0:80 offset1:90
    ds_read2st64_b32 v[222:223], v6 offset0:100 offset1:110
    ds_read2st64_b32 v[224:225], v6 offset0:120 offset1:130
    ds_read2st64_b32 v[226:227], v6 offset0:140 offset1:150
    ds_read_b128 v[228:231], v237 offset:57344
    s_waitcnt lgkmcnt(0)
    v_cmp_gt_f32 vcc, 0, v10
    s_cbranch_vccnz A1_SP5
    s_branch A1_OK5
A1_SP6:
    ds_read_b32 v10, v239 offset:55296
    ds_read2st64_b32 v[220:221], v6 offset0:0 offset1:10
    ds_read2st64_b32 v[222:223], v6 offset0:20 offset1:30
    ds_read2st64_b32 v[224:225], v6 offset0:40 offset1:50
    ds_read2st64_b32 v[226:227], v6 offset0:60 offset1:70
    ds_read_b128 v[228:231], v237 offset:58624
    s_waitcnt lgkmcnt(0)
    v_cmp_gt_f32 vcc, 0, v10
    s_cbranch_vccnz A1_SP6
    s_branch A1_OK6
A1_CKq0_R:
    s_cmp_eq_u32 s41, 0
    s_cbranch_scc1 A1_CKq0_K
    s_sub_u32 s41, s41, 1
    buffer_load_dwordx4 v[168:171], v1, s[20:23], s5 offen sc1
    buffer_load_dwordx4 v[16:19], v1, s[20:23], s6 offen offset:0 sc1
    buffer_load_dwordx4 v[228:231], v1, s[20:23], s5 offen offset:1024 sc1
    s_mov_b64 exec, s[32:33]
    buffer_load_dwordx4 v[48:51], v1, s[20:23], s8 offen offset:0 sc1
    buffer_load_dwordx4 v[52:55], v1, s[20:23], s8 offen offset:256 sc1
    s_mov_b64 exec, -1
    buffer_load_dwordx4 v[20:23], v1, s[20:23], s6 offen offset:1024 sc1
    s_waitcnt vmcnt(0)
    v_cmp_u_f32 vcc, v168, v170
    s_cbranch_vccnz A1_CKq0_R
    v_cmp_u_f32 vcc, v16, v18
    s_cbranch_vccnz A1_CKq0_R
    s_branch A1_CKq0_K
A1_CKq1_R:
    s_cmp_eq_u32 s41, 0
    s_cbranch_scc1 A1_CKq1_K
    s_sub_u32 s41, s41, 1
    buffer_load_dwordx4 v[228:231], v1, s[20:23], s5 offen offset:1024 sc1
    s_mov_b64 exec, s[32:33]
    buffer_load_dwordx4 v[48:51], v1, s[20:23], s8 offen offset:0 sc1
    buffer_load_dwordx4 v[52:55], v1, s[20:23], s8 offen offset:256 sc1
    s_mov_b64 exec, -1
    buffer_load_dwordx4 v[20:23], v1, s[20:23], s6 offen offset:1024 sc1
    s_mov_b64 exec, s[32:33]
    buffer_load_dwordx4 v[56:59], v1, s[20:23], s8 offen offset:1024 sc1
    buffer_load_dwordx4 v[60:63], v1, s[20:23], s8 offen offset:1280 sc1
    s_mov_b64 exec, -1
    s_waitcnt vmcnt(0)
    v_cmp_u_f32 vcc, v228, v230
    s_cbranch_vccnz A1_CKq1_R
    s_branch A1_CKq1_K
A1_CKv0_R:
    s_cmp_eq_u32 s41, 0
    s_cbranch_scc1 A1_CKv0_K
    s_sub_u32 s41, s41, 1
    s_mov_b64 exec, s[32:33]
    buffer_load_dwordx4 v[48:51], v1, s[20:23], s8 offen offset:0 sc1
    buffer_load_dwordx4 v[52:55], v1, s[20:23], s8 offen offset:256 sc1
    s_mov_b64 exec, -1
    buffer_load_dwordx4 v[20:23], v1, s[20:23], s6 offen offset:1024 sc1
    s_mov_b64 exec, s[32:33]
    buffer_load_dwordx4 v[56:59], v1, s[20:23], s8 offen offset:1024 sc1
    buffer_load_dwordx4 v[60:63], v1, s[20:23], s8 offen offset:1280 sc1
    s_mov_b64 exec, -1
    buffer_load_dwordx4 v[24:27], v1, s[20:23], s6 offen offset:2048 sc1
    s_waitcnt vmcnt(0)
    v_cmp_u_f32 vcc, v48, v50
    s_cbranch_vccnz A1_CKv0_R
    v_cmp_u_f32 vcc, v52, v54
    s_cbranch_vccnz A1_CKv0_R
    s_branch A1_CKv0_K
A1_CKk1_R:
    s_cmp_eq_u32 s41, 0
    s_cbranch_scc1 A1_CKk1_K
    s_sub_u32 s41, s41, 1
    buffer_load_dwordx4 v[20:23], v1, s[20:23], s6 offen offset:1024 sc1
    s_mov_b64 exec, s[32:33]
    buffer_load_dwordx4 v[56:59], v1, s[20:23], s8 offen offset:1024 sc1
    buffer_load_dwordx4 v[60:63], v1, s[20:23], s8 offen offset:1280 sc1
    s_mov_b64 exec, -1
    buffer_load_dwordx4 v[24:27], v1, s[20:23], s6 offen offset:2048 sc1
    s_mov_b64 exec, s[32:33]
    buffer_load_dwordx4 v[64:67], v1, s[20:23], s8 offen offset:2048 sc1
    buffer_load_dwordx4 v[68:71], v1, s[20:23], s8 offen offset:2304 sc1
    s_mov_b64 exec, -1
    s_waitcnt vmcnt(0)
    v_cmp_u_f32 vcc, v20, v22
    s_cbranch_vccnz A1_CKk1_R
    s_branch A1_CKk1_K
A1_CKv1_R:
    s_cmp_eq_u32 s41, 0
    s_cbranch_scc1 A1_CKv1_K
    s_sub_u32 s41, s41, 1
    s_mov_b64 exec, s[32:33]
    buffer_load_dwordx4 v[56:59], v1, s[20:23], s8 offen offset:1024 sc1
    buffer_load_dwordx4 v[60:63], v1, s[20:23], s8 offen offset:1280 sc1
    s_mov_b64 exec, -1
    buffer_load_dwordx4 v[24:27], v1, s[20:23], s6 offen offset:2048 sc1
    s_mov_b64 exec, s[32:33]
    buffer_load_dwordx4 v[64:67], v1, s[20:23], s8 offen offset:2048 sc1
    buffer_load_dwordx4 v[68:71], v1, s[20:23], s8 offen offset:2304 sc1
    s_mov_b64 exec, -1
    buffer_load_dwordx4 v[28:31], v1, s[20:23], s6 offen offset:3072 sc1
    s_mov_b64 exec, s[32:33]
    buffer_load_dwordx4 v[72:75], v1, s[20:23], s8 offen offset:3072 sc1
    buffer_load_dwordx4 v[76:79], v1, s[20:23], s8 offen offset:3328 sc1
    s_mov_b64 exec, -1
    s_waitcnt vmcnt(0)
    v_cmp_u_f32 vcc, v56, v58
    s_cbranch_vccnz A1_CKv1_R
    v_cmp_u_f32 vcc, v60, v62
    s_cbranch_vccnz A1_CKv1_R
    s_branch A1_CKv1_K
A1_CKk2_R:
    s_cmp_eq_u32 s41, 0
    s_cbranch_scc1 A1_CKk2_K
    s_sub_u32 s41, s41, 1
    buffer_load_dwordx4 v[24:27], v1, s[20:23], s6 offen offset:2048 sc1
    s_mov_b64 exec, s[32:33]
    buffer_load_dwordx4 v[64:67], v1, s[20:23], s8 offen offset:2048 sc1
    buffer_load_dwordx4 v[68:71], v1, s[20:23], s8 offen offset:2304 sc1
    s_mov_b64 exec, -1
    buffer_load_dwordx4 v[28:31], v1, s[20:23], s6 offen offset:3072 sc1
    s_mov_b64 exec, s[32:33]
    buffer_load_dwordx4 v[72:75], v1, s[20:23], s8 offen offset:3072 sc1
    buffer_load_dwordx4 v[76:79], v1, s[20:23], s8 offen offset:3328 sc1
    s_mov_b64 exec, -1
    buffer_load_dwordx4 v[32:35], v1, s[20:23], s7 offen offset:0 sc1
    s_waitcnt vmcnt(0)
    v_cmp_u_f32 vcc, v24, v26
    s_cbranch_vccnz A1_CKk2_R
    s_branch A1_CKk2_K
A1_CKv2_R:
    s_cmp_eq_u32 s41, 0
    s_cbranch_scc1 A1_CKv2_K
    s_sub_u32 s41, s41, 1
    s_mov_b64 exec, s[32:33]
    buffer_load_dwordx4 v[64:67], v1, s[20:23], s8 offen offset:2048 sc1
    buffer_load_dwordx4 v[68:71], v1, s[20:23], s8 offen offset:2304 sc1
    s_mov_b64 exec, -1
    buffer_load_dwordx4 v[28:31], v1, s[20:23], s6 offen offset:3072 sc1
    s_mov_b64 exec, s[32:33]
    buffer_load_dwordx4 v[72:75], v1, s[20:23], s8 offen offset:3072 sc1
    buffer_load_dwordx4 v[76:79], v1, s[20:23], s8 offen offset:3328 sc1
    s_mov_b64 exec, -1
    buffer_load_dwordx4 v[32:35], v1, s[20:23], s7 offen offset:0 sc1
    s_mov_b64 exec, s[32:33]
    buffer_load_dwordx4 v[80:83], v1, s[20:23], s9 offen offset:0 sc1
    buffer_load_dwordx4 v[84:87], v1, s[20:23], s9 offen offset:256 sc1
    s_mov_b64 exec, -1
    buffer_load_dwordx4 v[36:39], v1, s[20:23], s7 offen offset:1024 sc1
    s_waitcnt vmcnt(0)
    v_cmp_u_f32 vcc, v64, v66
    s_cbranch_vccnz A1_CKv2_R
    v_cmp_u_f32 vcc, v68, v70
    s_cbranch_vccnz A1_CKv2_R
    s_branch A1_CKv2_K
A1_CKk3_R:
    s_cmp_eq_u32 s41, 0
    s_cbranch_scc1 A1_CKk3_K
    s_sub_u32 s41, s41, 1
    buffer_load_dwordx4 v[28:31], v1, s[20:23], s6 offen offset:3072 sc1
    s_mov_b64 exec, s[32:33]
    buffer_load_dwordx4 v[72:75], v1, s[20:23], s8 offen offset:3072 sc1
    buffer_load_dwordx4 v[76:79], v1, s[20:23], s8 offen offset:3328 sc1
    s_mov_b64 exec, -1
    buffer_load_dwordx4 v[32:35], v1, s[20:23], s7 offen offset:0 sc1
    s_mov_b64 exec, s[32:33]
    buffer_load_dwordx4 v[80:83], v1, s[20:23], s9 offen offset:0 sc1
    buffer_load_dwordx4 v[84:87], v1, s[20:23], s9 offen offset:256 sc1
    s_mov_b64 exec, -1
    buffer_load_dwordx4 v[36:39], v1, s[20:23], s7 offen offset:1024 sc1
    s_mov_b64 exec, s[32:33]
    buffer_load_dwordx4 v[88:91], v1, s[20:23], s9 offen offset:1024 sc1
    buffer_load_dwordx4 v[92:95], v1, s[20:23], s9 offen offset:1280 sc1
    s_mov_b64 exec, -1
    s_waitcnt vmcnt(0)
    v_cmp_u_f32 vcc, v28, v30
    s_cbranch_vccnz A1_CKk3_R
    s_branch A1_CKk3_K
A1_CKv3_R:
    s_cmp_eq_u32 s41, 0
    s_cbranch_scc1 A1_CKv3_K
    s_sub_u32 s41, s41, 1
    s_mov_b64 exec, s[32:33]
    buffer_load_dwordx4 v[72:75], v1, s[20:23], s8 offen offset:3072 sc1
    buffer_load_dwordx4 v[76:79], v1, s[20:23], s8 offen offset:3328 sc1
    s_mov_b64 exec, -1
    buffer_load_dwordx4 v[32:35], v1, s[20:23], s7 offen offset:0 sc1
    s_mov_b64 exec, s[32:33]
    buffer_load_dwordx4 v[80:83], v1, s[20:23], s9 offen offset:0 sc1
    buffer_load_dwordx4 v[84:87], v1, s[20:23], s9 offen offset:256 sc1
    s_mov_b64 exec, -1
    buffer_load_dwordx4 v[36:39], v1, s[20:23], s7 offen offset:1024 sc1
    s_mov_b64 exec, s[32:33]
    buffer_load_dwordx4 v[88:91], v1, s[20:23], s9 offen offset:1024 sc1
    buffer_load_dwordx4 v[92:95], v1, s[20:23], s9 offen offset:1280 sc1
    s_mov_b64 exec, -1
    buffer_load_dwordx4 v[40:43], v1, s[20:23], s7 offen offset:2048 sc1
    s_mov_b64 exec, s[32:33]
    buffer_load_dwordx4 v[96:99], v1, s[20:23], s9 offen offset:2048 sc1
    buffer_load_dwordx4 v[100:103], v1, s[20:23], s9 offen offset:2304 sc1
    s_mov_b64 exec, -1
    s_waitcnt vmcnt(0)
    v_cmp_u_f32 vcc, v72, v74
    s_cbranch_vccnz A1_CKv3_R
    v_cmp_u_f32 vcc, v76, v78
    s_cbranch_vccnz A1_CKv3_R
    s_branch A1_CKv3_K
A1_CKk4_R:
    s_cmp_eq_u32 s41, 0
    s_cbranch_scc1 A1_CKk4_K
    s_sub_u32 s41, s41, 1
    buffer_load_dwordx4 v[32:35], v1, s[20:23], s7 offen offset:0 sc1
    s_mov_b64 exec, s[32:33]
    buffer_load_dwordx4 v[80:83], v1, s[20:23], s9 offen offset:0 sc1
    buffer_load_dwordx4 v[84:87], v1, s[20:23], s9 offen offset:256 sc1
    s_mov_b64 exec, -1
    buffer_load_dwordx4 v[36:39], v1, s[20:23], s7 offen offset:1024 sc1
    s_mov_b64 exec, s[32:33]
    buffer_load_dwordx4 v[88:91], v1, s[20:23], s9 offen offset:1024 sc1
    buffer_load_dwordx4 v[92:95], v1, s[20:23], s9 offen offset:1280 sc1
    s_mov_b64 exec, -1
    buffer_load_dwordx4 v[40:43], v1, s[20:23], s7 offen offset:2048 sc1
    s_mov_b64 exec, s[32:33]
    buffer_load_dwordx4 v[96:99], v1, s[20:23], s9 offen offset:2048 sc1
    buffer_load_dwordx4 v[100:103], v1, s[20:23], s9 offen offset:2304 sc1
    s_mov_b64 exec, -1
    buffer_load_dwordx4 v[44:47], v1, s[20:23], s7 offen offset:3072 sc1
    s_waitcnt vmcnt(0)
    v_cmp_u_f32 vcc, v32, v34
    s_cbranch_vccnz A1_CKk4_R
    s_branch A1_CKk4_K
A1_CKk5_R:
    s_cmp_eq_u32 s41, 0
    s_cbranch_scc1 A1_CKk5_K
    s_sub_u32 s41, s41, 1
    s_mov_b64 exec, s[32:33]
    buffer_load_dwordx4 v[80:83], v1, s[20:23], s9 offen offset:0 sc1
    buffer_load_dwordx4 v[84:87], v1, s[20:23], s9 offen offset:256 sc1
    s_mov_b64 exec, -1
    buffer_load_dwordx4 v[36:39], v1, s[20:23], s7 offen offset:1024 sc1
    s_mov_b64 exec, s[32:33]
    buffer_load_dwordx4 v[88:91], v1, s[20:23], s9 offen offset:1024 sc1
    buffer_load_dwordx4 v[92:95], v1, s[20:23], s9 offen offset:1280 sc1
    s_mov_b64 exec, -1
    buffer_load_dwordx4 v[40:43], v1, s[20:23], s7 offen offset:2048 sc1
    s_mov_b64 exec, s[32:33]
    buffer_load_dwordx4 v[96:99], v1, s[20:23], s9 offen offset:2048 sc1
    buffer_load_dwordx4 v[100:103], v1, s[20:23], s9 offen offset:2304 sc1
    s_mov_b64 exec, -1
    buffer_load_dwordx4 v[44:47], v1, s[20:23], s7 offen offset:3072 sc1
    s_mov_b64 exec, s[32:33]
    buffer_load_dwordx4 v[104:107], v1, s[20:23], s9 offen offset:3072 sc1
    buffer_load_dwordx4 v[108:111], v1, s[20:23], s9 offen offset:3328 sc1
    s_mov_b64 exec, -1
    buffer_load_dwordx4 v[220:223], v1, s[20:23], s14 offen sc1
    s_waitcnt vmcnt(0)
    v_cmp_u_f32 vcc, v36, v38
    s_cbranch_vccnz A1_CKk5_R
    s_branch A1_CKk5_K
A1_CKv4_R:
    s_cmp_eq_u32 s41, 0
    s_cbranch_scc1 A1_CKv4_K
    s_sub_u32 s41, s41, 1
    s_mov_b64 exec, s[32:33]
    buffer_load_dwordx4 v[80:83], v1, s[20:23], s9 offen offset:0 sc1
    buffer_load_dwordx4 v[84:87], v1, s[20:23], s9 offen offset:256 sc1
    s_mov_b64 exec, -1
    s_mov_b64 exec, s[32:33]
    buffer_load_dwordx4 v[88:91], v1, s[20:23], s9 offen offset:1024 sc1
    buffer_load_dwordx4 v[92:95], v1, s[20:23], s9 offen offset:1280 sc1
    s_mov_b64 exec, -1
    buffer_load_dwordx4 v[40:43], v1, s[20:23], s7 offen offset:2048 sc1
    s_mov_b64 exec, s[32:33]
    buffer_load_dwordx4 v[96:99], v1, s[20:23], s9 offen offset:2048 sc1
    buffer_load_dwordx4 v[100:103], v1, s[20:23], s9 offen offset:2304 sc1
    s_mov_b64 exec, -1
    buffer_load_dwordx4 v[44:47], v1, s[20:23], s7 offen offset:3072 sc1
    s_mov_b64 exec, s[32:33]
    buffer_load_dwordx4 v[104:107], v1, s[20:23], s9 offen offset:3072 sc1
    buffer_load_dwordx4 v[108:111], v1, s[20:23], s9 offen offset:3328 sc1
    s_mov_b64 exec, -1
    buffer_load_dwordx4 v[220:223], v1, s[20:23], s14 offen sc1
    s_waitcnt vmcnt(0)
    v_cmp_u_f32 vcc, v80, v82
    s_cbranch_vccnz A1_CKv4_R
    v_cmp_u_f32 vcc, v84, v86
    s_cbranch_vccnz A1_CKv4_R
    s_branch A1_CKv4_K
A1_CKk6_R:
    s_cmp_eq_u32 s41, 0
    s_cbranch_scc1 A1_CKk6_K
    s_sub_u32 s41, s41, 1
    s_mov_b64 exec, s[32:33]
    buffer_load_dwordx4 v[88:91], v1, s[20:23], s9 offen offset:1024 sc1
    buffer_load_dwordx4 v[92:95], v1, s[20:23], s9 offen offset:1280 sc1
    s_mov_b64 exec, -1
    buffer_load_dwordx4 v[40:43], v1, s[20:23], s7 offen offset:2048 sc1
    s_mov_b64 exec, s[32:33]
    buffer_load_dwordx4 v[96:99], v1, s[20:23], s9 offen offset:2048 sc1
    buffer_load_dwordx4 v[100:103], v1, s[20:23], s9 offen offset:2304 sc1
    s_mov_b64 exec, -1
    buffer_load_dwordx4 v[44:47], v1, s[20:23], s7 offen offset:3072 sc1
    s_mov_b64 exec, s[32:33]
    buffer_load_dwordx4 v[104:107], v1, s[20:23], s9 offen offset:3072 sc1
    buffer_load_dwordx4 v[108:111], v1, s[20:23], s9 offen offset:3328 sc1
    s_mov_b64 exec, -1
    buffer_load_dwordx4 v[220:223], v1, s[20:23], s14 offen sc1
    s_waitcnt vmcnt(0)
    v_cmp_u_f32 vcc, v40, v42
    s_cbranch_vccnz A1_CKk6_R
    s_branch A1_CKk6_K
A1_CKv5_R:
    s_cmp_eq_u32 s41, 0
    s_cbranch_scc1 A1_CKv5_K
    s_sub_u32 s41, s41, 1
    s_mov_b64 exec, s[32:33]
    buffer_load_dwordx4 v[88:91], v1, s[20:23], s9 offen offset:1024 sc1
    buffer_load_dwordx4 v[92:95], v1, s[20:23], s9 offen offset:1280 sc1
    s_mov_b64 exec, -1
    s_mov_b64 exec, s[32:33]
    buffer_load_dwordx4 v[96:99], v1, s[20:23], s9 offen offset:2048 sc1
    buffer_load_dwordx4 v[100:103], v1, s[20:23], s9 offen offset:2304 sc1
    s_mov_b64 exec, -1
    buffer_load_dwordx4 v[44:47], v1, s[20:23], s7 offen offset:3072 sc1
    s_mov_b64 exec, s[32:33]
    buffer_load_dwordx4 v[104:107], v1, s[20:23], s9 offen offset:3072 sc1
    buffer_load_dwordx4 v[108:111], v1, s[20:23], s9 offen offset:3328 sc1
    s_mov_b64 exec, -1
    buffer_load_dwordx4 v[220:223], v1, s[20:23], s14 offen sc1
    s_waitcnt vmcnt(0)
    v_cmp_u_f32 vcc, v88, v90
    s_cbranch_vccnz A1_CKv5_R
    v_cmp_u_f32 vcc, v92, v94
    s_cbranch_vccnz A1_CKv5_R
    s_branch A1_CKv5_K
A1_CKk7_R:
    s_cmp_eq_u32 s41, 0
    s_cbranch_scc1 A1_CKk7_K
    s_sub_u32 s41, s41, 1
    s_mov_b64 exec, s[32:33]
    buffer_load_dwordx4 v[96:99], v1, s[20:23], s9 offen offset:2048 sc1
    buffer_load_dwordx4 v[100:103], v1, s[20:23], s9 offen offset:2304 sc1
    s_mov_b64 exec, -1
    buffer_load_dwordx4 v[44:47], v1, s[20:23], s7 offen offset:3072 sc1
    s_mov_b64 exec, s[32:33]
    buffer_load_dwordx4 v[104:107], v1, s[20:23], s9 offen offset:3072 sc1
    buffer_load_dwordx4 v[108:111], v1, s[20:23], s9 offen offset:3328 sc1
    s_mov_b64 exec, -1
    buffer_load_dwordx4 v[220:223], v1, s[20:23], s14 offen sc1
    s_waitcnt vmcnt(0)
    v_cmp_u_f32 vcc, v44, v46
    s_cbranch_vccnz A1_CKk7_R
    s_branch A1_CKk7_K
A1_CKv6_R:
    s_cmp_eq_u32 s41, 0
    s_cbranch_scc1 A1_CKv6_K
    s_sub_u32 s41, s41, 1
    s_mov_b64 exec, s[32:33]
    buffer_load_dwordx4 v[96:99], v1, s[20:23], s9 offen offset:2048 sc1
    buffer_load_dwordx4 v[100:103], v1, s[20:23], s9 offen offset:2304 sc1
    s_mov_b64 exec, -1
    s_mov_b64 exec, s[32:33]
    buffer_load_dwordx4 v[104:107], v1, s[20:23], s9 offen offset:3072 sc1
    buffer_load_dwordx4 v[108:111], v1, s[20:23], s9 offen offset:3328 sc1
    s_mov_b64 exec, -1
    buffer_load_dwordx4 v[220:223], v1, s[20:23], s14 offen sc1
    s_waitcnt vmcnt(0)
    v_cmp_u_f32 vcc, v96, v98
    s_cbranch_vccnz A1_CKv6_R
    v_cmp_u_f32 vcc, v100, v102
    s_cbranch_vccnz A1_CKv6_R
    s_branch A1_CKv6_K
A1_CKv7_R:
    s_cmp_eq_u32 s41, 0
    s_cbranch_scc1 A1_CKv7_K
    s_sub_u32 s41, s41, 1
    s_mov_b64 exec, s[32:33]
    buffer_load_dwordx4 v[104:107], v1, s[20:23], s9 offen offset:3072 sc1
    buffer_load_dwordx4 v[108:111], v1, s[20:23], s9 offen offset:3328 sc1
    s_mov_b64 exec, -1
    buffer_load_dwordx4 v[220:223], v1, s[20:23], s14 offen sc1
    s_waitcnt vmcnt(0)
    v_cmp_u_f32 vcc, v104, v106
    s_cbranch_vccnz A1_CKv7_R
    v_cmp_u_f32 vcc, v108, v110
    s_cbranch_vccnz A1_CKv7_R
    s_branch A1_CKv7_K
A1_CKqd_R:
    s_cmp_eq_u32 s41, 0
    s_cbranch_scc1 A1_CKqd_K
    s_sub_u32 s41, s41, 1
    buffer_load_dwordx4 v[220:223], v1, s[20:23], s14 offen sc1
    s_waitcnt vmcnt(0)
    v_cmp_u_f32 vcc, v220, v222
    s_cbranch_vccnz A1_CKqd_R
    s_branch A1_CKqd_K
A1_CKres_R:
    s_cmp_eq_u32 s41, 0
    s_cbranch_scc1 A1_CKres_K
    s_sub_u32 s41, s41, 1
    buffer_load_dwordx2 v[232:233], v9, s[20:23], s15 offen offset:0 sc1
    buffer_load_dwordx2 v[234:235], v9, s[20:23], s15 offen offset:2048 sc1
    s_waitcnt vmcnt(0)
    v_cmp_u_f32 vcc, v232, v234
    s_cbranch_vccnz A1_CKres_R
    s_branch A1_CKres_K
A1_SLOW:
    s_nop 7
    v_mfma_f32_32x32x16_bf16 v[204:219], v[160:163], v[160:163], 0
    buffer_load_dwordx4 v[16:19], v1, s[20:23], s6 offen offset:0 sc1
    buffer_load_dwordx4 v[20:23], v1, s[20:23], s6 offen offset:1024 sc1
    buffer_load_dwordx4 v[24:27], v1, s[20:23], s6 offen offset:2048 sc1
    buffer_load_dwordx4 v[28:31], v1, s[20:23], s6 offen offset:3072 sc1
    buffer_load_dwordx4 v[32:35], v1, s[20:23], s7 offen offset:0 sc1
    buffer_load_dwordx4 v[36:39], v1, s[20:23], s7 offen offset:1024 sc1
    buffer_load_dwordx4 v[40:43], v1, s[20:23], s7 offen offset:2048 sc1
    buffer_load_dwordx4 v[44:47], v1, s[20:23], s7 offen offset:3072 sc1
    v_and_b32 v14, 59, v0
    v_cmp_eq_u32 vcc, 16, v14
    v_mov_b32 v15, 0xbf80bf80
    v_mov_b32 v220, 0xbafebf80
    v_mov_b32 v221, v220
    v_cndmask_b32 v224, 0, v15, vcc
    v_mov_b32 v222, v220
    v_mov_b32 v223, v220
    v_mov_b32 v225, 0
    v_mov_b32 v226, 0
    v_mov_b32 v227, 0
    s_nop 1
    v_mfma_f32_32x32x16_bf16 v[48:63], v[220:223], v[224:227], 0
    s_mov_b64 exec, s[32:33]
    s_nop 10
    buffer_load_dwordx4 v[48:51], v1, s[20:23], s8 offen offset:0 sc1
    buffer_load_dwordx4 v[52:55], v1, s[20:23], s8 offen offset:256 sc1
    s_mov_b64 exec, -1
    s_mov_b64 exec, s[32:33]
    buffer_load_dwordx4 v[56:59], v1, s[20:23], s8 offen offset:1024 sc1
    buffer_load_dwordx4 v[60:63], v1, s[20:23], s8 offen offset:1280 sc1
    s_mov_b64 exec, -1
    s_waitcnt vmcnt(0)
    v_and_b32 v15, 31, v0
    v_lshlrev_b32 v15, 2, v15
    s_lshl_b32 s24, s3, 7
    v_add_u32 v14, s24, v15
    v_mov_b32 v13, v1
    s_mov_b32 s12, 0
A1_S1:
    ds_read_b128 v[168:171], v13 offset:0
    v_mov_b32 v12, 0xff800000
    s_waitcnt lgkmcnt(0)
    v_mfma_f32_32x32x16_bf16 v[112:127], v[16:19], v[168:171], 0
    s_nop 11
    v_max3_f32 v12, v12, v112, v113
    v_max3_f32 v12, v12, v114, v115
    v_max3_f32 v12, v12, v116, v117
    v_max3_f32 v12, v12, v118, v119
    v_max3_f32 v12, v12, v120, v121
    v_max3_f32 v12, v12, v122, v123
    v_max3_f32 v12, v12, v124, v125
    v_max3_f32 v12, v12, v126, v127
    v_mfma_f32_32x32x16_bf16 v[112:127], v[20:23], v[168:171], 0
    s_nop 11
    v_max3_f32 v12, v12, v112, v113
    v_max3_f32 v12, v12, v114, v115
    v_max3_f32 v12, v12, v116, v117
    v_max3_f32 v12, v12, v118, v119
    v_max3_f32 v12, v12, v120, v121
    v_max3_f32 v12, v12, v122, v123
    v_max3_f32 v12, v12, v124, v125
    v_max3_f32 v12, v12, v126, v127
    v_mfma_f32_32x32x16_bf16 v[112:127], v[24:27], v[168:171], 0
    s_nop 11
    v_max3_f32 v12, v12, v112, v113
    v_max3_f32 v12, v12, v114, v115
    v_max3_f32 v12, v12, v116, v117
    v_max3_f32 v12, v12, v118, v119
    v_max3_f32 v12, v12, v120, v121
    v_max3_f32 v12, v12, v122, v123
    v_max3_f32 v12, v12, v124, v125
    v_max3_f32 v12, v12, v126, v127
    v_mfma_f32_32x32x16_bf16 v[112:127], v[28:31], v[168:171], 0
    s_nop 11
    v_max3_f32 v12, v12, v112, v113
    v_max3_f32 v12, v12, v114, v115
    v_max3_f32 v12, v12, v116, v117
    v_max3_f32 v12, v12, v118, v119
    v_max3_f32 v12, v12, v120, v121
    v_max3_f32 v12, v12, v122, v123
    v_max3_f32 v12, v12, v124, v125
    v_max3_f32 v12, v12, v126, v127
    v_mfma_f32_32x32x16_bf16 v[112:127], v[32:35], v[168:171], 0
    s_nop 11
    v_max3_f32 v12, v12, v112, v113
    v_max3_f32 v12, v12, v114, v115
    v_max3_f32 v12, v12, v116, v117
    v_max3_f32 v12, v12, v118, v119
    v_max3_f32 v12, v12, v120, v121
    v_max3_f32 v12, v12, v122, v123
    v_max3_f32 v12, v12, v124, v125
    v_max3_f32 v12, v12, v126, v127
    v_mfma_f32_32x32x16_bf16 v[112:127], v[36:39], v[168:171], 0
    s_nop 11
    v_max3_f32 v12, v12, v112, v113
    v_max3_f32 v12, v12, v114, v115
    v_max3_f32 v12, v12, v116, v117
    v_max3_f32 v12, v12, v118, v119
    v_max3_f32 v12, v12, v120, v121
    v_max3_f32 v12, v12, v122, v123
    v_max3_f32 v12, v12, v124, v125
    v_max3_f32 v12, v12, v126, v127
    v_mfma_f32_32x32x16_bf16 v[112:127], v[40:43], v[168:171], 0
    s_nop 11
    v_max3_f32 v12, v12, v112, v113
    v_max3_f32 v12, v12, v114, v115
    v_max3_f32 v12, v12, v116, v117
    v_max3_f32 v12, v12, v118, v119
    v_max3_f32 v12, v12, v120, v121
    v_max3_f32 v12, v12, v122, v123
    v_max3_f32 v12, v12, v124, v125
    v_max3_f32 v12, v12, v126, v127
    v_mfma_f32_32x32x16_bf16 v[112:127], v[44:47], v[168:171], 0
    s_nop 11
    v_max3_f32 v12, v12, v112, v113
    v_max3_f32 v12, v12, v114, v115
    v_max3_f32 v12, v12, v116, v117
    v_max3_f32 v12, v12, v118, v119
    v_max3_f32 v12, v12, v120, v121
    v_max3_f32 v12, v12, v122, v123
    v_max3_f32 v12, v12, v124, v125
    v_max3_f32 v12, v12, v126, v127
    v_mov_b32 v10, v12
    s_nop 1
    v_permlane32_swap_b32 v10, v12
    v_max_f32 v12, v12, v10
    ds_write_b32 v14, v12 offset:28672
    v_add_u32 v13, 0x400, v13
    v_add_u32 v14, 0x400, v14
    s_add_u32 s12, s12, 1
    s_cmp_lt_u32 s12, 8
    s_cbranch_scc1 A1_S1
    v_mov_b32 v13, v1
    s_sub_u32 s10, s10, 0x70000
    s_sub_u32 s11, s11, 0x70000
    s_mov_b32 s12, 0
    s_waitcnt lgkmcnt(0)
    s_barrier
A1_S2:
    buffer_load_dwordx4 v[172:175], v1, s[20:23], s10 offen offset:0
    buffer_load_dwordx4 v[176:179], v1, s[20:23], s10 offen offset:1024
    buffer_load_dwordx4 v[180:183], v1, s[20:23], s10 offen offset:2048
    buffer_load_dwordx4 v[184:187], v1, s[20:23], s10 offen offset:3072
    buffer_load_dwordx4 v[188:191], v1, s[20:23], s11 offen offset:0
    buffer_load_dwordx4 v[192:195], v1, s[20:23], s11 offen offset:1024
    buffer_load_dwordx4 v[196:199], v1, s[20:23], s11 offen offset:2048
    buffer_load_dwordx4 v[200:203], v1, s[20:23], s11 offen offset:3072
    ds_read_b128 v[168:171], v13 offset:0
    ds_read_b32 v220, v15 offset:28672
    ds_read_b32 v221, v15 offset:28800
    ds_read_b32 v222, v15 offset:28928
    ds_read_b32 v223, v15 offset:29056
    ds_read_b32 v224, v15 offset:29184
    ds_read_b32 v225, v15 offset:29312
    ds_read_b32 v226, v15 offset:29440
    ds_read_b32 v227, v15 offset:29568
    s_waitcnt lgkmcnt(0)
    v_max_f32 v12, v220, v221
    v_max3_f32 v12, v12, v222, v223
    v_max3_f32 v12, v12, v224, v225
    v_max3_f32 v12, v12, v226, v227
    v_sub_f32 v128, 0, v12
    v_sub_f32 v129, 0, v12
    v_sub_f32 v130, 0, v12
    v_sub_f32 v131, 0, v12
    v_sub_f32 v132, 0, v12
    v_sub_f32 v133, 0, v12
    v_sub_f32 v134, 0, v12
    v_sub_f32 v135, 0, v12
    v_sub_f32 v136, 0, v12
    v_sub_f32 v137, 0, v12
    v_sub_f32 v138, 0, v12
    v_sub_f32 v139, 0, v12
    v_sub_f32 v140, 0, v12
    v_sub_f32 v141, 0, v12
    v_sub_f32 v142, 0, v12
    v_sub_f32 v143, 0, v12
    v_mfma_f32_32x32x16_bf16 v[144:159], v[160:163], v[160:163], 0
    s_nop 0
    v_mfma_f32_32x32x16_bf16 v[112:127], v[16:19], v[168:171], v[128:143]
    s_nop 11
    v_exp_f32 v112, v112
    v_exp_f32 v113, v113
    v_exp_f32 v114, v114
    v_exp_f32 v115, v115
    v_exp_f32 v116, v116
    v_exp_f32 v117, v117
    v_exp_f32 v118, v118
    v_exp_f32 v119, v119
    v_exp_f32 v120, v120
    v_exp_f32 v121, v121
    v_exp_f32 v122, v122
    v_exp_f32 v123, v123
    v_exp_f32 v124, v124
    v_exp_f32 v125, v125
    v_exp_f32 v126, v126
    v_exp_f32 v127, v127
    v_smfmac_f32_32x32x32_bf16 v[144:159], v[48:51], v[112:119], v164
    s_nop 0
    v_smfmac_f32_32x32x32_bf16 v[144:159], v[52:55], v[120:127], v164
    v_mfma_f32_32x32x16_bf16 v[112:127], v[20:23], v[168:171], v[128:143]
    s_nop 11
    v_exp_f32 v112, v112
    v_exp_f32 v113, v113
    v_exp_f32 v114, v114
    v_exp_f32 v115, v115
    v_exp_f32 v116, v116
    v_exp_f32 v117, v117
    v_exp_f32 v118, v118
    v_exp_f32 v119, v119
    v_exp_f32 v120, v120
    v_exp_f32 v121, v121
    v_exp_f32 v122, v122
    v_exp_f32 v123, v123
    v_exp_f32 v124, v124
    v_exp_f32 v125, v125
    v_exp_f32 v126, v126
    v_exp_f32 v127, v127
    v_smfmac_f32_32x32x32_bf16 v[144:159], v[56:59], v[112:119], v164
    s_nop 0
    v_smfmac_f32_32x32x32_bf16 v[144:159], v[60:63], v[120:127], v164
    v_mfma_f32_32x32x16_bf16 v[112:127], v[24:27], v[168:171], v[128:143]
    s_nop 11
    v_exp_f32 v112, v112
    v_exp_f32 v113, v113
    v_exp_f32 v114, v114
    v_exp_f32 v115, v115
    v_exp_f32 v116, v116
    v_exp_f32 v117, v117
    v_exp_f32 v118, v118
    v_exp_f32 v119, v119
    v_exp_f32 v120, v120
    v_exp_f32 v121, v121
    v_exp_f32 v122, v122
    v_exp_f32 v123, v123
    v_exp_f32 v124, v124
    v_exp_f32 v125, v125
    v_exp_f32 v126, v126
    v_exp_f32 v127, v127
    v_smfmac_f32_32x32x32_bf16 v[144:159], v[64:67], v[112:119], v164
    s_nop 0
    v_smfmac_f32_32x32x32_bf16 v[144:159], v[68:71], v[120:127], v164
    v_mfma_f32_32x32x16_bf16 v[112:127], v[28:31], v[168:171], v[128:143]
    s_nop 11
    v_exp_f32 v112, v112
    v_exp_f32 v113, v113
    v_exp_f32 v114, v114
    v_exp_f32 v115, v115
    v_exp_f32 v116, v116
    v_exp_f32 v117, v117
    v_exp_f32 v118, v118
    v_exp_f32 v119, v119
    v_exp_f32 v120, v120
    v_exp_f32 v121, v121
    v_exp_f32 v122, v122
    v_exp_f32 v123, v123
    v_exp_f32 v124, v124
    v_exp_f32 v125, v125
    v_exp_f32 v126, v126
    v_exp_f32 v127, v127
    v_smfmac_f32_32x32x32_bf16 v[144:159], v[72:75], v[112:119], v164
    s_nop 0
    v_smfmac_f32_32x32x32_bf16 v[144:159], v[76:79], v[120:127], v164
    v_mfma_f32_32x32x16_bf16 v[112:127], v[32:35], v[168:171], v[128:143]
    s_nop 11
    v_exp_f32 v112, v112
    v_exp_f32 v113, v113
    v_exp_f32 v114, v114
    v_exp_f32 v115, v115
    v_exp_f32 v116, v116
    v_exp_f32 v117, v117
    v_exp_f32 v118, v118
    v_exp_f32 v119, v119
    v_exp_f32 v120, v120
    v_exp_f32 v121, v121
    v_exp_f32 v122, v122
    v_exp_f32 v123, v123
    v_exp_f32 v124, v124
    v_exp_f32 v125, v125
    v_exp_f32 v126, v126
    v_exp_f32 v127, v127
    v_smfmac_f32_32x32x32_bf16 v[144:159], v[80:83], v[112:119], v164
    s_nop 0
    v_smfmac_f32_32x32x32_bf16 v[144:159], v[84:87], v[120:127], v164
    v_mfma_f32_32x32x16_bf16 v[112:127], v[36:39], v[168:171], v[128:143]
    s_nop 11
    v_exp_f32 v112, v112
    v_exp_f32 v113, v113
    v_exp_f32 v114, v114
    v_exp_f32 v115, v115
    v_exp_f32 v116, v116
    v_exp_f32 v117, v117
    v_exp_f32 v118, v118
    v_exp_f32 v119, v119
    v_exp_f32 v120, v120
    v_exp_f32 v121, v121
    v_exp_f32 v122, v122
    v_exp_f32 v123, v123
    v_exp_f32 v124, v124
    v_exp_f32 v125, v125
    v_exp_f32 v126, v126
    v_exp_f32 v127, v127
    v_smfmac_f32_32x32x32_bf16 v[144:159], v[88:91], v[112:119], v164
    s_nop 0
    v_smfmac_f32_32x32x32_bf16 v[144:159], v[92:95], v[120:127], v164
    v_mfma_f32_32x32x16_bf16 v[112:127], v[40:43], v[168:171], v[128:143]
    s_nop 11
    v_exp_f32 v112, v112
    v_exp_f32 v113, v113
    v_exp_f32 v114, v114
    v_exp_f32 v115, v115
    v_exp_f32 v116, v116
    v_exp_f32 v117, v117
    v_exp_f32 v118, v118
    v_exp_f32 v119, v119
    v_exp_f32 v120, v120
    v_exp_f32 v121, v121
    v_exp_f32 v122, v122
    v_exp_f32 v123, v123
    v_exp_f32 v124, v124
    v_exp_f32 v125, v125
    v_exp_f32 v126, v126
    v_exp_f32 v127, v127
    v_smfmac_f32_32x32x32_bf16 v[144:159], v[96:99], v[112:119], v164
    s_nop 0
    v_smfmac_f32_32x32x32_bf16 v[144:159], v[100:103], v[120:127], v164
    v_mfma_f32_32x32x16_bf16 v[112:127], v[44:47], v[168:171], v[128:143]
    s_nop 11
    v_exp_f32 v112, v112
    v_exp_f32 v113, v113
    v_exp_f32 v114, v114
    v_exp_f32 v115, v115
    v_exp_f32 v116, v116
    v_exp_f32 v117, v117
    v_exp_f32 v118, v118
    v_exp_f32 v119, v119
    v_exp_f32 v120, v120
    v_exp_f32 v121, v121
    v_exp_f32 v122, v122
    v_exp_f32 v123, v123
    v_exp_f32 v124, v124
    v_exp_f32 v125, v125
    v_exp_f32 v126, v126
    v_exp_f32 v127, v127
    v_smfmac_f32_32x32x32_bf16 v[144:159], v[104:107], v[112:119], v164
    s_nop 0
    v_smfmac_f32_32x32x32_bf16 v[144:159], v[108:111], v[120:127], v164
    s_nop 11
    ds_write_b128 v4, v[144:147] offset:8192
    ds_write_b128 v4, v[148:151] offset:8224
    ds_write_b32 v5, v152 offset:49152
    s_waitcnt lgkmcnt(0)
    s_barrier
    ds_read_b32 v10, v239 offset:49152
    ds_read2st64_b32 v[220:221], v6 offset0:0 offset1:10
    ds_read2st64_b32 v[222:223], v6 offset0:20 offset1:30
    ds_read2st64_b32 v[224:225], v6 offset0:40 offset1:50
    ds_read2st64_b32 v[226:227], v6 offset0:60 offset1:70
    s_waitcnt lgkmcnt(0)
    v_add_f32 v10, v10, v10 quad_perm:[1,0,3,2] row_mask:0xf bank_mask:0xf
    v_pk_add_f32 v[220:221], v[220:221], v[222:223]
    v_pk_add_f32 v[224:225], v[224:225], v[226:227]
    v_add_f32 v10, v10, v10 quad_perm:[2,3,0,1] row_mask:0xf bank_mask:0xf
    v_pk_add_f32 v[220:221], v[220:221], v[224:225]
    v_add_f32 v220, v220, v221
    v_add_f32 v10, v10, v10 row_half_mirror row_mask:0xf bank_mask:0xf
    v_rcp_f32 v221, v10
    s_nop 0
    v_mul_f32 v220, v220, v221
    v_max3_f32 v238, v238, v10, v221
    v_cvt_pk_bf16_f32 v220, v220, v220
    ds_write_b16 v236, v220 offset:57344
    s_waitcnt lgkmcnt(0)
    s_barrier
    ds_read_b128 v[228:231], v237 offset:57344
    s_waitcnt vmcnt(0) lgkmcnt(0)
    v_smfmac_f32_16x16x64_bf16 v[204:207], v[228:231], v[172:179], v164 abid:1
    v_smfmac_f32_16x16x64_bf16 v[208:211], v[228:231], v[180:187], v164 abid:1
    v_smfmac_f32_16x16x64_bf16 v[212:215], v[228:231], v[188:195], v164 abid:1
    v_smfmac_f32_16x16x64_bf16 v[216:219], v[228:231], v[196:203], v164 abid:1
    v_add_u32 v13, 0x400, v13
    v_add_u32 v15, 0x400, v15
    s_add_u32 s10, s10, 0x10000
    s_add_u32 s11, s11, 0x10000
    s_add_u32 s12, s12, 1
    s_cmp_lt_u32 s12, 8
    s_cbranch_scc1 A1_S2
    v_lshlrev_b32 v112, 16, v232
    v_and_b32 v113, 0xffff0000, v232
    v_lshlrev_b32 v114, 16, v233
    v_and_b32 v115, 0xffff0000, v233
    v_lshlrev_b32 v116, 16, v234
    v_and_b32 v117, 0xffff0000, v234
    v_lshlrev_b32 v118, 16, v235
    v_and_b32 v119, 0xffff0000, v235
    s_nop 7
    s_branch A1_FIN
H1_XR0:
    s_cmp_eq_u32 s41, 0
    s_cbranch_scc1 H1_XK0
    s_sub_u32 s41, s41, 1
    s_add_u32 m0, s43, 0
    s_nop 0
    buffer_load_dwordx4 v240, s[20:23], s32 offen sc1 lds
    s_add_u32 m0, s43, 8192
    s_nop 0
    buffer_load_dwordx4 v240, s[20:23], s33 offen sc1 lds
    s_add_u32 m0, s43, 16384
    s_nop 0
    buffer_load_dwordx4 v240, s[20:23], s34 offen sc1 lds
    s_add_u32 m0, s43, 24576
    s_nop 0
    buffer_load_dwordx4 v240, s[20:23], s35 offen sc1 lds
    s_add_u32 m0, s43, 32768
    s_nop 0
    buffer_load_dwordx4 v240, s[20:23], s36 offen sc1 lds
    s_add_u32 m0, s43, 40960
    s_nop 0
    buffer_load_dwordx4 v240, s[20:23], s37 offen sc1 lds
    s_add_u32 m0, s43, 49152
    s_nop 0
    buffer_load_dwordx4 v240, s[20:23], s38 offen sc1 lds
    s_add_u32 m0, s43, 57344
    s_nop 0
    buffer_load_dwordx4 v240, s[20:23], s39 offen sc1 lds
    s_waitcnt vmcnt(7)
    ds_read_b128 v[192:195], v238 offset:0
    s_waitcnt lgkmcnt(0)
    v_cmp_u_f32 vcc, v192, v194
    s_cbranch_vccnz H1_XR0
    s_branch H1_XK0
H1_XR1:
    s_cmp_eq_u32 s41, 0
    s_cbranch_scc1 H1_XK1
    s_sub_u32 s41, s41, 1
    s_add_u32 m0, s43, 8192
    s_nop 0
    buffer_load_dwordx4 v240, s[20:23], s33 offen sc1 lds
    s_add_u32 m0, s43, 16384
    s_nop 0
    buffer_load_dwordx4 v240, s[20:23], s34 offen sc1 lds
    s_add_u32 m0, s43, 24576
    s_nop 0
    buffer_load_dwordx4 v240, s[20:23], s35 offen sc1 lds
    s_add_u32 m0, s43, 32768
    s_nop 0
    buffer_load_dwordx4 v240, s[20:23], s36 offen sc1 lds
    s_add_u32 m0, s43, 40960
    s_nop 0
    buffer_load_dwordx4 v240, s[20:23], s37 offen sc1 lds
    s_add_u32 m0, s43, 49152
    s_nop 0
    buffer_load_dwordx4 v240, s[20:23], s38 offen sc1 lds
    s_add_u32 m0, s43, 57344
    s_nop 0
    buffer_load_dwordx4 v240, s[20:23], s39 offen sc1 lds
    s_waitcnt vmcnt(6)
    ds_read_b128 v[196:199], v238 offset:8192
    s_waitcnt vmcnt(5)
    ds_read_b128 v[200:203], v238 offset:16384
    s_waitcnt lgkmcnt(0)
    v_max3_u32 v196, v196, v198, v200
    v_cmp_u_f32 vcc, v196, v202
    s_cbranch_vccnz H1_XR1
    s_branch H1_XK1
H1_XR3:
    s_cmp_eq_u32 s41, 0
    s_cbranch_scc1 H1_XK3
    s_sub_u32 s41, s41, 1
    s_add_u32 m0, s43, 24576
    s_nop 0
    buffer_load_dwordx4 v240, s[20:23], s35 offen sc1 lds
    s_add_u32 m0, s43, 32768
    s_nop 0
    buffer_load_dwordx4 v240, s[20:23], s36 offen sc1 lds
    s_add_u32 m0, s43, 40960
    s_nop 0
    buffer_load_dwordx4 v240, s[20:23], s37 offen sc1 lds
    s_add_u32 m0, s43, 49152
    s_nop 0
    buffer_load_dwordx4 v240, s[20:23], s38 offen sc1 lds
    s_add_u32 m0, s43, 57344
    s_nop 0
    buffer_load_dwordx4 v240, s[20:23], s39 offen sc1 lds
    s_waitcnt vmcnt(4)
    ds_read_b128 v[204:207], v238 offset:24576
    s_waitcnt vmcnt(3)
    ds_read_b128 v[208:211], v238 offset:32768
    s_waitcnt lgkmcnt(0)
    v_max3_u32 v204, v204, v206, v208
    v_cmp_u_f32 vcc, v204, v210
    s_cbranch_vccnz H1_XR3
    s_branch H1_XK3
H1_XR5:
    s_cmp_eq_u32 s41, 0
    s_cbranch_scc1 H1_XK5
    s_sub_u32 s41, s41, 1
    s_add_u32 m0, s43, 40960
    s_nop 0
    buffer_load_dwordx4 v240, s[20:23], s37 offen sc1 lds
    s_add_u32 m0, s43, 49152
    s_nop 0
    buffer_load_dwordx4 v240, s[20:23], s38 offen sc1 lds
    s_add_u32 m0, s43, 57344
    s_nop 0
    buffer_load_dwordx4 v240, s[20:23], s39 offen sc1 lds
    s_waitcnt vmcnt(2)
    ds_read_b128 v[212:215], v238 offset:40960
    s_waitcnt vmcnt(1)
    ds_read_b128 v[216:219], v238 offset:49152
    s_waitcnt vmcnt(0)
    ds_read_b128 v[220:223], v238 offset:57344
    s_waitcnt lgkmcnt(0)
    v_max3_u32 v212, v212, v214, v216
    v_max3_u32 v212, v212, v218, v220
    v_cmp_u_f32 vcc, v212, v222
    s_cbranch_vccnz H1_XR5
    s_branch H1_XK5
H2:
    s_setprio 3
TP3:
    s_cbranch_execz TR3
    s_sub_u32 s6, s3, 4
    s_lshl_b32 s19, s6, 11
    v_lshlrev_b32 v238, 4, v0
    v_lshrrev_b32 v12, 1, v0
    v_mul_u32_u24 v236, 8320, v12
    v_and_b32 v13, 1, v0
    v_lshl_add_u32 v236, v13, 4, v236
    v_lshlrev_b32 v237, 4, v12
    v_lshl_add_u32 v237, v13, 9, v237
    v_add_u32 v237, s19, v237
    s_mul_i32 s14, s6, 532480
    s_lshl_b32 s12, s42, 5
    s_add_u32 s12, s12, s14
    s_add_u32 s12, s12, 0x1000000
    s_add_u32 s13, s12, 266240
    s_add_u32 s14, s14, 0x1002000
    s_add_u32 s15, s14, 266240
    s_waitcnt vmcnt(0)
    buffer_load_dwordx4 v[192:195], v236, s[20:23], s12 offen sc1
    buffer_load_dwordx4 v[196:199], v236, s[20:23], s13 offen sc1
    buffer_load_dwordx4 v[200:203], v236, s[20:23], s14 offen sc1
    buffer_load_dwordx4 v[204:207], v236, s[20:23], s15 offen sc1
    s_and_b32 s24, s2, 7
    s_lshl_b32 s24, s24, 2
    s_bfe_u32 s25, s2, 0x20003
    s_add_u32 s4, s24, s25
    s_lshr_b32 s5, s2, 5
    s_lshl_b32 s25, s25, 1
    s_xor_b32 s18, s5, s25
    v_and_b32 v12, 4, v0
    v_lshlrev_b32 v4, 5, v12
    v_bfe_u32 v12, v0, 3, 3
    v_lshl_add_u32 v4, v12, 9, v4
    v_and_b32 v13, 3, v0
    v_lshl_add_u32 v4, v13, 3, v4
    v_and_b32 v12, 3, v12
    v_xor_b32 v12, s6, v12
    v_lshl_add_u32 v4, v12, 5, v4
    v_xor_b32 v5, 64, v4
    v_mov_b32 v11, 0x3727c5ac
    s_lshl_b32 s24, s6, 6
    s_add_u32 s24, s24, 0x24000
    v_lshl_add_u32 v8, v2, 2, s24
    v_mov_b32 v12, -1
    v_mov_b32 v13, 0xffff0000
    s_mov_b64 s[24:25], 0xffff
    v_cndmask_b32 v10, v12, v13, s[24:25]
    v_and_b32 v12, 1, v3
    v_xor_b32 v12, s3, v12
    v_and_b32 v12, 1, v12
    v_lshlrev_b32 v12, 6, v12
    v_xor_b32 v240, v12, v238
    v_and_b32 v12, 32, v0
    v_xor_b32 v240, v12, v240
    s_mul_i32 s24, s4, 65792
    s_lshl_b32 s43, s3, 10
    s_add_u32 s24, s24, s43
    s_add_u32 s24, s24, 0x240000
    s_add_u32 s24, s24, 0x1000000
    s_lshl_b32 s25, s18, 13
    s_xor_b32 s32, s25, 0
    s_add_u32 s32, s32, s24
    s_xor_b32 s33, s25, 8192
    s_add_u32 s33, s33, s24
    s_xor_b32 s34, s25, 16384
    s_add_u32 s34, s34, s24
    s_xor_b32 s35, s25, 24576
    s_add_u32 s35, s35, s24
    s_xor_b32 s36, s25, 32768
    s_add_u32 s36, s36, s24
    s_xor_b32 s37, s25, 40960
    s_add_u32 s37, s37, s24
    s_xor_b32 s38, s25, 49152
    s_add_u32 s38, s38, s24
    s_xor_b32 s39, s25, 57344
    s_add_u32 s39, s39, s24
    s_lshr_b32 s30, s5, 1
    s_and_b32 s31, s5, 1
    v_and_b32 v12, 1, v3
    v_lshlrev_b32 v225, 9, v12
    v_lshl_add_u32 v225, v2, 4, v225
    v_lshrrev_b32 v12, 5, v0
    v_lshl_add_u32 v225, v12, 3, v225
    v_add_u32 v225, 0x20000, v225
    v_add_u32 v224, 4, v225
    s_lshl_b32 s9, s4, 11
    s_lshr_b32 s24, s30, 1
    s_lshl_b32 s24, s24, 10
    s_add_u32 s9, s9, s24
    s_and_b32 s24, s30, 1
    s_lshl_b32 s24, s24, 8
    s_add_u32 s9, s9, s24
    s_lshl_b32 s24, s31, 16
    s_add_u32 s9, s9, s24
    s_add_u32 s9, s9, 0x1d00000
    v_and_b32 v227, 1, v3
    v_lshlrev_b32 v227, 3, v227
    v_lshl_add_u32 v227, v2, 4, v227
    v_lshrrev_b32 v13, 1, v3
    v_lshl_add_u32 v227, v13, 9, v227
    s_lshl_b32 s8, s30, 6
    s_add_u32 s8, s8, 0x24000
    s_cmp_eq_u32 s6, s30
    s_cselect_b32 s31, s31, 2
    v_xor_b32 v6, 32, v4
    v_xor_b32 v7, 32, v5
    s_and_b32 s7, s6, 1
    s_lshl_b32 s24, s5, 5
    s_add_u32 s24, s24, s7
    v_lshl_add_u32 v12, v2, 1, s24
    v_cvt_f32_u32 v12, v12
    v_mul_f32 v12, 0x3b000000, v12
    v_cvt_f32_u32 v13, v3
    s_lshl_b32 s24, s18, 3
    v_cvt_f32_u32 v14, s24
    v_add_f32 v13, v13, v14
    v_mul_f32 v13, 4.0, v13
    v_mul_f32 v13, v13, v12
    s_bitcmp1_b32 s18, 0
    s_cselect_b32 s24, -0.5, 0.5
    v_mul_f32 v20, 0x42800000, v12
    v_mul_f32 v18, s24, v20
    s_bitcmp1_b32 s18, 1
    s_cselect_b32 s24, -1.0, 1.0
    v_mul_f32 v20, s24, v20
    s_mov_b32 s26, 0x3d800000
    s_mov_b32 s27, 0xbd800000
H2_ZW:
    s_waitcnt vmcnt(0)
    v_cmp_u_f32 vcc, v192, v194
    v_cmp_u_f32 s[24:25], v196, v198
    v_max3_u32 v208, v200, v201, v202
    v_max3_u32 v209, v203, v204, v205
    v_max3_u32 v208, v208, v206, v207
    s_or_b64 vcc, vcc, s[24:25]
    v_cmp_u_f32 s[24:25], v208, v209
    s_or_b64 vcc, vcc, s[24:25]
    s_cbranch_scc1 H2_ZR
H2_ZK:
    s_mov_b64 exec, -1
    ds_write_b128 v237, v[192:195] offset:0
    ds_write_b128 v237, v[196:199] offset:1024
    ds_write_b128 v237, v[200:203] offset:8192
    ds_write_b128 v237, v[204:207] offset:9216
    s_waitcnt lgkmcnt(0)
    s_barrier
    s_setprio 0
    v_fmamk_f32 v128, v12, 0x00000000, v13
    v_fmamk_f32 v130, v12, 0x40000000, v13
    v_fmamk_f32 v132, v12, 0x41800000, v13
    v_fmamk_f32 v134, v12, 0x41900000, v13
    v_fmamk_f32 v136, v12, 0x3f800000, v13
    v_fmamk_f32 v138, v12, 0x40400000, v13
    v_fmamk_f32 v140, v12, 0x41880000, v13
    v_fmamk_f32 v142, v12, 0x41980000, v13
    v_sin_f32 v19, v18
    v_cos_f32 v18, v18
    v_sin_f32 v21, v20
    v_cos_f32 v20, v20
    v_sin_f32 v129, v128
    v_cos_f32 v128, v128
    v_sin_f32 v131, v130
    v_cos_f32 v130, v130
    v_sin_f32 v133, v132
    v_cos_f32 v132, v132
    v_sin_f32 v135, v134
    v_cos_f32 v134, v134
    v_sin_f32 v137, v136
    v_cos_f32 v136, v136
    v_sin_f32 v139, v138
    v_cos_f32 v138, v138
    v_sin_f32 v141, v140
    v_cos_f32 v140, v140
    v_sin_f32 v143, v142
    v_cos_f32 v142, v142
    v_pk_mul_f32 v[128:129], v[128:129], s[26:27]
    v_pk_mul_f32 v[130:131], v[130:131], s[26:27]
    v_pk_mul_f32 v[132:133], v[132:133], s[26:27]
    v_pk_mul_f32 v[134:135], v[134:135], s[26:27]
    v_pk_mul_f32 v[136:137], v[136:137], s[26:27]
    v_pk_mul_f32 v[138:139], v[138:139], s[26:27]
    v_pk_mul_f32 v[140:141], v[140:141], s[26:27]
    v_pk_mul_f32 v[142:143], v[142:143], s[26:27]
    v_cvt_pk_bf16_f32 v64, v128, v129
    v_cvt_pk_bf16_f32 v65, v130, v131
    v_cvt_pk_bf16_f32 v66, v132, v133
    v_cvt_pk_bf16_f32 v67, v134, v135
    v_cvt_pk_bf16_f32 v68, v136, v137
    v_cvt_pk_bf16_f32 v69, v138, v139
    v_cvt_pk_bf16_f32 v70, v140, v141
    v_cvt_pk_bf16_f32 v71, v142, v143
    v_pk_mul_f32 v[144:145], v[128:129], v[18:19] op_sel_hi:[1,0]
    v_pk_mul_f32 v[146:147], v[130:131], v[18:19] op_sel_hi:[1,0]
    v_pk_mul_f32 v[148:149], v[132:133], v[18:19] op_sel_hi:[1,0]
    v_pk_mul_f32 v[150:151], v[134:135], v[18:19] op_sel_hi:[1,0]
    v_pk_mul_f32 v[152:153], v[136:137], v[18:19] op_sel_hi:[1,0]
    v_pk_mul_f32 v[154:155], v[138:139], v[18:19] op_sel_hi:[1,0]
    v_pk_mul_f32 v[156:157], v[140:141], v[18:19] op_sel_hi:[1,0]
    v_pk_mul_f32 v[158:159], v[142:143], v[18:19] op_sel_hi:[1,0]
    v_pk_fma_f32 v[144:145], v[128:129], v[18:19], v[144:145] op_sel:[1,1,0] op_sel_hi:[0,1,1] neg_hi:[1,0,0]
    v_pk_fma_f32 v[146:147], v[130:131], v[18:19], v[146:147] op_sel:[1,1,0] op_sel_hi:[0,1,1] neg_hi:[1,0,0]
    v_pk_fma_f32 v[148:149], v[132:133], v[18:19], v[148:149] op_sel:[1,1,0] op_sel_hi:[0,1,1] neg_hi:[1,0,0]
    v_pk_fma_f32 v[150:151], v[134:135], v[18:19], v[150:151] op_sel:[1,1,0] op_sel_hi:[0,1,1] neg_hi:[1,0,0]
    v_pk_fma_f32 v[152:153], v[136:137], v[18:19], v[152:153] op_sel:[1,1,0] op_sel_hi:[0,1,1] neg_hi:[1,0,0]
    v_pk_fma_f32 v[154:155], v[138:139], v[18:19], v[154:155] op_sel:[1,1,0] op_sel_hi:[0,1,1] neg_hi:[1,0,0]
    v_pk_fma_f32 v[156:157], v[140:141], v[18:19], v[156:157] op_sel:[1,1,0] op_sel_hi:[0,1,1] neg_hi:[1,0,0]
    v_pk_fma_f32 v[158:159], v[142:143], v[18:19], v[158:159] op_sel:[1,1,0] op_sel_hi:[0,1,1] neg_hi:[1,0,0]
    v_cvt_pk_bf16_f32 v72, v144, v145
    v_cvt_pk_bf16_f32 v73, v146, v147
    v_cvt_pk_bf16_f32 v74, v148, v149
    v_cvt_pk_bf16_f32 v75, v150, v151
    v_cvt_pk_bf16_f32 v76, v152, v153
    v_cvt_pk_bf16_f32 v77, v154, v155
    v_cvt_pk_bf16_f32 v78, v156, v157
    v_cvt_pk_bf16_f32 v79, v158, v159
    v_pk_mul_f32 v[32:33], v[128:129], v[20:21] op_sel_hi:[1,0]
    v_pk_mul_f32 v[34:35], v[130:131], v[20:21] op_sel_hi:[1,0]
    v_pk_mul_f32 v[36:37], v[132:133], v[20:21] op_sel_hi:[1,0]
    v_pk_mul_f32 v[38:39], v[134:135], v[20:21] op_sel_hi:[1,0]
    v_pk_mul_f32 v[40:41], v[136:137], v[20:21] op_sel_hi:[1,0]
    v_pk_mul_f32 v[42:43], v[138:139], v[20:21] op_sel_hi:[1,0]
    v_pk_mul_f32 v[44:45], v[140:141], v[20:21] op_sel_hi:[1,0]
    v_pk_mul_f32 v[46:47], v[142:143], v[20:21] op_sel_hi:[1,0]
    v_pk_fma_f32 v[32:33], v[128:129], v[20:21], v[32:33] op_sel:[1,1,0] op_sel_hi:[0,1,1] neg_hi:[1,0,0]
    v_pk_fma_f32 v[34:35], v[130:131], v[20:21], v[34:35] op_sel:[1,1,0] op_sel_hi:[0,1,1] neg_hi:[1,0,0]
    v_pk_fma_f32 v[36:37], v[132:133], v[20:21], v[36:37] op_sel:[1,1,0] op_sel_hi:[0,1,1] neg_hi:[1,0,0]
    v_pk_fma_f32 v[38:39], v[134:135], v[20:21], v[38:39] op_sel:[1,1,0] op_sel_hi:[0,1,1] neg_hi:[1,0,0]
    v_pk_fma_f32 v[40:41], v[136:137], v[20:21], v[40:41] op_sel:[1,1,0] op_sel_hi:[0,1,1] neg_hi:[1,0,0]
    v_pk_fma_f32 v[42:43], v[138:139], v[20:21], v[42:43] op_sel:[1,1,0] op_sel_hi:[0,1,1] neg_hi:[1,0,0]
    v_pk_fma_f32 v[44:45], v[140:141], v[20:21], v[44:45] op_sel:[1,1,0] op_sel_hi:[0,1,1] neg_hi:[1,0,0]
    v_pk_fma_f32 v[46:47], v[142:143], v[20:21], v[46:47] op_sel:[1,1,0] op_sel_hi:[0,1,1] neg_hi:[1,0,0]
    v_cvt_pk_bf16_f32 v80, v32, v33
    v_cvt_pk_bf16_f32 v81, v34, v35
    v_cvt_pk_bf16_f32 v82, v36, v37
    v_cvt_pk_bf16_f32 v83, v38, v39
    v_cvt_pk_bf16_f32 v84, v40, v41
    v_cvt_pk_bf16_f32 v85, v42, v43
    v_cvt_pk_bf16_f32 v86, v44, v45
    v_cvt_pk_bf16_f32 v87, v46, v47
    v_pk_mul_f32 v[48:49], v[144:145], v[20:21] op_sel_hi:[1,0]
    v_pk_mul_f32 v[50:51], v[146:147], v[20:21] op_sel_hi:[1,0]
    v_pk_mul_f32 v[52:53], v[148:149], v[20:21] op_sel_hi:[1,0]
    v_pk_mul_f32 v[54:55], v[150:151], v[20:21] op_sel_hi:[1,0]
    v_pk_mul_f32 v[56:57], v[152:153], v[20:21] op_sel_hi:[1,0]
    v_pk_mul_f32 v[58:59], v[154:155], v[20:21] op_sel_hi:[1,0]
    v_pk_mul_f32 v[60:61], v[156:157], v[20:21] op_sel_hi:[1,0]
    v_pk_mul_f32 v[62:63], v[158:159], v[20:21] op_sel_hi:[1,0]
    v_pk_fma_f32 v[48:49], v[144:145], v[20:21], v[48:49] op_sel:[1,1,0] op_sel_hi:[0,1,1] neg_hi:[1,0,0]
    v_pk_fma_f32 v[50:51], v[146:147], v[20:21], v[50:51] op_sel:[1,1,0] op_sel_hi:[0,1,1] neg_hi:[1,0,0]
    v_pk_fma_f32 v[52:53], v[148:149], v[20:21], v[52:53] op_sel:[1,1,0] op_sel_hi:[0,1,1] neg_hi:[1,0,0]
    v_pk_fma_f32 v[54:55], v[150:151], v[20:21], v[54:55] op_sel:[1,1,0] op_sel_hi:[0,1,1] neg_hi:[1,0,0]
    v_pk_fma_f32 v[56:57], v[152:153], v[20:21], v[56:57] op_sel:[1,1,0] op_sel_hi:[0,1,1] neg_hi:[1,0,0]
    v_pk_fma_f32 v[58:59], v[154:155], v[20:21], v[58:59] op_sel:[1,1,0] op_sel_hi:[0,1,1] neg_hi:[1,0,0]
    v_pk_fma_f32 v[60:61], v[156:157], v[20:21], v[60:61] op_sel:[1,1,0] op_sel_hi:[0,1,1] neg_hi:[1,0,0]
    v_pk_fma_f32 v[62:63], v[158:159], v[20:21], v[62:63] op_sel:[1,1,0] op_sel_hi:[0,1,1] neg_hi:[1,0,0]
    v_cvt_pk_bf16_f32 v88, v48, v49
    v_cvt_pk_bf16_f32 v89, v50, v51
    v_cvt_pk_bf16_f32 v90, v52, v53
    v_cvt_pk_bf16_f32 v91, v54, v55
    v_cvt_pk_bf16_f32 v92, v56, v57
    v_cvt_pk_bf16_f32 v93, v58, v59
    v_cvt_pk_bf16_f32 v94, v60, v61
    v_cvt_pk_bf16_f32 v95, v62, v63
    s_barrier
    v_and_b32 v17, 1, v0
    s_lshl_b32 s24, s7, 31
    s_or_b32 s24, s24, 0x3d353d35
    v_mov_b32 v16, s24
    s_cmp_eq_u32 s7, 1
    s_cbranch_scc1 H2_HO
    v_mul_u32_u24 v17, 0x8000, v17
    v_lshl_or_b32 v17, v17, 16, v17
    v_xor_b32 v96, v17, v64
    v_xor_b32 v97, v17, v65
    v_xor_b32 v98, v17, v66
    v_xor_b32 v99, v17, v67
    v_xor_b32 v100, v17, v68
    v_xor_b32 v101, v17, v69
    v_xor_b32 v102, v17, v70
    v_xor_b32 v103, v17, v71
    v_xor_b32 v104, v17, v72
    v_xor_b32 v105, v17, v73
    v_xor_b32 v106, v17, v74
    v_xor_b32 v107, v17, v75
    v_xor_b32 v108, v17, v76
    v_xor_b32 v109, v17, v77
    v_xor_b32 v110, v17, v78
    v_xor_b32 v111, v17, v79
    v_xor_b32 v112, v17, v80
    v_xor_b32 v113, v17, v81
    v_xor_b32 v114, v17, v82
    v_xor_b32 v115, v17, v83
    v_xor_b32 v116, v17, v84
    v_xor_b32 v117, v17, v85
    v_xor_b32 v118, v17, v86
    v_xor_b32 v119, v17, v87
    v_xor_b32 v120, v17, v88
    v_xor_b32 v121, v17, v89
    v_xor_b32 v122, v17, v90
    v_xor_b32 v123, v17, v91
    v_xor_b32 v124, v17, v92
    v_xor_b32 v125, v17, v93
    v_xor_b32 v126, v17, v94
    v_xor_b32 v127, v17, v95
    s_branch H2_HJ
H2_HO:
    s_lshr_b32 s24, s18, 2
    v_xor_b32 v17, s24, v17
    v_lshlrev_b32 v17, 4, v17
    s_mov_b32 s24, 0x80000000
    v_lshrrev_b32 v17, v17, s24
    v_pk_add_u16 v96, v64, v17 op_sel:[1,0] op_sel_hi:[0,1]
    v_pk_add_u16 v97, v65, v17 op_sel:[1,0] op_sel_hi:[0,1]
    v_pk_add_u16 v98, v66, v17 op_sel:[1,0] op_sel_hi:[0,1]
    v_pk_add_u16 v99, v67, v17 op_sel:[1,0] op_sel_hi:[0,1]
    v_pk_add_u16 v100, v68, v17 op_sel:[1,0] op_sel_hi:[0,1]
    v_pk_add_u16 v101, v69, v17 op_sel:[1,0] op_sel_hi:[0,1]
    v_pk_add_u16 v102, v70, v17 op_sel:[1,0] op_sel_hi:[0,1]
    v_pk_add_u16 v103, v71, v17 op_sel:[1,0] op_sel_hi:[0,1]
    v_pk_add_u16 v104, v72, v17 op_sel:[1,0] op_sel_hi:[0,1]
    v_pk_add_u16 v105, v73, v17 op_sel:[1,0] op_sel_hi:[0,1]
    v_pk_add_u16 v106, v74, v17 op_sel:[1,0] op_sel_hi:[0,1]
    v_pk_add_u16 v107, v75, v17 op_sel:[1,0] op_sel_hi:[0,1]
    v_pk_add_u16 v108, v76, v17 op_sel:[1,0] op_sel_hi:[0,1]
    v_pk_add_u16 v109, v77, v17 op_sel:[1,0] op_sel_hi:[0,1]
    v_pk_add_u16 v110, v78, v17 op_sel:[1,0] op_sel_hi:[0,1]
    v_pk_add_u16 v111, v79, v17 op_sel:[1,0] op_sel_hi:[0,1]
    v_pk_add_u16 v112, v80, v17 op_sel:[1,0] op_sel_hi:[0,1]
    v_pk_add_u16 v113, v81, v17 op_sel:[1,0] op_sel_hi:[0,1]
    v_pk_add_u16 v114, v82, v17 op_sel:[1,0] op_sel_hi:[0,1]
    v_pk_add_u16 v115, v83, v17 op_sel:[1,0] op_sel_hi:[0,1]
    v_pk_add_u16 v116, v84, v17 op_sel:[1,0] op_sel_hi:[0,1]
    v_pk_add_u16 v117, v85, v17 op_sel:[1,0] op_sel_hi:[0,1]
    v_pk_add_u16 v118, v86, v17 op_sel:[1,0] op_sel_hi:[0,1]
    v_pk_add_u16 v119, v87, v17 op_sel:[1,0] op_sel_hi:[0,1]
    v_pk_add_u16 v120, v88, v17 op_sel:[1,0] op_sel_hi:[0,1]
    v_pk_add_u16 v121, v89, v17 op_sel:[1,0] op_sel_hi:[0,1]
    v_pk_add_u16 v122, v90, v17 op_sel:[1,0] op_sel_hi:[0,1]
    v_pk_add_u16 v123, v91, v17 op_sel:[1,0] op_sel_hi:[0,1]
    v_pk_add_u16 v124, v92, v17 op_sel:[1,0] op_sel_hi:[0,1]
    v_pk_add_u16 v125, v93, v17 op_sel:[1,0] op_sel_hi:[0,1]
    v_pk_add_u16 v126, v94, v17 op_sel:[1,0] op_sel_hi:[0,1]
    v_pk_add_u16 v127, v95, v17 op_sel:[1,0] op_sel_hi:[0,1]
H2_HJ:
    s_cmp_eq_u32 s18, 0
    s_cselect_b64 s[24:25], 0xffff, 0
    v_cndmask_b32 v64, v64, v16, s[24:25]
    s_cmp_eq_u32 s18, 1
    s_cselect_b64 s[24:25], 0xffff, 0
    v_cndmask_b32 v72, v72, v16, s[24:25]
    s_cmp_eq_u32 s18, 2
    s_cselect_b64 s[24:25], 0xffff, 0
    v_cndmask_b32 v80, v80, v16, s[24:25]
    s_cmp_eq_u32 s18, 3
    s_cselect_b64 s[24:25], 0xffff, 0
    v_cndmask_b32 v88, v88, v16, s[24:25]
    s_cmp_eq_u32 s18, 4
    s_cselect_b64 s[24:25], 0xffff, 0
    v_cndmask_b32 v96, v96, v16, s[24:25]
    s_cmp_eq_u32 s18, 5
    s_cselect_b64 s[24:25], 0xffff, 0
    v_cndmask_b32 v104, v104, v16, s[24:25]
    s_cmp_eq_u32 s18, 6
    s_cselect_b64 s[24:25], 0xffff, 0
    v_cndmask_b32 v112, v112, v16, s[24:25]
    s_cmp_eq_u32 s18, 7
    s_cselect_b64 s[24:25], 0xffff, 0
    v_cndmask_b32 v120, v120, v16, s[24:25]
    v_and_b32 v9, 31, v0
    v_lshlrev_b32 v9, 3, v9
    v_lshrrev_b32 v12, 5, v0
    v_lshl_add_u32 v9, v12, 13, v9
    s_lshl_b32 s10, s4, 16
    s_lshr_b32 s24, s5, 1
    s_lshl_b32 s24, s24, 10
    s_add_u32 s10, s10, s24
    s_lshl_b32 s24, s7, 9
    s_add_u32 s10, s10, s24
    s_and_b32 s24, s5, 1
    s_lshl_b32 s24, s24, 8
    s_add_u32 s10, s10, s24
    s_add_u32 s10, s10, 0x680000
    s_lshl_b32 s24, s6, 14
    s_xor_b32 s25, s24, 0x4000
    s_add_u32 s11, s10, s25
    s_add_u32 s10, s10, s24
    s_add_u32 s28, s10, 0x1000
    s_add_u32 s29, s11, 0x1000
    s_mov_b32 s12, 0xaaaaaaaa
    s_mov_b32 s13, 0xaaaaaaaa
    s_mov_b32 s14, 0xcccccccc
    s_mov_b32 s15, 0xcccccccc
    s_mov_b32 s16, 0x00f0000f
    s_mov_b32 s17, 0xf0000f00
    s_cmp_lg_u32 s3, 5
    s_cbranch_scc1 TS6
    s_mov_b64 exec, 0
    s_branch TP6
TR6:
    s_mov_b64 exec, -1
TS6:
    s_cmp_lg_u32 s3, 6
    s_cbranch_scc1 TS7
    s_mov_b64 exec, 0
    s_branch TP7
TR7:
    s_mov_b64 exec, -1
TS7:
    s_cmp_lg_u32 s3, 7
    s_cbranch_scc1 TS8
    s_mov_b64 exec, 0
    s_branch TP8
TR8:
    s_mov_b64 exec, -1
TS8:
    s_setprio 3
    s_barrier
    s_cmp_eq_u32 s31, 2
    s_cbranch_scc1 H2_KW
    ds_read2st64_b32 v[128:129], v225 offset0:0 offset1:1
    ds_read2st64_b32 v[130:131], v225 offset0:4 offset1:5
    ds_read2st64_b32 v[132:133], v224 offset0:0 offset1:1
    ds_read2st64_b32 v[134:135], v224 offset0:4 offset1:5
    ds_read2st64_b32 v[136:137], v225 offset0:8 offset1:9
    ds_read2st64_b32 v[138:139], v225 offset0:12 offset1:13
    ds_read2st64_b32 v[140:141], v224 offset0:8 offset1:9
    ds_read2st64_b32 v[142:143], v224 offset0:12 offset1:13
    s_waitcnt lgkmcnt(4)
    ds_read2st64_b32 v[144:145], v225 offset0:16 offset1:17
    ds_read2st64_b32 v[146:147], v225 offset0:20 offset1:21
    ds_read2st64_b32 v[148:149], v224 offset0:16 offset1:17
    ds_read2st64_b32 v[150:151], v224 offset0:20 offset1:21
    s_waitcnt lgkmcnt(4)
    ds_read2st64_b32 v[152:153], v225 offset0:24 offset1:25
    ds_read2st64_b32 v[154:155], v225 offset0:28 offset1:29
    ds_read2st64_b32 v[156:157], v224 offset0:24 offset1:25
    ds_read2st64_b32 v[158:159], v224 offset0:28 offset1:29
    s_waitcnt lgkmcnt(4)
    ds_read2st64_b32 v[160:161], v225 offset0:32 offset1:33
    ds_read2st64_b32 v[162:163], v225 offset0:36 offset1:37
    ds_read2st64_b32 v[164:165], v224 offset0:32 offset1:33
    ds_read2st64_b32 v[166:167], v224 offset0:36 offset1:37
    s_waitcnt lgkmcnt(4)
    ds_read2st64_b32 v[168:169], v225 offset0:40 offset1:41
    ds_read2st64_b32 v[170:171], v225 offset0:44 offset1:45
    ds_read2st64_b32 v[172:173], v224 offset0:40 offset1:41
    ds_read2st64_b32 v[174:175], v224 offset0:44 offset1:45
    s_waitcnt lgkmcnt(4)
    ds_read2st64_b32 v[176:177], v225 offset0:48 offset1:49
    ds_read2st64_b32 v[178:179], v225 offset0:52 offset1:53
    ds_read2st64_b32 v[180:181], v224 offset0:48 offset1:49
    ds_read2st64_b32 v[182:183], v224 offset0:52 offset1:53
    s_waitcnt lgkmcnt(4)
    ds_read2st64_b32 v[184:185], v225 offset0:56 offset1:57
    ds_read2st64_b32 v[186:187], v225 offset0:60 offset1:61
    ds_read2st64_b32 v[188:189], v224 offset0:56 offset1:57
    ds_read2st64_b32 v[190:191], v224 offset0:60 offset1:61
    s_branch H2_KW
H2_N0:
    s_nop 0
    v_and_b32 v32, v10, v32
    s_nop 0
    s_branch H2_M0
H2_N1:
    s_nop 0
    v_and_b32 v48, v10, v48
    s_nop 0
    s_branch H2_M1
H2_N2:
    s_nop 0
    v_and_b32 v32, v10, v32
    s_nop 0
    s_branch H2_M2
H2_N3:
    s_nop 0
    v_and_b32 v48, v10, v48
    s_nop 0
    s_branch H2_M3
H2_N4:
    s_nop 0
    v_and_b32 v32, v10, v32
    s_nop 0
    s_branch H2_M4
H2_N5:
    s_nop 0
    v_and_b32 v48, v10, v48
    s_nop 0
    s_branch H2_M5
H2_N6:
    s_nop 0
    v_and_b32 v32, v10, v32
    s_nop 0
    s_branch H2_M6
H2_N7:
    s_nop 0
    v_and_b32 v48, v10, v48
    s_nop 0
    s_branch H2_M7
H2_KW:
    s_barrier
    v_add_u32 v238, s43, v238
    s_add_u32 m0, s43, 0
    s_nop 0
    buffer_load_dwordx4 v240, s[20:23], s32 offen sc1 lds
    s_add_u32 m0, s43, 8192
    s_nop 0
    buffer_load_dwordx4 v240, s[20:23], s33 offen sc1 lds
    s_barrier
    s_add_u32 m0, s43, 16384
    s_nop 0
    buffer_load_dwordx4 v240, s[20:23], s34 offen sc1 lds
    s_add_u32 m0, s43, 24576
    s_nop 0
    buffer_load_dwordx4 v240, s[20:23], s35 offen sc1 lds
    s_add_u32 m0, s43, 32768
    s_nop 0
    buffer_load_dwordx4 v240, s[20:23], s36 offen sc1 lds
    s_add_u32 m0, s43, 40960
    s_nop 0
    buffer_load_dwordx4 v240, s[20:23], s37 offen sc1 lds
    s_add_u32 m0, s43, 49152
    s_nop 0
    buffer_load_dwordx4 v240, s[20:23], s38 offen sc1 lds
    s_add_u32 m0, s43, 57344
    s_nop 0
    buffer_load_dwordx4 v240, s[20:23], s39 offen sc1 lds
    s_waitcnt vmcnt(7)
    ds_read_b128 v[192:195], v238 offset:0
    s_waitcnt lgkmcnt(0)
    v_cmp_u_f32 vcc, v192, v194
    s_cbranch_vccnz H2_XR0
H2_XK0:
    s_barrier
    ds_read_b64_tr_b16 v[32:33], v4 offset:0
    ds_read_b64_tr_b16 v[34:35], v4 offset:4096
    ds_read_b64_tr_b16 v[36:37], v5 offset:256
    ds_read_b64_tr_b16 v[38:39], v5 offset:4352
    ds_read_b64_tr_b16 v[40:41], v6 offset:0
    ds_read_b64_tr_b16 v[42:43], v6 offset:4096
    ds_read_b64_tr_b16 v[44:45], v7 offset:256
    ds_read_b64_tr_b16 v[46:47], v7 offset:4352
    s_waitcnt vmcnt(6)
    ds_read_b128 v[196:199], v238 offset:8192
    s_waitcnt vmcnt(5)
    ds_read_b128 v[200:203], v238 offset:16384
    s_waitcnt lgkmcnt(0)
    v_mfma_f32_16x16x32_bf16 v[16:19], v[32:35], v[64:67], 0
    v_max3_u32 v196, v196, v198, v200
    v_cmp_u_f32 vcc, v196, v202
    s_cbranch_vccnz H2_XR1
H2_XK1:
    s_barrier
    ds_read_b64_tr_b16 v[48:49], v4 offset:8192
    ds_read_b64_tr_b16 v[50:51], v4 offset:12288
    v_mfma_f32_16x16x32_bf16 v[12:15], v[36:39], v[36:39], 0
    ds_read_b64_tr_b16 v[52:53], v5 offset:8448
    ds_read_b64_tr_b16 v[54:55], v5 offset:12544
    v_mfma_f32_16x16x32_bf16 v[20:23], v[36:39], v[68:71], 0
    ds_read_b64_tr_b16 v[56:57], v6 offset:8192
    ds_read_b64_tr_b16 v[58:59], v6 offset:12288
    s_cmp_eq_u32 s18, 0
    s_cbranch_scc1 H2_N0
H2_M0:
    v_mfma_f32_16x16x32_bf16 v[12:15], v[32:35], v[32:35], v[12:15]
    ds_read_b64_tr_b16 v[60:61], v7 offset:8448
    ds_read_b64_tr_b16 v[62:63], v7 offset:12544
    v_mfma_f32_16x16x32_bf16 v[24:27], v[40:43], v[64:67], 0
    s_waitcnt vmcnt(4)
    ds_read_b128 v[204:207], v238 offset:24576
    v_mfma_f32_16x16x32_bf16 v[28:31], v[44:47], v[68:71], 0
    s_cmp_eq_u32 s31, 2
    s_cbranch_scc1 H2_KS1
TP4:
    s_cbranch_execz TR4
    s_cmp_eq_u32 s31, 1
    s_cbranch_scc1 H2_V0
    v_mfma_f32_16x16x32_bf16 v[232:235], v[128:131], v[32:35], 0
    v_mfma_f32_16x16x32_bf16 v[232:235], v[132:135], v[36:39], v[232:235]
    s_branch H2_KS1
H2_V0:
    v_mfma_f32_16x16x32_bf16 v[232:235], v[32:35], v[128:131], 0
    v_mfma_f32_16x16x32_bf16 v[232:235], v[36:39], v[132:135], v[232:235]
H2_KS1:
    s_waitcnt vmcnt(3)
    ds_read_b128 v[208:211], v238 offset:32768
    s_waitcnt lgkmcnt(0)
    v_mfma_f32_16x16x32_bf16 v[16:19], v[48:51], v[72:75], v[16:19]
    v_max3_u32 v204, v204, v206, v208
    v_cmp_u_f32 vcc, v204, v210
    s_cbranch_vccnz H2_XR3
H2_XK3:
    ds_read_b64_tr_b16 v[32:33], v4 offset:16384
    ds_read_b64_tr_b16 v[34:35], v4 offset:20480
    v_mfma_f32_16x16x32_bf16 v[12:15], v[52:55], v[52:55], v[12:15]
    ds_read_b64_tr_b16 v[36:37], v5 offset:16640
    ds_read_b64_tr_b16 v[38:39], v5 offset:20736
    v_mfma_f32_16x16x32_bf16 v[20:23], v[52:55], v[76:79], v[20:23]
    ds_read_b64_tr_b16 v[40:41], v6 offset:16384
    ds_read_b64_tr_b16 v[42:43], v6 offset:20480
    s_cmp_eq_u32 s18, 1
    s_cbranch_scc1 H2_N1
H2_M1:
    v_mfma_f32_16x16x32_bf16 v[12:15], v[48:51], v[48:51], v[12:15]
    ds_read_b64_tr_b16 v[44:45], v7 offset:16640
    ds_read_b64_tr_b16 v[46:47], v7 offset:20736
    v_mfma_f32_16x16x32_bf16 v[24:27], v[56:59], v[72:75], v[24:27]
    s_waitcnt vmcnt(2)
    ds_read_b128 v[212:215], v238 offset:40960
    v_mfma_f32_16x16x32_bf16 v[28:31], v[60:63], v[76:79], v[28:31]
    s_cmp_eq_u32 s31, 2
    s_cbranch_scc1 H2_KS2
    s_cmp_eq_u32 s31, 1
    s_cbranch_scc1 H2_V1
    v_mfma_f32_16x16x32_bf16 v[232:235], v[136:139], v[48:51], v[232:235]
    v_mfma_f32_16x16x32_bf16 v[232:235], v[140:143], v[52:55], v[232:235]
    s_branch H2_KS2
H2_V1:
    v_mfma_f32_16x16x32_bf16 v[232:235], v[48:51], v[136:139], v[232:235]
    v_mfma_f32_16x16x32_bf16 v[232:235], v[52:55], v[140:143], v[232:235]
H2_KS2:
    s_waitcnt vmcnt(1)
    ds_read_b128 v[216:219], v238 offset:49152
    s_waitcnt vmcnt(0)
    ds_read_b128 v[220:223], v238 offset:57344
    s_waitcnt lgkmcnt(0)
    v_mfma_f32_16x16x32_bf16 v[16:19], v[32:35], v[80:83], v[16:19]
    v_max3_u32 v212, v212, v214, v216
    v_max3_u32 v212, v212, v218, v220
    v_cmp_u_f32 vcc, v212, v222
    s_cbranch_vccnz H2_XR5
H2_XK5:
    s_barrier
    ds_read_b64_tr_b16 v[48:49], v4 offset:24576
    ds_read_b64_tr_b16 v[50:51], v4 offset:28672
    v_mfma_f32_16x16x32_bf16 v[12:15], v[36:39], v[36:39], v[12:15]
    ds_read_b64_tr_b16 v[52:53], v5 offset:24832
    ds_read_b64_tr_b16 v[54:55], v5 offset:28928
    v_mfma_f32_16x16x32_bf16 v[20:23], v[36:39], v[84:87], v[20:23]
    ds_read_b64_tr_b16 v[56:57], v6 offset:24576
    ds_read_b64_tr_b16 v[58:59], v6 offset:28672
    s_cmp_eq_u32 s18, 2
    s_cbranch_scc1 H2_N2
H2_M2:
    v_mfma_f32_16x16x32_bf16 v[12:15], v[32:35], v[32:35], v[12:15]
    ds_read_b64_tr_b16 v[60:61], v7 offset:24832
    ds_read_b64_tr_b16 v[62:63], v7 offset:28928
    v_mfma_f32_16x16x32_bf16 v[24:27], v[40:43], v[80:83], v[24:27]
    v_mfma_f32_16x16x32_bf16 v[28:31], v[44:47], v[84:87], v[28:31]
    s_cmp_eq_u32 s31, 2
    s_cbranch_scc1 H2_KS3
    s_cmp_eq_u32 s31, 1
    s_cbranch_scc1 H2_V2
    v_mfma_f32_16x16x32_bf16 v[232:235], v[144:147], v[32:35], v[232:235]
    v_mfma_f32_16x16x32_bf16 v[232:235], v[148:151], v[36:39], v[232:235]
    s_branch H2_KS3
H2_V2:
    v_mfma_f32_16x16x32_bf16 v[232:235], v[32:35], v[144:147], v[232:235]
    v_mfma_f32_16x16x32_bf16 v[232:235], v[36:39], v[148:151], v[232:235]
H2_KS3:
    s_waitcnt lgkmcnt(0)
    v_mfma_f32_16x16x32_bf16 v[16:19], v[48:51], v[88:91], v[16:19]
    ds_read_b64_tr_b16 v[32:33], v4 offset:32768
    ds_read_b64_tr_b16 v[34:35], v4 offset:36864
    v_mfma_f32_16x16x32_bf16 v[12:15], v[52:55], v[52:55], v[12:15]
    ds_read_b64_tr_b16 v[36:37], v5 offset:33024
    ds_read_b64_tr_b16 v[38:39], v5 offset:37120
    v_mfma_f32_16x16x32_bf16 v[20:23], v[52:55], v[92:95], v[20:23]
    ds_read_b64_tr_b16 v[40:41], v6 offset:32768
    ds_read_b64_tr_b16 v[42:43], v6 offset:36864
    s_cmp_eq_u32 s18, 3
    s_cbranch_scc1 H2_N3
H2_M3:
    v_mfma_f32_16x16x32_bf16 v[12:15], v[48:51], v[48:51], v[12:15]
    ds_read_b64_tr_b16 v[44:45], v7 offset:33024
    ds_read_b64_tr_b16 v[46:47], v7 offset:37120
    v_mfma_f32_16x16x32_bf16 v[24:27], v[56:59], v[88:91], v[24:27]
    v_mfma_f32_16x16x32_bf16 v[28:31], v[60:63], v[92:95], v[28:31]
    s_cmp_eq_u32 s31, 2
    s_cbranch_scc1 H2_KS4
    s_cmp_eq_u32 s31, 1
    s_cbranch_scc1 H2_V3
    v_mfma_f32_16x16x32_bf16 v[232:235], v[152:155], v[48:51], v[232:235]
    v_mfma_f32_16x16x32_bf16 v[232:235], v[156:159], v[52:55], v[232:235]
    s_branch H2_KS4
H2_V3:
    v_mfma_f32_16x16x32_bf16 v[232:235], v[48:51], v[152:155], v[232:235]
    v_mfma_f32_16x16x32_bf16 v[232:235], v[52:55], v[156:159], v[232:235]
H2_KS4:
    s_waitcnt lgkmcnt(0)
    v_mfma_f32_16x16x32_bf16 v[16:19], v[32:35], v[96:99], v[16:19]
    ds_read_b64_tr_b16 v[48:49], v4 offset:40960
    ds_read_b64_tr_b16 v[50:51], v4 offset:45056
    v_mfma_f32_16x16x32_bf16 v[12:15], v[36:39], v[36:39], v[12:15]
    ds_read_b64_tr_b16 v[52:53], v5 offset:41216
    ds_read_b64_tr_b16 v[54:55], v5 offset:45312
    v_mfma_f32_16x16x32_bf16 v[20:23], v[36:39], v[100:103], v[20:23]
    ds_read_b64_tr_b16 v[56:57], v6 offset:40960
    ds_read_b64_tr_b16 v[58:59], v6 offset:45056
    s_cmp_eq_u32 s18, 4
    s_cbranch_scc1 H2_N4
H2_M4:
    v_mfma_f32_16x16x32_bf16 v[12:15], v[32:35], v[32:35], v[12:15]
    ds_read_b64_tr_b16 v[60:61], v7 offset:41216
    ds_read_b64_tr_b16 v[62:63], v7 offset:45312
    v_mfma_f32_16x16x32_bf16 v[24:27], v[40:43], v[96:99], v[24:27]
    v_mfma_f32_16x16x32_bf16 v[28:31], v[44:47], v[100:103], v[28:31]
    s_cmp_eq_u32 s31, 2
    s_cbranch_scc1 H2_KS5
    s_cmp_eq_u32 s31, 1
    s_cbranch_scc1 H2_V4
    v_mfma_f32_16x16x32_bf16 v[232:235], v[160:163], v[32:35], v[232:235]
    v_mfma_f32_16x16x32_bf16 v[232:235], v[164:167], v[36:39], v[232:235]
    s_branch H2_KS5
H2_V4:
    v_mfma_f32_16x16x32_bf16 v[232:235], v[32:35], v[160:163], v[232:235]
    v_mfma_f32_16x16x32_bf16 v[232:235], v[36:39], v[164:167], v[232:235]
H2_KS5:
    s_waitcnt lgkmcnt(0)
    v_mfma_f32_16x16x32_bf16 v[16:19], v[48:51], v[104:107], v[16:19]
    ds_read_b64_tr_b16 v[32:33], v4 offset:49152
    ds_read_b64_tr_b16 v[34:35], v4 offset:53248
    v_mfma_f32_16x16x32_bf16 v[12:15], v[52:55], v[52:55], v[12:15]
    ds_read_b64_tr_b16 v[36:37], v5 offset:49408
    ds_read_b64_tr_b16 v[38:39], v5 offset:53504
    v_mfma_f32_16x16x32_bf16 v[20:23], v[52:55], v[108:111], v[20:23]
    ds_read_b64_tr_b16 v[40:41], v6 offset:49152
    ds_read_b64_tr_b16 v[42:43], v6 offset:53248
    s_cmp_eq_u32 s18, 5
    s_cbranch_scc1 H2_N5
H2_M5:
    v_mfma_f32_16x16x32_bf16 v[12:15], v[48:51], v[48:51], v[12:15]
    ds_read_b64_tr_b16 v[44:45], v7 offset:49408
    ds_read_b64_tr_b16 v[46:47], v7 offset:53504
    v_mfma_f32_16x16x32_bf16 v[24:27], v[56:59], v[104:107], v[24:27]
    v_mfma_f32_16x16x32_bf16 v[28:31], v[60:63], v[108:111], v[28:31]
    s_cmp_eq_u32 s31, 2
    s_cbranch_scc1 H2_KS6
    s_cmp_eq_u32 s31, 1
    s_cbranch_scc1 H2_V5
    v_mfma_f32_16x16x32_bf16 v[232:235], v[168:171], v[48:51], v[232:235]
    v_mfma_f32_16x16x32_bf16 v[232:235], v[172:175], v[52:55], v[232:235]
    s_branch H2_KS6
H2_V5:
    v_mfma_f32_16x16x32_bf16 v[232:235], v[48:51], v[168:171], v[232:235]
    v_mfma_f32_16x16x32_bf16 v[232:235], v[52:55], v[172:175], v[232:235]
H2_KS6:
    s_waitcnt lgkmcnt(0)
    v_mfma_f32_16x16x32_bf16 v[16:19], v[32:35], v[112:115], v[16:19]
    ds_read_b64_tr_b16 v[48:49], v4 offset:57344
    ds_read_b64_tr_b16 v[50:51], v4 offset:61440
    v_mfma_f32_16x16x32_bf16 v[12:15], v[36:39], v[36:39], v[12:15]
    ds_read_b64_tr_b16 v[52:53], v5 offset:57600
    ds_read_b64_tr_b16 v[54:55], v5 offset:61696
    v_mfma_f32_16x16x32_bf16 v[20:23], v[36:39], v[116:119], v[20:23]
    ds_read_b64_tr_b16 v[56:57], v6 offset:57344
    ds_read_b64_tr_b16 v[58:59], v6 offset:61440
    s_cmp_eq_u32 s18, 6
    s_cbranch_scc1 H2_N6
H2_M6:
    v_mfma_f32_16x16x32_bf16 v[12:15], v[32:35], v[32:35], v[12:15]
    ds_read_b64_tr_b16 v[60:61], v7 offset:57600
    ds_read_b64_tr_b16 v[62:63], v7 offset:61696
    v_mfma_f32_16x16x32_bf16 v[24:27], v[40:43], v[112:115], v[24:27]
    v_mfma_f32_16x16x32_bf16 v[28:31], v[44:47], v[116:119], v[28:31]
    s_cmp_eq_u32 s31, 2
    s_cbranch_scc1 H2_KS7
    s_cmp_eq_u32 s31, 1
    s_cbranch_scc1 H2_V6
    v_mfma_f32_16x16x32_bf16 v[232:235], v[176:179], v[32:35], v[232:235]
    v_mfma_f32_16x16x32_bf16 v[232:235], v[180:183], v[36:39], v[232:235]
    s_branch H2_KS7
H2_V6:
    v_mfma_f32_16x16x32_bf16 v[232:235], v[32:35], v[176:179], v[232:235]
    v_mfma_f32_16x16x32_bf16 v[232:235], v[36:39], v[180:183], v[232:235]
H2_KS7:
    s_waitcnt lgkmcnt(0)
    v_mfma_f32_16x16x32_bf16 v[16:19], v[48:51], v[120:123], v[16:19]
    v_mfma_f32_16x16x32_bf16 v[12:15], v[52:55], v[52:55], v[12:15]
    v_mfma_f32_16x16x32_bf16 v[20:23], v[52:55], v[124:127], v[20:23]
    s_cmp_eq_u32 s18, 7
    s_cbranch_scc1 H2_N7
H2_M7:
    v_mfma_f32_16x16x32_bf16 v[12:15], v[48:51], v[48:51], v[12:15]
    v_mfma_f32_16x16x32_bf16 v[24:27], v[56:59], v[120:123], v[24:27]
    v_mfma_f32_16x16x32_bf16 v[28:31], v[60:63], v[124:127], v[28:31]
    s_nop 5
    v_cndmask_b32 v12, v12, v13, s[12:13]
    v_cndmask_b32 v14, v14, v15, s[12:13]
    v_cndmask_b32 v12, v12, v14, s[14:15]
    v_fmamk_f32 v12, v12, 0x3b000000, v11
    v_rsq_f32 v12, v12
    s_mov_b64 exec, s[16:17]
    ds_write_b32 v8, v12
    s_mov_b64 exec, -1
    s_cmp_eq_u32 s31, 2
    s_cbranch_scc1 H2_KS8
    s_cmp_eq_u32 s31, 1
    s_cbranch_scc1 H2_V7
    v_mfma_f32_16x16x32_bf16 v[232:235], v[184:187], v[48:51], v[232:235]
    v_mfma_f32_16x16x32_bf16 v[232:235], v[188:191], v[52:55], v[232:235]
    s_branch H2_KS8
H2_V7:
    v_mfma_f32_16x16x32_bf16 v[232:235], v[48:51], v[184:187], v[232:235]
    v_mfma_f32_16x16x32_bf16 v[232:235], v[52:55], v[188:191], v[232:235]
H2_KS8:
    s_waitcnt lgkmcnt(0)
    s_barrier
    s_cmp_eq_u32 s31, 2
    s_cbranch_scc1 H2_KS9
    v_lshl_add_u32 v226, v3, 4, s8
    ds_read_b128 v[228:231], v226
    v_lshl_add_u32 v226, v2, 2, s8
    s_cmp_eq_u32 s31, 1
    s_cbranch_scc1 H2_KV1
    ds_read_b32 v228, v226
    ds_read_b32 v229, v226
    ds_read_b32 v230, v226
    ds_read_b32 v231, v226
H2_KV1:
    s_waitcnt lgkmcnt(0)
    v_pk_mul_f32 v[232:233], v[232:233], v[228:229]
    v_pk_mul_f32 v[234:235], v[234:235], v[230:231]
    v_cvt_pk_bf16_f32 v232, v232, v233
    v_cvt_pk_bf16_f32 v233, v234, v235
    buffer_store_dwordx2 v[232:233], v227, s[20:23], s9 offen sc1
H2_KS9:
    v_pk_add_f32 v[32:33], v[16:17], v[20:21]
    v_pk_add_f32 v[34:35], v[18:19], v[22:23]
    v_cvt_pk_bf16_f32 v32, v32, v33
    v_cvt_pk_bf16_f32 v33, v34, v35
    buffer_store_dwordx2 v[32:33], v9, s[20:23], s10 offen sc1
    v_pk_add_f32 v[36:37], v[16:17], v[20:21] neg_lo:[0,1] neg_hi:[0,1]
    v_pk_add_f32 v[38:39], v[18:19], v[22:23] neg_lo:[0,1] neg_hi:[0,1]
    v_cvt_pk_bf16_f32 v36, v36, v37
    v_cvt_pk_bf16_f32 v37, v38, v39
    buffer_store_dwordx2 v[36:37], v9, s[20:23], s28 offen sc1
    v_pk_add_f32 v[40:41], v[24:25], v[28:29]
    v_pk_add_f32 v[42:43], v[26:27], v[30:31]
    v_cvt_pk_bf16_f32 v40, v40, v41
    v_cvt_pk_bf16_f32 v41, v42, v43
    buffer_store_dwordx2 v[40:41], v9, s[20:23], s11 offen sc1
    v_pk_add_f32 v[44:45], v[24:25], v[28:29] neg_lo:[0,1] neg_hi:[0,1]
    v_pk_add_f32 v[46:47], v[26:27], v[30:31] neg_lo:[0,1] neg_hi:[0,1]
    v_cvt_pk_bf16_f32 v44, v44, v45
    v_cvt_pk_bf16_f32 v45, v46, v47
    buffer_store_dwordx2 v[44:45], v9, s[20:23], s29 offen sc1
A2_GO:
    s_setprio 3
TP6:
    s_cbranch_execz TR6
    s_load_dwordx2 s[16:17], s[0:1], 64
    v_mov_b32 v160, 0
    v_mov_b32 v161, 0
    v_mov_b32 v162, 0
    v_mov_b32 v163, 0
    v_lshlrev_b32 v1, 4, v0
    v_mov_b32 v11, 0
    v_mfma_f32_32x32x16_bf16 v[144:159], v[160:163], v[160:163], 0
    ds_write_b64 v11, v[160:161] offset:60416
    v_and_b32 v14, 59, v0
    v_cmp_eq_u32 vcc, 16, v14
    v_mov_b32 v15, 0xbf80bf80
    v_mov_b32 v220, 0xbafebf80
    v_mov_b32 v221, v220
    v_cndmask_b32 v224, 0, v15, vcc
    v_mov_b32 v222, v220
    v_mov_b32 v223, v220
    v_mov_b32 v225, 0
    v_mov_b32 v226, 0
    v_mov_b32 v227, 0
    s_and_b32 s24, s2, 7
    s_lshl_b32 s24, s24, 5
    v_mfma_f32_32x32x16_bf16 v[48:63], v[220:223], v[224:227], 0
    s_lshr_b32 s25, s2, 3
    s_add_u32 s4, s24, s25
    s_lshl_b32 s24, s4, 13
    s_add_u32 s5, s24, 0x1480000
    s_lshl_b32 s25, s3, 13
    s_add_u32 s6, s25, 0x1d00000
    s_add_u32 s8, s6, 0x10000
    s_mov_b32 s22, 0x1d22000
    s_mov_b32 s23, 0x20000
    s_add_u32 s7, s6, 4096
    s_add_u32 s9, s8, 4096
    s_add_u32 s10, s25, 0xc80000
    s_add_u32 s11, s10, 4096
    s_lshl_b32 s25, s3, 10
    s_mov_b32 m0, s25
    v_mfma_f32_32x32x16_bf16 v[240:255], v[160:163], v[160:163], 0
    s_add_u32 s14, s5, s25
    v_add_u32 v14, s25, v1
    ds_write_b128 v14, v[220:223] offset:49152
    s_mov_b32 s32, 0xffff
    s_mov_b32 s33, 0xffff
    v_mov_b32 v164, 0x4444dddd
    v_and_b32 v2, 15, v0
    v_lshrrev_b32 v3, 4, v0
    v_mfma_f32_32x32x16_bf16 v[64:79], v[220:223], v[224:227], 0
    s_add_u32 s30, s10, 0x70000
    s_add_u32 s31, s10, 0x71000
    s_add_u32 s15, s14, 0xff200000
    s_waitcnt lgkmcnt(0)
    v_lshlrev_b32 v9, 3, v0
    v_and_b32 v12, 31, v0
    v_lshrrev_b32 v13, 5, v0
    s_mul_i32 s24, s3, 2560
    v_mul_u32_u24 v4, 80, v12
    v_add_u32 v4, s24, v4
    s_mul_i32 s24, s3, 36
    v_xor_b32 v5, s24, v12
    v_lshlrev_b32 v5, 2, v5
    v_lshl_add_u32 v4, v13, 4, v4
    s_lshl_b32 s24, s3, 2
    v_add_u32 v14, s24, v3
    v_mfma_f32_32x32x16_bf16 v[80:95], v[220:223], v[224:227], 0
    v_and_b32 v15, 7, v0
    v_mul_u32_u24 v239, 36, v15
    v_xor_b32 v239, v239, v14
    v_lshlrev_b32 v239, 2, v239
    v_mul_u32_u24 v14, 80, v14
    v_lshl_add_u32 v6, v2, 2, v14
    v_add_u32 v6, 8192, v6
    v_mul_u32_u24 v237, 160, v15
    v_lshl_add_u32 v237, v3, 5, v237
    v_mfma_f32_32x32x16_bf16 v[96:111], v[220:223], v[224:227], 0
    v_and_b32 v14, 8, v0
    v_lshl_add_u32 v237, v14, 1, v237
    v_mul_u32_u24 v14, 0x1555, v14
    v_lshl_or_b32 v164, v14, 16, v164
    v_lshl_or_b32 v164, v14, 14, v164
    s_and_b32 s24, s3, 1
    s_mul_i32 s24, s24, 640
    s_lshr_b32 s25, s3, 1
    s_lshl_b32 s25, s25, 5
    s_add_u32 s24, s24, s25
    v_mfma_f32_32x32x16_bf16 v[204:219], v[160:163], v[160:163], 0
    v_mul_u32_u24 v236, 160, v3
    v_and_b32 v14, 12, v0
    v_add_u32 v236, v14, v236
    v_and_b32 v14, 2, v0
    v_lshl_add_u32 v236, v14, 3, v236
    v_and_b32 v14, 1, v0
    v_lshl_add_u32 v236, v14, 1, v236
    v_add_u32 v236, s24, v236
    v_mov_b32 v238, 0
    s_lshl_b32 s25, s3, 10
    v_add_u32 v8, s25, v1
    s_waitcnt vmcnt(0) lgkmcnt(0)
    s_barrier
    buffer_load_dwordx4 v[168:171], v1, s[20:23], s5 offen sc1
    buffer_load_dwordx4 v[16:19], v1, s[20:23], s6 offen offset:0 sc1
    s_barrier
    buffer_load_dwordx4 v[228:231], v1, s[20:23], s5 offen offset:1024 sc1
    s_mov_b64 exec, s[32:33]
    buffer_load_dwordx4 v[48:51], v1, s[20:23], s8 offen offset:0 sc1
    buffer_load_dwordx4 v[52:55], v1, s[20:23], s8 offen offset:256 sc1
    s_mov_b64 exec, -1
    buffer_load_dwordx4 v[20:23], v1, s[20:23], s6 offen offset:1024 sc1
    s_setprio 3
    s_waitcnt vmcnt(4)
    v_cmp_u_f32 vcc, v168, v170
    s_cbranch_vccnz A2_CKq0_R
    v_cmp_u_f32 vcc, v16, v18
    s_cbranch_vccnz A2_CKq0_R
A2_CKq0_K:
    v_mfma_f32_32x32x16_bf16 v[112:127], v[16:19], v[168:171], 0
    s_nop 7
    s_nop 3
    v_exp_f32 v112, v112
    s_mov_b64 exec, s[32:33]
    buffer_load_dwordx4 v[56:59], v1, s[20:23], s8 offen offset:1024 sc1
    buffer_load_dwordx4 v[60:63], v1, s[20:23], s8 offen offset:1280 sc1
    s_mov_b64 exec, -1
    v_exp_f32 v113, v113
    v_exp_f32 v114, v114
    v_exp_f32 v115, v115
    s_waitcnt vmcnt(5)
    v_cmp_u_f32 vcc, v228, v230
    s_cbranch_vccnz A2_CKq1_R
A2_CKq1_K:
    v_mfma_f32_32x32x16_bf16 v[128:143], v[16:19], v[228:231], 0
    v_exp_f32 v116, v116
    v_exp_f32 v117, v117
    v_exp_f32 v118, v118
    v_exp_f32 v119, v119
    v_exp_f32 v120, v120
    buffer_load_dwordx4 v[24:27], v1, s[20:23], s6 offen offset:2048 sc1
    v_exp_f32 v121, v121
    s_waitcnt vmcnt(4)
    v_cmp_u_f32 vcc, v48, v50
    s_cbranch_vccnz A2_CKv0_R
    v_cmp_u_f32 vcc, v52, v54
    s_cbranch_vccnz A2_CKv0_R
A2_CKv0_K:
    v_smfmac_f32_32x32x32_bf16 v[144:159], v[48:51], v[112:119], v164
    v_exp_f32 v122, v122
    v_exp_f32 v123, v123
    v_exp_f32 v124, v124
    v_exp_f32 v125, v125
    v_exp_f32 v126, v126
    v_exp_f32 v127, v127
    v_exp_f32 v128, v128
    s_mov_b64 exec, s[32:33]
    buffer_load_dwordx4 v[64:67], v1, s[20:23], s8 offen offset:2048 sc1
    buffer_load_dwordx4 v[68:71], v1, s[20:23], s8 offen offset:2304 sc1
    s_mov_b64 exec, -1
    v_exp_f32 v129, v129
    v_smfmac_f32_32x32x32_bf16 v[144:159], v[52:55], v[120:127], v164
    v_exp_f32 v130, v130
    v_exp_f32 v131, v131
    s_waitcnt vmcnt(5)
    v_cmp_u_f32 vcc, v20, v22
    s_cbranch_vccnz A2_CKk1_R
A2_CKk1_K:
    v_mfma_f32_32x32x16_bf16 v[112:127], v[20:23], v[168:171], 0
    v_exp_f32 v132, v132
    v_exp_f32 v133, v133
    v_exp_f32 v134, v134
    v_exp_f32 v135, v135
    v_exp_f32 v136, v136
    v_exp_f32 v137, v137
    v_smfmac_f32_32x32x32_bf16 v[240:255], v[48:51], v[128:135], v164
    v_exp_f32 v138, v138
    v_exp_f32 v139, v139
    v_exp_f32 v140, v140
    v_exp_f32 v141, v141
    v_exp_f32 v142, v142
    v_exp_f32 v143, v143
    v_exp_f32 v112, v112
    buffer_load_dwordx4 v[28:31], v1, s[20:23], s6 offen offset:3072 sc1
    v_exp_f32 v113, v113
    v_smfmac_f32_32x32x32_bf16 v[240:255], v[52:55], v[136:143], v164
    v_exp_f32 v114, v114
    v_exp_f32 v115, v115
    v_mfma_f32_32x32x16_bf16 v[128:143], v[20:23], v[228:231], 0
    v_exp_f32 v116, v116
    v_exp_f32 v117, v117
    v_exp_f32 v118, v118
    v_exp_f32 v119, v119
    v_exp_f32 v120, v120
    s_mov_b64 exec, s[32:33]
    buffer_load_dwordx4 v[72:75], v1, s[20:23], s8 offen offset:3072 sc1
    buffer_load_dwordx4 v[76:79], v1, s[20:23], s8 offen offset:3328 sc1
    s_mov_b64 exec, -1
    v_exp_f32 v121, v121
    s_waitcnt vmcnt(6)
    v_cmp_u_f32 vcc, v56, v58
    s_cbranch_vccnz A2_CKv1_R
    v_cmp_u_f32 vcc, v60, v62
    s_cbranch_vccnz A2_CKv1_R
A2_CKv1_K:
    v_smfmac_f32_32x32x32_bf16 v[144:159], v[56:59], v[112:119], v164
    v_exp_f32 v122, v122
    v_exp_f32 v123, v123
    v_exp_f32 v124, v124
    v_exp_f32 v125, v125
    v_exp_f32 v126, v126
    v_exp_f32 v127, v127
    v_exp_f32 v128, v128
    buffer_load_dwordx4 v[32:35], v1, s[20:23], s7 offen offset:0 sc1
    v_exp_f32 v129, v129
    v_smfmac_f32_32x32x32_bf16 v[144:159], v[60:63], v[120:127], v164
    v_exp_f32 v130, v130
    v_exp_f32 v131, v131
    s_waitcnt vmcnt(6)
    v_cmp_u_f32 vcc, v24, v26
    s_cbranch_vccnz A2_CKk2_R
A2_CKk2_K:
    v_mfma_f32_32x32x16_bf16 v[112:127], v[24:27], v[168:171], 0
    v_exp_f32 v132, v132
    v_exp_f32 v133, v133
    v_exp_f32 v134, v134
    v_exp_f32 v135, v135
    v_exp_f32 v136, v136
    s_setprio 2
    v_exp_f32 v137, v137
    v_smfmac_f32_32x32x32_bf16 v[240:255], v[56:59], v[128:135], v164
    v_exp_f32 v138, v138
    v_exp_f32 v139, v139
    v_exp_f32 v140, v140
    v_exp_f32 v141, v141
    v_exp_f32 v142, v142
    v_exp_f32 v143, v143
    v_exp_f32 v112, v112
    s_mov_b64 exec, s[32:33]
    buffer_load_dwordx4 v[80:83], v1, s[20:23], s9 offen offset:0 sc1
    buffer_load_dwordx4 v[84:87], v1, s[20:23], s9 offen offset:256 sc1
    s_mov_b64 exec, -1
    v_exp_f32 v113, v113
    v_smfmac_f32_32x32x32_bf16 v[240:255], v[60:63], v[136:143], v164
    v_exp_f32 v114, v114
    v_exp_f32 v115, v115
    v_mfma_f32_32x32x16_bf16 v[128:143], v[24:27], v[228:231], 0
    v_exp_f32 v116, v116
    v_exp_f32 v117, v117
    v_exp_f32 v118, v118
    v_exp_f32 v119, v119
    v_exp_f32 v120, v120
    buffer_load_dwordx4 v[36:39], v1, s[20:23], s7 offen offset:1024 sc1
    v_exp_f32 v121, v121
    s_waitcnt vmcnt(7)
    v_cmp_u_f32 vcc, v64, v66
    s_cbranch_vccnz A2_CKv2_R
    v_cmp_u_f32 vcc, v68, v70
    s_cbranch_vccnz A2_CKv2_R
A2_CKv2_K:
    v_smfmac_f32_32x32x32_bf16 v[144:159], v[64:67], v[112:119], v164
    v_exp_f32 v122, v122
    v_exp_f32 v123, v123
    v_exp_f32 v124, v124
    v_exp_f32 v125, v125
    s_setprio 1
    v_exp_f32 v126, v126
    v_exp_f32 v127, v127
    v_exp_f32 v128, v128
    s_mov_b64 exec, s[32:33]
    buffer_load_dwordx4 v[88:91], v1, s[20:23], s9 offen offset:1024 sc1
    buffer_load_dwordx4 v[92:95], v1, s[20:23], s9 offen offset:1280 sc1
    s_mov_b64 exec, -1
    v_exp_f32 v129, v129
    v_smfmac_f32_32x32x32_bf16 v[144:159], v[68:71], v[120:127], v164
    v_exp_f32 v130, v130
    v_exp_f32 v131, v131
    s_waitcnt vmcnt(8)
    v_cmp_u_f32 vcc, v28, v30
    s_cbranch_vccnz A2_CKk3_R
A2_CKk3_K:
    v_mfma_f32_32x32x16_bf16 v[112:127], v[28:31], v[168:171], 0
    v_exp_f32 v132, v132
    v_exp_f32 v133, v133
    v_exp_f32 v134, v134
    v_exp_f32 v135, v135
    v_exp_f32 v136, v136
    v_exp_f32 v137, v137
    v_smfmac_f32_32x32x32_bf16 v[240:255], v[64:67], v[128:135], v164
    s_setprio 0
    v_exp_f32 v138, v138
    v_exp_f32 v139, v139
    v_exp_f32 v140, v140
    v_exp_f32 v141, v141
    v_exp_f32 v142, v142
    v_exp_f32 v143, v143
    s_setprio 3
    v_exp_f32 v112, v112
    buffer_load_dwordx4 v[40:43], v1, s[20:23], s7 offen offset:2048 sc1
    v_exp_f32 v113, v113
    v_smfmac_f32_32x32x32_bf16 v[240:255], v[68:71], v[136:143], v164
    v_exp_f32 v114, v114
    v_exp_f32 v115, v115
    v_mfma_f32_32x32x16_bf16 v[128:143], v[28:31], v[228:231], 0
    v_exp_f32 v116, v116
    v_exp_f32 v117, v117
    v_exp_f32 v118, v118
    v_exp_f32 v119, v119
    v_exp_f32 v120, v120
    s_mov_b64 exec, s[32:33]
    buffer_load_dwordx4 v[96:99], v1, s[20:23], s9 offen offset:2048 sc1
    buffer_load_dwordx4 v[100:103], v1, s[20:23], s9 offen offset:2304 sc1
    s_mov_b64 exec, -1
    v_exp_f32 v121, v121
    s_waitcnt vmcnt(9)
    v_cmp_u_f32 vcc, v72, v74
    s_cbranch_vccnz A2_CKv3_R
    v_cmp_u_f32 vcc, v76, v78
    s_cbranch_vccnz A2_CKv3_R
A2_CKv3_K:
    v_smfmac_f32_32x32x32_bf16 v[144:159], v[72:75], v[112:119], v164
    v_exp_f32 v122, v122
    v_exp_f32 v123, v123
    v_exp_f32 v124, v124
    v_exp_f32 v125, v125
    v_exp_f32 v126, v126
    v_exp_f32 v127, v127
    v_exp_f32 v128, v128
    buffer_load_dwordx4 v[44:47], v1, s[20:23], s7 offen offset:3072 sc1
    v_exp_f32 v129, v129
    v_smfmac_f32_32x32x32_bf16 v[144:159], v[76:79], v[120:127], v164
    v_exp_f32 v130, v130
    v_exp_f32 v131, v131
    s_waitcnt vmcnt(9)
    v_cmp_u_f32 vcc, v32, v34
    s_cbranch_vccnz A2_CKk4_R
A2_CKk4_K:
    v_mfma_f32_32x32x16_bf16 v[112:127], v[32:35], v[168:171], 0
    v_exp_f32 v132, v132
    v_exp_f32 v133, v133
    v_exp_f32 v134, v134
    v_exp_f32 v135, v135
    v_exp_f32 v136, v136
    s_setprio 2
    s_mov_b64 exec, s[32:33]
    buffer_load_dwordx4 v[104:107], v1, s[20:23], s9 offen offset:3072 sc1
    buffer_load_dwordx4 v[108:111], v1, s[20:23], s9 offen offset:3328 sc1
    s_mov_b64 exec, -1
    v_exp_f32 v137, v137
    v_smfmac_f32_32x32x32_bf16 v[240:255], v[72:75], v[128:135], v164
    v_exp_f32 v138, v138
    v_exp_f32 v139, v139
    v_exp_f32 v140, v140
    v_exp_f32 v141, v141
    v_exp_f32 v142, v142
    v_exp_f32 v143, v143
    v_exp_f32 v112, v112
    buffer_load_dwordx4 v[220:223], v1, s[20:23], s14 offen sc1
    v_exp_f32 v113, v113
    v_smfmac_f32_32x32x32_bf16 v[240:255], v[76:79], v[136:143], v164
    v_exp_f32 v114, v114
    v_exp_f32 v115, v115
    s_waitcnt vmcnt(9)
    v_cmp_u_f32 vcc, v36, v38
    s_cbranch_vccnz A2_CKk5_R
A2_CKk5_K:
    v_mfma_f32_32x32x16_bf16 v[128:143], v[36:39], v[168:171], 0
    v_exp_f32 v116, v116
    v_exp_f32 v117, v117
    v_exp_f32 v118, v118
    v_exp_f32 v119, v119
    v_exp_f32 v120, v120
    v_exp_f32 v121, v121
    s_waitcnt vmcnt(10)
    v_cmp_u_f32 vcc, v80, v82
    s_cbranch_vccnz A2_CKv4_R
    v_cmp_u_f32 vcc, v84, v86
    s_cbranch_vccnz A2_CKv4_R
A2_CKv4_K:
    v_smfmac_f32_32x32x32_bf16 v[144:159], v[80:83], v[112:119], v164
    v_exp_f32 v122, v122
    v_exp_f32 v123, v123
    v_exp_f32 v124, v124
    v_exp_f32 v125, v125
    s_setprio 1
    v_exp_f32 v126, v126
    v_exp_f32 v127, v127
    v_exp_f32 v128, v128
    buffer_load_dwordx2 v[232:233], v9, s[20:23], s15 offen offset:0 sc1
    v_exp_f32 v129, v129
    v_smfmac_f32_32x32x32_bf16 v[144:159], v[84:87], v[120:127], v164
    v_exp_f32 v130, v130
    v_exp_f32 v131, v131
    s_waitcnt vmcnt(7)
    v_cmp_u_f32 vcc, v40, v42
    s_cbranch_vccnz A2_CKk6_R
A2_CKk6_K:
    v_mfma_f32_32x32x16_bf16 v[112:127], v[40:43], v[168:171], 0
    v_exp_f32 v132, v132
    v_exp_f32 v133, v133
    v_exp_f32 v134, v134
    v_exp_f32 v135, v135
    v_exp_f32 v136, v136
    buffer_load_dwordx2 v[234:235], v9, s[20:23], s15 offen offset:512 sc1
    v_exp_f32 v137, v137
    s_waitcnt vmcnt(9)
    v_cmp_u_f32 vcc, v88, v90
    s_cbranch_vccnz A2_CKv5_R
    v_cmp_u_f32 vcc, v92, v94
    s_cbranch_vccnz A2_CKv5_R
A2_CKv5_K:
    v_smfmac_f32_32x32x32_bf16 v[144:159], v[88:91], v[128:135], v164
    s_setprio 0
    v_exp_f32 v138, v138
    v_exp_f32 v139, v139
    v_exp_f32 v140, v140
    v_exp_f32 v141, v141
    v_exp_f32 v142, v142
    v_exp_f32 v143, v143
    s_setprio 3
    v_exp_f32 v112, v112
    buffer_load_dwordx4 v[172:175], v1, s[20:23], s10 offen offset:0
    v_exp_f32 v113, v113
    v_smfmac_f32_32x32x32_bf16 v[144:159], v[92:95], v[136:143], v164
    v_exp_f32 v114, v114
    v_exp_f32 v115, v115
    s_waitcnt vmcnt(6)
    v_cmp_u_f32 vcc, v44, v46
    s_cbranch_vccnz A2_CKk7_R
A2_CKk7_K:
    v_mfma_f32_32x32x16_bf16 v[128:143], v[44:47], v[168:171], 0
    v_exp_f32 v116, v116
    v_exp_f32 v117, v117
    v_exp_f32 v118, v118
    v_exp_f32 v119, v119
    v_exp_f32 v120, v120
    v_exp_f32 v121, v121
    s_waitcnt vmcnt(7)
    v_cmp_u_f32 vcc, v96, v98
    s_cbranch_vccnz A2_CKv6_R
    v_cmp_u_f32 vcc, v100, v102
    s_cbranch_vccnz A2_CKv6_R
A2_CKv6_K:
    v_smfmac_f32_32x32x32_bf16 v[144:159], v[96:99], v[112:119], v164
    v_exp_f32 v122, v122
    v_exp_f32 v123, v123
    v_exp_f32 v124, v124
    v_exp_f32 v125, v125
    v_exp_f32 v126, v126
    v_exp_f32 v127, v127
    v_exp_f32 v128, v128
    buffer_load_dwordx4 v[176:179], v1, s[20:23], s10 offen offset:1024
    v_exp_f32 v129, v129
    v_smfmac_f32_32x32x32_bf16 v[144:159], v[100:103], v[120:127], v164
    v_exp_f32 v130, v130
    v_exp_f32 v131, v131
    v_mfma_f32_32x32x16_bf16 v[112:127], v[32:35], v[228:231], 0
    v_exp_f32 v132, v132
    v_exp_f32 v133, v133
    v_exp_f32 v134, v134
    v_exp_f32 v135, v135
    v_exp_f32 v136, v136
    s_setprio 2
    v_exp_f32 v137, v137
    s_waitcnt vmcnt(5)
    v_cmp_u_f32 vcc, v104, v106
    s_cbranch_vccnz A2_CKv7_R
    v_cmp_u_f32 vcc, v108, v110
    s_cbranch_vccnz A2_CKv7_R
A2_CKv7_K:
    v_smfmac_f32_32x32x32_bf16 v[144:159], v[104:107], v[128:135], v164
    v_exp_f32 v138, v138
    v_exp_f32 v139, v139
    v_exp_f32 v140, v140
    v_exp_f32 v141, v141
    v_exp_f32 v142, v142
    v_exp_f32 v143, v143
    v_exp_f32 v112, v112
    v_exp_f32 v113, v113
    v_smfmac_f32_32x32x32_bf16 v[144:159], v[108:111], v[136:143], v164
    v_exp_f32 v114, v114
    v_exp_f32 v115, v115
    v_mfma_f32_32x32x16_bf16 v[128:143], v[36:39], v[228:231], 0
    v_exp_f32 v116, v116
    v_exp_f32 v117, v117
    v_exp_f32 v118, v118
    buffer_load_dwordx4 v[180:183], v1, s[20:23], s10 offen offset:2048
    v_exp_f32 v119, v119
    v_exp_f32 v120, v120
    v_exp_f32 v121, v121
    v_smfmac_f32_32x32x32_bf16 v[240:255], v[80:83], v[112:119], v164
    s_waitcnt vmcnt(5)
    v_cmp_u_f32 vcc, v220, v222
    s_cbranch_vccnz A2_CKqd_R
A2_CKqd_K:
    ds_write_b128 v8, v[220:223] offset:0
    v_exp_f32 v122, v122
    v_exp_f32 v123, v123
    ds_write_b128 v4, v[144:147] offset:8192
    v_exp_f32 v124, v124
    ds_write_b128 v4, v[148:151] offset:8224
    v_exp_f32 v125, v125
    s_setprio 1
    ds_write_b32 v5, v152 offset:49152
    v_exp_f32 v126, v126
    v_exp_f32 v127, v127
    v_exp_f32 v128, v128
    v_exp_f32 v129, v129
    v_smfmac_f32_32x32x32_bf16 v[240:255], v[84:87], v[120:127], v164
    v_exp_f32 v130, v130
    v_exp_f32 v131, v131
    v_mfma_f32_32x32x16_bf16 v[112:127], v[40:43], v[228:231], 0
TP7:
    s_cbranch_execz TR7
    v_exp_f32 v132, v132
TP5:
    s_cbranch_execz TR5
    v_exp_f32 v133, v133
    v_exp_f32 v134, v134
    buffer_load_dwordx4 v[184:187], v1, s[20:23], s10 offen offset:3072
    s_add_u32 s10, s10, 0x10000
    v_exp_f32 v135, v135
    v_exp_f32 v136, v136
    v_exp_f32 v137, v137
    v_smfmac_f32_32x32x32_bf16 v[240:255], v[88:91], v[128:135], v164
    s_setprio 0
    v_exp_f32 v138, v138
    v_exp_f32 v139, v139
    v_exp_f32 v140, v140
    v_exp_f32 v141, v141
    v_exp_f32 v142, v142
    v_exp_f32 v143, v143
    s_setprio 3
    v_exp_f32 v112, v112
    v_exp_f32 v113, v113
    v_smfmac_f32_32x32x32_bf16 v[240:255], v[92:95], v[136:143], v164
    v_exp_f32 v114, v114
    ds_read_b32 v10, v239 offset:49152
    ds_read2st64_b32 v[220:221], v6 offset0:0 offset1:10
    ds_read2st64_b32 v[222:223], v6 offset0:20 offset1:30
    ds_read2st64_b32 v[224:225], v6 offset0:40 offset1:50
    ds_read2st64_b32 v[226:227], v6 offset0:60 offset1:70
    ds_read_b128 v[168:171], v1 offset:2048
    v_exp_f32 v115, v115
    v_mfma_f32_32x32x16_bf16 v[128:143], v[44:47], v[228:231], 0
    v_exp_f32 v116, v116
    v_exp_f32 v117, v117
    v_exp_f32 v118, v118
    buffer_load_dwordx4 v[188:191], v1, s[20:23], s11 offen offset:0
    v_exp_f32 v119, v119
    v_exp_f32 v120, v120
    v_exp_f32 v121, v121
    v_smfmac_f32_32x32x32_bf16 v[240:255], v[96:99], v[112:119], v164
    v_exp_f32 v122, v122
    s_waitcnt lgkmcnt(0)
    v_cmp_gt_f32 vcc, 0, v10
    s_cbranch_vccnz A2_SP0
A2_OK0:
    v_add_f32 v10, v10, v10 quad_perm:[1,0,3,2] row_mask:0xf bank_mask:0xf
    v_pk_add_f32 v[220:221], v[220:221], v[222:223]
    v_pk_add_f32 v[224:225], v[224:225], v[226:227]
    v_add_f32 v10, v10, v10 quad_perm:[2,3,0,1] row_mask:0xf bank_mask:0xf
    v_pk_add_f32 v[220:221], v[220:221], v[224:225]
    v_add_f32 v220, v220, v221
    v_add_f32 v10, v10, v10 row_half_mirror row_mask:0xf bank_mask:0xf
    v_rcp_f32 v221, v10
    v_exp_f32 v123, v123
    v_exp_f32 v124, v124
    v_mul_f32 v220, v220, v221
    v_max3_f32 v238, v238, v10, v221
    v_cvt_pk_bf16_f32 v220, v220, v220
    ds_write_b16 v236, v220 offset:57344
    v_exp_f32 v125, v125
    v_exp_f32 v126, v126
    v_exp_f32 v127, v127
    v_exp_f32 v128, v128
    v_exp_f32 v129, v129
    v_smfmac_f32_32x32x32_bf16 v[240:255], v[100:103], v[120:127], v164
    v_exp_f32 v130, v130
    v_exp_f32 v131, v131
    v_mfma_f32_32x32x16_bf16 v[112:127], v[16:19], v[168:171], 0
    v_exp_f32 v132, v132
    v_exp_f32 v133, v133
    v_exp_f32 v134, v134
    v_mfma_f32_32x32x16_bf16 v[144:159], v[160:163], v[160:163], 0
    buffer_load_dwordx4 v[192:195], v1, s[20:23], s11 offen offset:1024
    v_exp_f32 v135, v135
    v_exp_f32 v136, v136
    s_setprio 2
    v_exp_f32 v137, v137
    v_smfmac_f32_32x32x32_bf16 v[240:255], v[104:107], v[128:135], v164
    v_exp_f32 v138, v138
    v_exp_f32 v139, v139
    v_exp_f32 v140, v140
    v_exp_f32 v141, v141
    v_exp_f32 v142, v142
    v_exp_f32 v143, v143
    v_exp_f32 v112, v112
    v_exp_f32 v113, v113
    v_smfmac_f32_32x32x32_bf16 v[240:255], v[108:111], v[136:143], v164
    v_exp_f32 v114, v114
    v_exp_f32 v115, v115
    v_mfma_f32_32x32x16_bf16 v[128:143], v[20:23], v[168:171], 0
    v_exp_f32 v116, v116
    v_exp_f32 v117, v117
    v_exp_f32 v118, v118
    buffer_load_dwordx4 v[196:199], v1, s[20:23], s11 offen offset:2048
    v_exp_f32 v119, v119
    v_exp_f32 v120, v120
    v_exp_f32 v121, v121
    v_smfmac_f32_32x32x32_bf16 v[144:159], v[48:51], v[112:119], v164
    v_exp_f32 v122, v122
    v_exp_f32 v123, v123
    ds_write_b128 v4, v[240:243] offset:28672
    v_exp_f32 v124, v124
    ds_write_b128 v4, v[244:247] offset:28704
    v_exp_f32 v125, v125
    s_setprio 1
    ds_write_b32 v5, v248 offset:50176
    v_exp_f32 v126, v126
    v_exp_f32 v127, v127
    v_exp_f32 v128, v128
    v_exp_f32 v129, v129
    v_smfmac_f32_32x32x32_bf16 v[144:159], v[52:55], v[120:127], v164
    v_exp_f32 v130, v130
    v_exp_f32 v131, v131
    v_mfma_f32_32x32x16_bf16 v[112:127], v[24:27], v[168:171], 0
    v_exp_f32 v132, v132
    v_exp_f32 v133, v133
    v_exp_f32 v134, v134
    buffer_load_dwordx4 v[200:203], v1, s[20:23], s11 offen offset:3072
    s_add_u32 s11, s11, 0x10000
    v_mfma_f32_32x32x16_bf16 v[240:255], v[160:163], v[160:163], 0
    v_exp_f32 v135, v135
    v_exp_f32 v136, v136
    v_exp_f32 v137, v137
    v_smfmac_f32_32x32x32_bf16 v[144:159], v[56:59], v[128:135], v164
    s_setprio 0
    v_exp_f32 v138, v138
    v_exp_f32 v139, v139
    v_exp_f32 v140, v140
    v_exp_f32 v141, v141
    v_exp_f32 v142, v142
    v_exp_f32 v143, v143
    s_setprio 3
    v_exp_f32 v112, v112
    v_exp_f32 v113, v113
    v_smfmac_f32_32x32x32_bf16 v[144:159], v[60:63], v[136:143], v164
    v_exp_f32 v114, v114
    v_exp_f32 v115, v115
    v_mfma_f32_32x32x16_bf16 v[128:143], v[28:31], v[168:171], 0
    v_exp_f32 v116, v116
    v_exp_f32 v117, v117
    v_exp_f32 v118, v118
    ds_read_b32 v10, v239 offset:50176
    ds_read2st64_b32 v[220:221], v6 offset0:80 offset1:90
    ds_read2st64_b32 v[222:223], v6 offset0:100 offset1:110
    ds_read2st64_b32 v[224:225], v6 offset0:120 offset1:130
    ds_read2st64_b32 v[226:227], v6 offset0:140 offset1:150
    ds_read_b128 v[228:231], v237 offset:57344
    v_exp_f32 v119, v119
    v_exp_f32 v120, v120
    v_exp_f32 v121, v121
    v_smfmac_f32_32x32x32_bf16 v[144:159], v[64:67], v[112:119], v164
    v_exp_f32 v122, v122
    v_exp_f32 v123, v123
    v_exp_f32 v124, v124
    v_exp_f32 v125, v125
    v_exp_f32 v126, v126
    v_exp_f32 v127, v127
    v_exp_f32 v128, v128
    v_exp_f32 v129, v129
    s_waitcnt lgkmcnt(0)
    v_cmp_gt_f32 vcc, 0, v10
    s_cbranch_vccnz A2_SP1
A2_OK1:
    v_add_f32 v10, v10, v10 quad_perm:[1,0,3,2] row_mask:0xf bank_mask:0xf
    v_pk_add_f32 v[220:221], v[220:221], v[222:223]
    v_pk_add_f32 v[224:225], v[224:225], v[226:227]
    v_add_f32 v10, v10, v10 quad_perm:[2,3,0,1] row_mask:0xf bank_mask:0xf
    v_pk_add_f32 v[220:221], v[220:221], v[224:225]
    v_add_f32 v220, v220, v221
    v_add_f32 v10, v10, v10 row_half_mirror row_mask:0xf bank_mask:0xf
    v_rcp_f32 v221, v10
    v_smfmac_f32_32x32x32_bf16 v[144:159], v[68:71], v[120:127], v164
    v_exp_f32 v130, v130
    v_mul_f32 v220, v220, v221
    v_max3_f32 v238, v238, v10, v221
    v_cvt_pk_bf16_f32 v220, v220, v220
    ds_write_b16 v236, v220 offset:58624
    v_exp_f32 v131, v131
    v_mfma_f32_32x32x16_bf16 v[112:127], v[32:35], v[168:171], 0
    v_exp_f32 v132, v132
    v_exp_f32 v133, v133
    v_exp_f32 v134, v134
    v_exp_f32 v135, v135
    v_exp_f32 v136, v136
    s_setprio 2
    v_exp_f32 v137, v137
    s_waitcnt vmcnt(6)
    v_smfmac_f32_16x16x64_bf16 v[204:207], v[228:231], v[172:179], v164 abid:1
    v_smfmac_f32_32x32x32_bf16 v[144:159], v[72:75], v[128:135], v164
    v_exp_f32 v138, v138
    v_exp_f32 v139, v139
    v_exp_f32 v140, v140
    v_exp_f32 v141, v141
    v_exp_f32 v142, v142
    v_exp_f32 v143, v143
    v_exp_f32 v112, v112
    s_waitcnt vmcnt(4)
    v_smfmac_f32_16x16x64_bf16 v[208:211], v[228:231], v[180:187], v164 abid:1
    v_exp_f32 v113, v113
    v_smfmac_f32_32x32x32_bf16 v[144:159], v[76:79], v[136:143], v164
    v_exp_f32 v114, v114
    v_exp_f32 v115, v115
    v_mfma_f32_32x32x16_bf16 v[128:143], v[36:39], v[168:171], 0
    buffer_load_dwordx4 v[172:175], v1, s[20:23], s10 offen offset:0
    v_exp_f32 v116, v116
    v_exp_f32 v117, v117
    v_exp_f32 v118, v118
    v_exp_f32 v119, v119
    v_exp_f32 v120, v120
    s_waitcnt vmcnt(3)
    v_smfmac_f32_16x16x64_bf16 v[212:215], v[228:231], v[188:195], v164 abid:1
    v_exp_f32 v121, v121
    v_smfmac_f32_32x32x32_bf16 v[144:159], v[80:83], v[112:119], v164
    v_exp_f32 v122, v122
    v_exp_f32 v123, v123
    v_exp_f32 v124, v124
    v_exp_f32 v125, v125
    s_setprio 1
    v_exp_f32 v126, v126
    v_exp_f32 v127, v127
    v_exp_f32 v128, v128
    s_waitcnt vmcnt(1)
    v_smfmac_f32_16x16x64_bf16 v[216:219], v[228:231], v[196:203], v164 abid:1
    v_exp_f32 v129, v129
    v_smfmac_f32_32x32x32_bf16 v[144:159], v[84:87], v[120:127], v164
    v_exp_f32 v130, v130
    v_exp_f32 v131, v131
    v_mfma_f32_32x32x16_bf16 v[112:127], v[40:43], v[168:171], 0
    buffer_load_dwordx4 v[176:179], v1, s[20:23], s10 offen offset:1024
    v_exp_f32 v132, v132
    v_exp_f32 v133, v133
    v_exp_f32 v134, v134
    v_exp_f32 v135, v135
    v_exp_f32 v136, v136
    v_exp_f32 v137, v137
    v_smfmac_f32_32x32x32_bf16 v[144:159], v[88:91], v[128:135], v164
    s_setprio 0
    v_exp_f32 v138, v138
    v_exp_f32 v139, v139
    v_exp_f32 v140, v140
    v_exp_f32 v141, v141
    v_exp_f32 v142, v142
    v_exp_f32 v143, v143
    s_setprio 3
    v_exp_f32 v112, v112
    v_exp_f32 v113, v113
    v_smfmac_f32_32x32x32_bf16 v[144:159], v[92:95], v[136:143], v164
    v_exp_f32 v114, v114
    v_exp_f32 v115, v115
    v_mfma_f32_32x32x16_bf16 v[128:143], v[44:47], v[168:171], 0
    v_exp_f32 v116, v116
    ds_read_b128 v[168:171], v1 offset:3072
    v_exp_f32 v117, v117
    v_exp_f32 v118, v118
    v_exp_f32 v119, v119
    v_exp_f32 v120, v120
    buffer_load_dwordx4 v[180:183], v1, s[20:23], s10 offen offset:2048
    v_exp_f32 v121, v121
    v_smfmac_f32_32x32x32_bf16 v[144:159], v[96:99], v[112:119], v164
    v_exp_f32 v122, v122
    v_exp_f32 v123, v123
    v_exp_f32 v124, v124
    v_exp_f32 v125, v125
    v_exp_f32 v126, v126
    v_exp_f32 v127, v127
    v_exp_f32 v128, v128
    v_exp_f32 v129, v129
    v_smfmac_f32_32x32x32_bf16 v[144:159], v[100:103], v[120:127], v164
    v_exp_f32 v130, v130
    v_exp_f32 v131, v131
    s_waitcnt lgkmcnt(0)
    v_mfma_f32_32x32x16_bf16 v[112:127], v[16:19], v[168:171], 0
    v_exp_f32 v132, v132
    v_exp_f32 v133, v133
    v_exp_f32 v134, v134
    v_exp_f32 v135, v135
    v_exp_f32 v136, v136
    s_setprio 2
    buffer_load_dwordx4 v[184:187], v1, s[20:23], s10 offen offset:3072
    s_add_u32 s10, s10, 0x10000
    v_exp_f32 v137, v137
    v_smfmac_f32_32x32x32_bf16 v[144:159], v[104:107], v[128:135], v164
    v_exp_f32 v138, v138
    v_exp_f32 v139, v139
    v_exp_f32 v140, v140
    v_exp_f32 v141, v141
    v_exp_f32 v142, v142
    v_exp_f32 v143, v143
    v_exp_f32 v112, v112
    v_exp_f32 v113, v113
    v_smfmac_f32_32x32x32_bf16 v[144:159], v[108:111], v[136:143], v164
    v_exp_f32 v114, v114
    buffer_load_dwordx4 v[188:191], v1, s[20:23], s11 offen offset:0
    v_exp_f32 v115, v115
    v_mfma_f32_32x32x16_bf16 v[128:143], v[20:23], v[168:171], 0
    v_exp_f32 v116, v116
    v_exp_f32 v117, v117
    v_exp_f32 v118, v118
    v_exp_f32 v119, v119
    v_exp_f32 v120, v120
    v_exp_f32 v121, v121
    v_smfmac_f32_32x32x32_bf16 v[240:255], v[48:51], v[112:119], v164
    v_exp_f32 v122, v122
    v_exp_f32 v123, v123
    ds_write_b128 v4, v[144:147] offset:8192
    v_exp_f32 v124, v124
    ds_write_b128 v4, v[148:151] offset:8224
    v_exp_f32 v125, v125
    s_setprio 1
    ds_write_b32 v5, v152 offset:51200
    v_exp_f32 v126, v126
    v_exp_f32 v127, v127
    v_exp_f32 v128, v128
    buffer_load_dwordx4 v[192:195], v1, s[20:23], s11 offen offset:1024
    v_exp_f32 v129, v129
    v_smfmac_f32_32x32x32_bf16 v[240:255], v[52:55], v[120:127], v164
    v_exp_f32 v130, v130
    v_exp_f32 v131, v131
    v_mfma_f32_32x32x16_bf16 v[112:127], v[24:27], v[168:171], 0
    v_exp_f32 v132, v132
    v_exp_f32 v133, v133
    v_exp_f32 v134, v134
    v_mfma_f32_32x32x16_bf16 v[144:159], v[160:163], v[160:163], 0
    v_exp_f32 v135, v135
    v_exp_f32 v136, v136
    v_exp_f32 v137, v137
    v_smfmac_f32_32x32x32_bf16 v[240:255], v[56:59], v[128:135], v164
    s_setprio 0
    v_exp_f32 v138, v138
    buffer_load_dwordx4 v[196:199], v1, s[20:23], s11 offen offset:2048
    v_exp_f32 v139, v139
    v_exp_f32 v140, v140
    v_exp_f32 v141, v141
    v_exp_f32 v142, v142
    v_exp_f32 v143, v143
    s_setprio 3
    v_exp_f32 v112, v112
    buffer_load_dwordx4 v[200:203], v1, s[20:23], s11 offen offset:3072
    s_add_u32 s11, s11, 0x10000
    v_exp_f32 v113, v113
    v_smfmac_f32_32x32x32_bf16 v[240:255], v[60:63], v[136:143], v164
    v_exp_f32 v114, v114
    v_exp_f32 v115, v115
    v_mfma_f32_32x32x16_bf16 v[128:143], v[28:31], v[168:171], 0
    v_exp_f32 v116, v116
    v_exp_f32 v117, v117
    v_exp_f32 v118, v118
    ds_read_b32 v10, v239 offset:51200
    ds_read2st64_b32 v[220:221], v6 offset0:0 offset1:10
    ds_read2st64_b32 v[222:223], v6 offset0:20 offset1:30
    ds_read2st64_b32 v[224:225], v6 offset0:40 offset1:50
    ds_read2st64_b32 v[226:227], v6 offset0:60 offset1:70
    ds_read_b128 v[228:231], v237 offset:58624
    v_exp_f32 v119, v119
    v_exp_f32 v120, v120
    v_exp_f32 v121, v121
    v_smfmac_f32_32x32x32_bf16 v[240:255], v[64:67], v[112:119], v164
    v_exp_f32 v122, v122
    v_exp_f32 v123, v123
    v_exp_f32 v124, v124
    v_exp_f32 v125, v125
    v_exp_f32 v126, v126
    v_exp_f32 v127, v127
    v_exp_f32 v128, v128
    v_exp_f32 v129, v129
    s_waitcnt lgkmcnt(0)
    v_cmp_gt_f32 vcc, 0, v10
    s_cbranch_vccnz A2_SP2
A2_OK2:
    v_add_f32 v10, v10, v10 quad_perm:[1,0,3,2] row_mask:0xf bank_mask:0xf
    v_pk_add_f32 v[220:221], v[220:221], v[222:223]
    v_pk_add_f32 v[224:225], v[224:225], v[226:227]
    v_add_f32 v10, v10, v10 quad_perm:[2,3,0,1] row_mask:0xf bank_mask:0xf
    v_pk_add_f32 v[220:221], v[220:221], v[224:225]
    v_add_f32 v220, v220, v221
    v_add_f32 v10, v10, v10 row_half_mirror row_mask:0xf bank_mask:0xf
    v_rcp_f32 v221, v10
    v_smfmac_f32_32x32x32_bf16 v[240:255], v[68:71], v[120:127], v164
    v_exp_f32 v130, v130
    v_mul_f32 v220, v220, v221
    v_max3_f32 v238, v238, v10, v221
    v_cvt_pk_bf16_f32 v220, v220, v220
    ds_write_b16 v236, v220 offset:57344
    v_exp_f32 v131, v131
    v_mfma_f32_32x32x16_bf16 v[112:127], v[32:35], v[168:171], 0
    v_exp_f32 v132, v132
    v_exp_f32 v133, v133
    v_exp_f32 v134, v134
    v_exp_f32 v135, v135
    v_exp_f32 v136, v136
    s_setprio 2
    v_exp_f32 v137, v137
    s_waitcnt vmcnt(6)
    v_smfmac_f32_16x16x64_bf16 v[204:207], v[228:231], v[172:179], v164 abid:1
    v_smfmac_f32_32x32x32_bf16 v[240:255], v[72:75], v[128:135], v164
    v_exp_f32 v138, v138
    v_exp_f32 v139, v139
    v_exp_f32 v140, v140
    v_exp_f32 v141, v141
    v_exp_f32 v142, v142
    v_exp_f32 v143, v143
    v_exp_f32 v112, v112
    s_waitcnt vmcnt(4)
    v_smfmac_f32_16x16x64_bf16 v[208:211], v[228:231], v[180:187], v164 abid:1
    v_exp_f32 v113, v113
    v_smfmac_f32_32x32x32_bf16 v[240:255], v[76:79], v[136:143], v164
    v_exp_f32 v114, v114
    v_exp_f32 v115, v115
    v_mfma_f32_32x32x16_bf16 v[128:143], v[36:39], v[168:171], 0
    buffer_load_dwordx4 v[172:175], v1, s[20:23], s10 offen offset:0
    v_exp_f32 v116, v116
    v_exp_f32 v117, v117
    v_exp_f32 v118, v118
    v_exp_f32 v119, v119
    v_exp_f32 v120, v120
    s_waitcnt vmcnt(3)
    v_smfmac_f32_16x16x64_bf16 v[212:215], v[228:231], v[188:195], v164 abid:1
    v_exp_f32 v121, v121
    v_smfmac_f32_32x32x32_bf16 v[240:255], v[80:83], v[112:119], v164
    v_exp_f32 v122, v122
    v_exp_f32 v123, v123
    v_exp_f32 v124, v124
    v_exp_f32 v125, v125
    s_setprio 1
    v_exp_f32 v126, v126
    v_exp_f32 v127, v127
    v_exp_f32 v128, v128
    s_waitcnt vmcnt(1)
    v_smfmac_f32_16x16x64_bf16 v[216:219], v[228:231], v[196:203], v164 abid:1
    v_exp_f32 v129, v129
    v_smfmac_f32_32x32x32_bf16 v[240:255], v[84:87], v[120:127], v164
    v_exp_f32 v130, v130
    v_exp_f32 v131, v131
    v_mfma_f32_32x32x16_bf16 v[112:127], v[40:43], v[168:171], 0
    buffer_load_dwordx4 v[176:179], v1, s[20:23], s10 offen offset:1024
    v_exp_f32 v132, v132
    v_exp_f32 v133, v133
    v_exp_f32 v134, v134
    v_exp_f32 v135, v135
    v_exp_f32 v136, v136
    v_exp_f32 v137, v137
    v_smfmac_f32_32x32x32_bf16 v[240:255], v[88:91], v[128:135], v164
    s_setprio 0
    v_exp_f32 v138, v138
    v_exp_f32 v139, v139
    v_exp_f32 v140, v140
    v_exp_f32 v141, v141
    v_exp_f32 v142, v142
    v_exp_f32 v143, v143
    s_setprio 3
    v_exp_f32 v112, v112
    v_exp_f32 v113, v113
    v_smfmac_f32_32x32x32_bf16 v[240:255], v[92:95], v[136:143], v164
    v_exp_f32 v114, v114
    v_exp_f32 v115, v115
    v_mfma_f32_32x32x16_bf16 v[128:143], v[44:47], v[168:171], 0
    v_exp_f32 v116, v116
    ds_read_b128 v[168:171], v1 offset:4096
    v_exp_f32 v117, v117
    v_exp_f32 v118, v118
    v_exp_f32 v119, v119
    v_exp_f32 v120, v120
    buffer_load_dwordx4 v[180:183], v1, s[20:23], s10 offen offset:2048
    v_exp_f32 v121, v121
    v_smfmac_f32_32x32x32_bf16 v[240:255], v[96:99], v[112:119], v164
    v_exp_f32 v122, v122
    v_exp_f32 v123, v123
    v_exp_f32 v124, v124
    v_exp_f32 v125, v125
    v_exp_f32 v126, v126
    v_exp_f32 v127, v127
    v_exp_f32 v128, v128
    v_exp_f32 v129, v129
    v_smfmac_f32_32x32x32_bf16 v[240:255], v[100:103], v[120:127], v164
    v_exp_f32 v130, v130
    v_exp_f32 v131, v131
    s_waitcnt lgkmcnt(0)
    v_mfma_f32_32x32x16_bf16 v[112:127], v[16:19], v[168:171], 0
    v_exp_f32 v132, v132
    v_exp_f32 v133, v133
    v_exp_f32 v134, v134
    v_exp_f32 v135, v135
    v_exp_f32 v136, v136
    s_setprio 2
    buffer_load_dwordx4 v[184:187], v1, s[20:23], s10 offen offset:3072
    s_add_u32 s10, s10, 0x10000
    v_exp_f32 v137, v137
    v_smfmac_f32_32x32x32_bf16 v[240:255], v[104:107], v[128:135], v164
    v_exp_f32 v138, v138
    v_exp_f32 v139, v139
    v_exp_f32 v140, v140
    v_exp_f32 v141, v141
    v_exp_f32 v142, v142
    v_exp_f32 v143, v143
    v_exp_f32 v112, v112
    v_exp_f32 v113, v113
    v_smfmac_f32_32x32x32_bf16 v[240:255], v[108:111], v[136:143], v164
    v_exp_f32 v114, v114
    buffer_load_dwordx4 v[188:191], v1, s[20:23], s11 offen offset:0
    v_exp_f32 v115, v115
    v_mfma_f32_32x32x16_bf16 v[128:143], v[20:23], v[168:171], 0
    v_exp_f32 v116, v116
    v_exp_f32 v117, v117
    v_exp_f32 v118, v118
    v_exp_f32 v119, v119
    v_exp_f32 v120, v120
    v_exp_f32 v121, v121
    v_smfmac_f32_32x32x32_bf16 v[144:159], v[48:51], v[112:119], v164
    v_exp_f32 v122, v122
    v_exp_f32 v123, v123
    ds_write_b128 v4, v[240:243] offset:28672
    v_exp_f32 v124, v124
    ds_write_b128 v4, v[244:247] offset:28704
    v_exp_f32 v125, v125
    s_setprio 1
    ds_write_b32 v5, v248 offset:52224
    v_exp_f32 v126, v126
    v_exp_f32 v127, v127
    v_exp_f32 v128, v128
    buffer_load_dwordx4 v[192:195], v1, s[20:23], s11 offen offset:1024
    v_exp_f32 v129, v129
    v_smfmac_f32_32x32x32_bf16 v[144:159], v[52:55], v[120:127], v164
    v_exp_f32 v130, v130
    v_exp_f32 v131, v131
    v_mfma_f32_32x32x16_bf16 v[112:127], v[24:27], v[168:171], 0
    v_exp_f32 v132, v132
    v_exp_f32 v133, v133
    v_exp_f32 v134, v134
    v_mfma_f32_32x32x16_bf16 v[240:255], v[160:163], v[160:163], 0
    v_exp_f32 v135, v135
    v_exp_f32 v136, v136
    v_exp_f32 v137, v137
    v_smfmac_f32_32x32x32_bf16 v[144:159], v[56:59], v[128:135], v164
    s_setprio 0
    v_exp_f32 v138, v138
    buffer_load_dwordx4 v[196:199], v1, s[20:23], s11 offen offset:2048
    v_exp_f32 v139, v139
    v_exp_f32 v140, v140
    v_exp_f32 v141, v141
    v_exp_f32 v142, v142
    v_exp_f32 v143, v143
    s_setprio 3
    v_exp_f32 v112, v112
    buffer_load_dwordx4 v[200:203], v1, s[20:23], s11 offen offset:3072
    s_add_u32 s11, s11, 0x10000
    v_exp_f32 v113, v113
    v_smfmac_f32_32x32x32_bf16 v[144:159], v[60:63], v[136:143], v164
    v_exp_f32 v114, v114
    v_exp_f32 v115, v115
    v_mfma_f32_32x32x16_bf16 v[128:143], v[28:31], v[168:171], 0
    v_exp_f32 v116, v116
    v_exp_f32 v117, v117
    v_exp_f32 v118, v118
    ds_read_b32 v10, v239 offset:52224
    ds_read2st64_b32 v[220:221], v6 offset0:80 offset1:90
    ds_read2st64_b32 v[222:223], v6 offset0:100 offset1:110
    ds_read2st64_b32 v[224:225], v6 offset0:120 offset1:130
    ds_read2st64_b32 v[226:227], v6 offset0:140 offset1:150
    ds_read_b128 v[228:231], v237 offset:57344
    v_exp_f32 v119, v119
    v_exp_f32 v120, v120
    v_exp_f32 v121, v121
    v_smfmac_f32_32x32x32_bf16 v[144:159], v[64:67], v[112:119], v164
    v_exp_f32 v122, v122
    v_exp_f32 v123, v123
    v_exp_f32 v124, v124
    v_exp_f32 v125, v125
    v_exp_f32 v126, v126
    v_exp_f32 v127, v127
    v_exp_f32 v128, v128
    v_exp_f32 v129, v129
    s_waitcnt lgkmcnt(0)
    v_cmp_gt_f32 vcc, 0, v10
    s_cbranch_vccnz A2_SP3
A2_OK3:
    v_add_f32 v10, v10, v10 quad_perm:[1,0,3,2] row_mask:0xf bank_mask:0xf
    v_pk_add_f32 v[220:221], v[220:221], v[222:223]
    v_pk_add_f32 v[224:225], v[224:225], v[226:227]
    v_add_f32 v10, v10, v10 quad_perm:[2,3,0,1] row_mask:0xf bank_mask:0xf
    v_pk_add_f32 v[220:221], v[220:221], v[224:225]
    v_add_f32 v220, v220, v221
    v_add_f32 v10, v10, v10 row_half_mirror row_mask:0xf bank_mask:0xf
    v_rcp_f32 v221, v10
    v_smfmac_f32_32x32x32_bf16 v[144:159], v[68:71], v[120:127], v164
    v_exp_f32 v130, v130
    v_mul_f32 v220, v220, v221
    v_max3_f32 v238, v238, v10, v221
    v_cvt_pk_bf16_f32 v220, v220, v220
    ds_write_b16 v236, v220 offset:58624
    v_exp_f32 v131, v131
    v_mfma_f32_32x32x16_bf16 v[112:127], v[32:35], v[168:171], 0
    v_exp_f32 v132, v132
    v_exp_f32 v133, v133
    v_exp_f32 v134, v134
    v_exp_f32 v135, v135
    v_exp_f32 v136, v136
    s_setprio 2
    v_exp_f32 v137, v137
    s_waitcnt vmcnt(6)
    v_smfmac_f32_16x16x64_bf16 v[204:207], v[228:231], v[172:179], v164 abid:1
    v_smfmac_f32_32x32x32_bf16 v[144:159], v[72:75], v[128:135], v164
    v_exp_f32 v138, v138
    v_exp_f32 v139, v139
    v_exp_f32 v140, v140
    v_exp_f32 v141, v141
    v_exp_f32 v142, v142
    v_exp_f32 v143, v143
    v_exp_f32 v112, v112
    s_waitcnt vmcnt(4)
    v_smfmac_f32_16x16x64_bf16 v[208:211], v[228:231], v[180:187], v164 abid:1
    v_exp_f32 v113, v113
    v_smfmac_f32_32x32x32_bf16 v[144:159], v[76:79], v[136:143], v164
    v_exp_f32 v114, v114
    v_exp_f32 v115, v115
    v_mfma_f32_32x32x16_bf16 v[128:143], v[36:39], v[168:171], 0
    buffer_load_dwordx4 v[172:175], v1, s[20:23], s10 offen offset:0
    v_exp_f32 v116, v116
    v_exp_f32 v117, v117
    v_exp_f32 v118, v118
    v_exp_f32 v119, v119
    v_exp_f32 v120, v120
    s_waitcnt vmcnt(3)
    v_smfmac_f32_16x16x64_bf16 v[212:215], v[228:231], v[188:195], v164 abid:1
    v_exp_f32 v121, v121
    v_smfmac_f32_32x32x32_bf16 v[144:159], v[80:83], v[112:119], v164
    v_exp_f32 v122, v122
    v_exp_f32 v123, v123
    v_exp_f32 v124, v124
    v_exp_f32 v125, v125
    s_setprio 1
    v_exp_f32 v126, v126
    v_exp_f32 v127, v127
    v_exp_f32 v128, v128
    s_waitcnt vmcnt(1)
    v_smfmac_f32_16x16x64_bf16 v[216:219], v[228:231], v[196:203], v164 abid:1
    v_exp_f32 v129, v129
    v_smfmac_f32_32x32x32_bf16 v[144:159], v[84:87], v[120:127], v164
    v_exp_f32 v130, v130
    v_exp_f32 v131, v131
    v_mfma_f32_32x32x16_bf16 v[112:127], v[40:43], v[168:171], 0
    buffer_load_dwordx4 v[176:179], v1, s[20:23], s10 offen offset:1024
    v_exp_f32 v132, v132
    v_exp_f32 v133, v133
    v_exp_f32 v134, v134
    v_exp_f32 v135, v135
    v_exp_f32 v136, v136
    v_exp_f32 v137, v137
    v_smfmac_f32_32x32x32_bf16 v[144:159], v[88:91], v[128:135], v164
    s_setprio 0
    v_exp_f32 v138, v138
    v_exp_f32 v139, v139
    v_exp_f32 v140, v140
    v_exp_f32 v141, v141
    v_exp_f32 v142, v142
    v_exp_f32 v143, v143
    s_setprio 3
    v_exp_f32 v112, v112
    v_exp_f32 v113, v113
    v_smfmac_f32_32x32x32_bf16 v[144:159], v[92:95], v[136:143], v164
    v_exp_f32 v114, v114
    v_exp_f32 v115, v115
    v_mfma_f32_32x32x16_bf16 v[128:143], v[44:47], v[168:171], 0
    v_exp_f32 v116, v116
    ds_read_b128 v[168:171], v1 offset:5120
    v_exp_f32 v117, v117
    v_exp_f32 v118, v118
    v_exp_f32 v119, v119
    v_exp_f32 v120, v120
    buffer_load_dwordx4 v[180:183], v1, s[20:23], s10 offen offset:2048
    v_exp_f32 v121, v121
    v_smfmac_f32_32x32x32_bf16 v[144:159], v[96:99], v[112:119], v164
    v_exp_f32 v122, v122
    v_exp_f32 v123, v123
    v_exp_f32 v124, v124
    v_exp_f32 v125, v125
    v_exp_f32 v126, v126
    v_exp_f32 v127, v127
    v_exp_f32 v128, v128
    v_exp_f32 v129, v129
    v_smfmac_f32_32x32x32_bf16 v[144:159], v[100:103], v[120:127], v164
    v_exp_f32 v130, v130
    v_exp_f32 v131, v131
    s_waitcnt lgkmcnt(0)
    v_mfma_f32_32x32x16_bf16 v[112:127], v[16:19], v[168:171], 0
    v_exp_f32 v132, v132
    v_exp_f32 v133, v133
    v_exp_f32 v134, v134
    v_exp_f32 v135, v135
    v_exp_f32 v136, v136
    s_setprio 2
    buffer_load_dwordx4 v[184:187], v1, s[20:23], s10 offen offset:3072
    s_add_u32 s10, s10, 0x10000
    v_exp_f32 v137, v137
    v_smfmac_f32_32x32x32_bf16 v[144:159], v[104:107], v[128:135], v164
    v_exp_f32 v138, v138
    v_exp_f32 v139, v139
    v_exp_f32 v140, v140
    v_exp_f32 v141, v141
    v_exp_f32 v142, v142
    v_exp_f32 v143, v143
    v_exp_f32 v112, v112
    v_exp_f32 v113, v113
    v_smfmac_f32_32x32x32_bf16 v[144:159], v[108:111], v[136:143], v164
    v_exp_f32 v114, v114
    buffer_load_dwordx4 v[188:191], v1, s[20:23], s11 offen offset:0
    v_exp_f32 v115, v115
    v_mfma_f32_32x32x16_bf16 v[128:143], v[20:23], v[168:171], 0
    v_exp_f32 v116, v116
    v_exp_f32 v117, v117
    v_exp_f32 v118, v118
    v_exp_f32 v119, v119
    v_exp_f32 v120, v120
    v_exp_f32 v121, v121
    v_smfmac_f32_32x32x32_bf16 v[240:255], v[48:51], v[112:119], v164
    v_exp_f32 v122, v122
    v_exp_f32 v123, v123
    ds_write_b128 v4, v[144:147] offset:8192
    v_exp_f32 v124, v124
    ds_write_b128 v4, v[148:151] offset:8224
    v_exp_f32 v125, v125
    s_setprio 1
    ds_write_b32 v5, v152 offset:53248
    v_exp_f32 v126, v126
    v_exp_f32 v127, v127
    v_exp_f32 v128, v128
    buffer_load_dwordx4 v[192:195], v1, s[20:23], s11 offen offset:1024
    v_exp_f32 v129, v129
    v_smfmac_f32_32x32x32_bf16 v[240:255], v[52:55], v[120:127], v164
    v_exp_f32 v130, v130
    v_exp_f32 v131, v131
    v_mfma_f32_32x32x16_bf16 v[112:127], v[24:27], v[168:171], 0
    v_exp_f32 v132, v132
    v_exp_f32 v133, v133
    v_exp_f32 v134, v134
    v_mfma_f32_32x32x16_bf16 v[144:159], v[160:163], v[160:163], 0
    v_exp_f32 v135, v135
    v_exp_f32 v136, v136
    v_exp_f32 v137, v137
    v_smfmac_f32_32x32x32_bf16 v[240:255], v[56:59], v[128:135], v164
    s_setprio 0
    v_exp_f32 v138, v138
    buffer_load_dwordx4 v[196:199], v1, s[20:23], s11 offen offset:2048
    v_exp_f32 v139, v139
    v_exp_f32 v140, v140
    v_exp_f32 v141, v141
    v_exp_f32 v142, v142
    v_exp_f32 v143, v143
    s_setprio 3
    v_exp_f32 v112, v112
    buffer_load_dwordx4 v[200:203], v1, s[20:23], s11 offen offset:3072
    s_add_u32 s11, s11, 0x10000
    v_exp_f32 v113, v113
    v_smfmac_f32_32x32x32_bf16 v[240:255], v[60:63], v[136:143], v164
    v_exp_f32 v114, v114
    v_exp_f32 v115, v115
    v_mfma_f32_32x32x16_bf16 v[128:143], v[28:31], v[168:171], 0
    v_exp_f32 v116, v116
    v_exp_f32 v117, v117
    v_exp_f32 v118, v118
    ds_read_b32 v10, v239 offset:53248
    ds_read2st64_b32 v[220:221], v6 offset0:0 offset1:10
    ds_read2st64_b32 v[222:223], v6 offset0:20 offset1:30
    ds_read2st64_b32 v[224:225], v6 offset0:40 offset1:50
    ds_read2st64_b32 v[226:227], v6 offset0:60 offset1:70
    ds_read_b128 v[228:231], v237 offset:58624
    v_exp_f32 v119, v119
    v_exp_f32 v120, v120
    v_exp_f32 v121, v121
    v_smfmac_f32_32x32x32_bf16 v[240:255], v[64:67], v[112:119], v164
    v_exp_f32 v122, v122
    v_exp_f32 v123, v123
    v_exp_f32 v124, v124
    v_exp_f32 v125, v125
    v_exp_f32 v126, v126
    v_exp_f32 v127, v127
    v_exp_f32 v128, v128
    v_exp_f32 v129, v129
    s_waitcnt lgkmcnt(0)
    v_cmp_gt_f32 vcc, 0, v10
    s_cbranch_vccnz A2_SP4
A2_OK4:
    v_add_f32 v10, v10, v10 quad_perm:[1,0,3,2] row_mask:0xf bank_mask:0xf
    v_pk_add_f32 v[220:221], v[220:221], v[222:223]
    v_pk_add_f32 v[224:225], v[224:225], v[226:227]
    v_add_f32 v10, v10, v10 quad_perm:[2,3,0,1] row_mask:0xf bank_mask:0xf
    v_pk_add_f32 v[220:221], v[220:221], v[224:225]
    v_add_f32 v220, v220, v221
    v_add_f32 v10, v10, v10 row_half_mirror row_mask:0xf bank_mask:0xf
    v_rcp_f32 v221, v10
    v_smfmac_f32_32x32x32_bf16 v[240:255], v[68:71], v[120:127], v164
    v_exp_f32 v130, v130
    v_mul_f32 v220, v220, v221
    v_max3_f32 v238, v238, v10, v221
    v_cvt_pk_bf16_f32 v220, v220, v220
    ds_write_b16 v236, v220 offset:57344
    v_exp_f32 v131, v131
    v_mfma_f32_32x32x16_bf16 v[112:127], v[32:35], v[168:171], 0
TP8:
    s_cbranch_execz TR8
    v_exp_f32 v132, v132
    v_exp_f32 v133, v133
    v_exp_f32 v134, v134
    v_exp_f32 v135, v135
    v_exp_f32 v136, v136
    s_setprio 2
    v_exp_f32 v137, v137
    s_waitcnt vmcnt(6)
    v_smfmac_f32_16x16x64_bf16 v[204:207], v[228:231], v[172:179], v164 abid:1
    v_smfmac_f32_32x32x32_bf16 v[240:255], v[72:75], v[128:135], v164
    v_exp_f32 v138, v138
    v_exp_f32 v139, v139
    v_exp_f32 v140, v140
    v_exp_f32 v141, v141
    v_exp_f32 v142, v142
    v_exp_f32 v143, v143
    v_exp_f32 v112, v112
    s_waitcnt vmcnt(4)
    v_smfmac_f32_16x16x64_bf16 v[208:211], v[228:231], v[180:187], v164 abid:1
    v_exp_f32 v113, v113
    v_smfmac_f32_32x32x32_bf16 v[240:255], v[76:79], v[136:143], v164
    v_exp_f32 v114, v114
    v_exp_f32 v115, v115
    v_mfma_f32_32x32x16_bf16 v[128:143], v[36:39], v[168:171], 0
    buffer_load_dwordx4 v[172:175], v1, s[20:23], s10 offen offset:0
    v_exp_f32 v116, v116
    v_exp_f32 v117, v117
    v_exp_f32 v118, v118
    v_exp_f32 v119, v119
    v_exp_f32 v120, v120
    s_waitcnt vmcnt(3)
    v_smfmac_f32_16x16x64_bf16 v[212:215], v[228:231], v[188:195], v164 abid:1
    v_exp_f32 v121, v121
    v_smfmac_f32_32x32x32_bf16 v[240:255], v[80:83], v[112:119], v164
    v_exp_f32 v122, v122
    v_exp_f32 v123, v123
    v_exp_f32 v124, v124
    v_exp_f32 v125, v125
    s_setprio 1
    v_exp_f32 v126, v126
    v_exp_f32 v127, v127
    v_exp_f32 v128, v128
    s_waitcnt vmcnt(1)
    v_smfmac_f32_16x16x64_bf16 v[216:219], v[228:231], v[196:203], v164 abid:1
    v_exp_f32 v129, v129
    v_smfmac_f32_32x32x32_bf16 v[240:255], v[84:87], v[120:127], v164
    v_exp_f32 v130, v130
    v_exp_f32 v131, v131
    v_mfma_f32_32x32x16_bf16 v[112:127], v[40:43], v[168:171], 0
    buffer_load_dwordx4 v[176:179], v1, s[20:23], s10 offen offset:1024
    v_exp_f32 v132, v132
    v_exp_f32 v133, v133
    v_exp_f32 v134, v134
    v_exp_f32 v135, v135
    v_exp_f32 v136, v136
    v_exp_f32 v137, v137
    v_smfmac_f32_32x32x32_bf16 v[240:255], v[88:91], v[128:135], v164
    s_setprio 0
    v_exp_f32 v138, v138
    v_exp_f32 v139, v139
    v_exp_f32 v140, v140
    v_exp_f32 v141, v141
    v_exp_f32 v142, v142
    v_exp_f32 v143, v143
    s_setprio 3
    v_exp_f32 v112, v112
    v_exp_f32 v113, v113
    v_smfmac_f32_32x32x32_bf16 v[240:255], v[92:95], v[136:143], v164
    v_exp_f32 v114, v114
    v_exp_f32 v115, v115
    v_mfma_f32_32x32x16_bf16 v[128:143], v[44:47], v[168:171], 0
    v_exp_f32 v116, v116
    ds_read_b128 v[168:171], v1 offset:6144
    v_exp_f32 v117, v117
    v_exp_f32 v118, v118
    v_exp_f32 v119, v119
    v_exp_f32 v120, v120
    buffer_load_dwordx4 v[180:183], v1, s[20:23], s10 offen offset:2048
    v_exp_f32 v121, v121
    v_smfmac_f32_32x32x32_bf16 v[240:255], v[96:99], v[112:119], v164
    v_exp_f32 v122, v122
    v_exp_f32 v123, v123
    v_exp_f32 v124, v124
    v_exp_f32 v125, v125
    v_exp_f32 v126, v126
    v_exp_f32 v127, v127
    v_exp_f32 v128, v128
    v_exp_f32 v129, v129
    v_smfmac_f32_32x32x32_bf16 v[240:255], v[100:103], v[120:127], v164
    v_exp_f32 v130, v130
    v_exp_f32 v131, v131
    s_waitcnt lgkmcnt(0)
    v_mfma_f32_32x32x16_bf16 v[112:127], v[16:19], v[168:171], 0
    v_exp_f32 v132, v132
    v_exp_f32 v133, v133
    v_exp_f32 v134, v134
    v_exp_f32 v135, v135
    v_exp_f32 v136, v136
    s_setprio 2
    buffer_load_dwordx4 v[184:187], v1, s[20:23], s10 offen offset:3072
    s_add_u32 s10, s10, 0x10000
    v_exp_f32 v137, v137
    v_smfmac_f32_32x32x32_bf16 v[240:255], v[104:107], v[128:135], v164
    v_exp_f32 v138, v138
    v_exp_f32 v139, v139
    v_exp_f32 v140, v140
    v_exp_f32 v141, v141
    v_exp_f32 v142, v142
    v_exp_f32 v143, v143
    v_exp_f32 v112, v112
    v_exp_f32 v113, v113
    v_smfmac_f32_32x32x32_bf16 v[240:255], v[108:111], v[136:143], v164
    v_exp_f32 v114, v114
    buffer_load_dwordx4 v[188:191], v1, s[20:23], s11 offen offset:0
    v_exp_f32 v115, v115
    v_mfma_f32_32x32x16_bf16 v[128:143], v[20:23], v[168:171], 0
    v_exp_f32 v116, v116
    v_exp_f32 v117, v117
    v_exp_f32 v118, v118
    v_exp_f32 v119, v119
    v_exp_f32 v120, v120
    v_exp_f32 v121, v121
    v_smfmac_f32_32x32x32_bf16 v[144:159], v[48:51], v[112:119], v164
    v_exp_f32 v122, v122
    v_exp_f32 v123, v123
    ds_write_b128 v4, v[240:243] offset:28672
    v_exp_f32 v124, v124
    ds_write_b128 v4, v[244:247] offset:28704
    v_exp_f32 v125, v125
    s_setprio 1
    ds_write_b32 v5, v248 offset:54272
    v_exp_f32 v126, v126
    v_exp_f32 v127, v127
    v_exp_f32 v128, v128
    buffer_load_dwordx4 v[192:195], v1, s[20:23], s11 offen offset:1024
    v_exp_f32 v129, v129
    v_smfmac_f32_32x32x32_bf16 v[144:159], v[52:55], v[120:127], v164
    v_exp_f32 v130, v130
    v_exp_f32 v131, v131
    v_mfma_f32_32x32x16_bf16 v[112:127], v[24:27], v[168:171], 0
    v_exp_f32 v132, v132
    v_exp_f32 v133, v133
    v_exp_f32 v134, v134
    v_mfma_f32_32x32x16_bf16 v[240:255], v[160:163], v[160:163], 0
    v_exp_f32 v135, v135
    v_exp_f32 v136, v136
    v_exp_f32 v137, v137
    v_smfmac_f32_32x32x32_bf16 v[144:159], v[56:59], v[128:135], v164
    s_setprio 0
    v_exp_f32 v138, v138
    buffer_load_dwordx4 v[196:199], v1, s[20:23], s11 offen offset:2048
    v_exp_f32 v139, v139
    v_exp_f32 v140, v140
    v_exp_f32 v141, v141
    v_exp_f32 v142, v142
    v_exp_f32 v143, v143
    s_setprio 3
    v_exp_f32 v112, v112
    buffer_load_dwordx4 v[200:203], v1, s[20:23], s11 offen offset:3072
    s_add_u32 s11, s11, 0x10000
    v_exp_f32 v113, v113
    v_smfmac_f32_32x32x32_bf16 v[144:159], v[60:63], v[136:143], v164
    v_exp_f32 v114, v114
    v_exp_f32 v115, v115
    v_mfma_f32_32x32x16_bf16 v[128:143], v[28:31], v[168:171], 0
    v_exp_f32 v116, v116
    v_exp_f32 v117, v117
    v_exp_f32 v118, v118
    ds_read_b32 v10, v239 offset:54272
    ds_read2st64_b32 v[220:221], v6 offset0:80 offset1:90
    ds_read2st64_b32 v[222:223], v6 offset0:100 offset1:110
    ds_read2st64_b32 v[224:225], v6 offset0:120 offset1:130
    ds_read2st64_b32 v[226:227], v6 offset0:140 offset1:150
    ds_read_b128 v[228:231], v237 offset:57344
    v_exp_f32 v119, v119
    v_exp_f32 v120, v120
    v_exp_f32 v121, v121
    v_smfmac_f32_32x32x32_bf16 v[144:159], v[64:67], v[112:119], v164
    v_exp_f32 v122, v122
    v_exp_f32 v123, v123
    v_exp_f32 v124, v124
    v_exp_f32 v125, v125
    v_exp_f32 v126, v126
    v_exp_f32 v127, v127
    v_exp_f32 v128, v128
    v_exp_f32 v129, v129
    s_waitcnt lgkmcnt(0)
    v_cmp_gt_f32 vcc, 0, v10
    s_cbranch_vccnz A2_SP5
A2_OK5:
    v_add_f32 v10, v10, v10 quad_perm:[1,0,3,2] row_mask:0xf bank_mask:0xf
    v_pk_add_f32 v[220:221], v[220:221], v[222:223]
    v_pk_add_f32 v[224:225], v[224:225], v[226:227]
    v_add_f32 v10, v10, v10 quad_perm:[2,3,0,1] row_mask:0xf bank_mask:0xf
    v_pk_add_f32 v[220:221], v[220:221], v[224:225]
    v_add_f32 v220, v220, v221
    v_add_f32 v10, v10, v10 row_half_mirror row_mask:0xf bank_mask:0xf
    v_rcp_f32 v221, v10
    v_smfmac_f32_32x32x32_bf16 v[144:159], v[68:71], v[120:127], v164
    v_exp_f32 v130, v130
    v_mul_f32 v220, v220, v221
    v_max3_f32 v238, v238, v10, v221
    v_cvt_pk_bf16_f32 v220, v220, v220
    ds_write_b16 v236, v220 offset:58624
    v_exp_f32 v131, v131
    v_mfma_f32_32x32x16_bf16 v[112:127], v[32:35], v[168:171], 0
    v_exp_f32 v132, v132
    v_exp_f32 v133, v133
    v_exp_f32 v134, v134
    v_exp_f32 v135, v135
    v_exp_f32 v136, v136
    s_setprio 2
    v_exp_f32 v137, v137
    s_waitcnt vmcnt(6)
    v_smfmac_f32_16x16x64_bf16 v[204:207], v[228:231], v[172:179], v164 abid:1
    v_smfmac_f32_32x32x32_bf16 v[144:159], v[72:75], v[128:135], v164
    v_exp_f32 v138, v138
    v_exp_f32 v139, v139
    v_exp_f32 v140, v140
    v_exp_f32 v141, v141
    v_exp_f32 v142, v142
    v_exp_f32 v143, v143
    v_exp_f32 v112, v112
    s_waitcnt vmcnt(4)
    v_smfmac_f32_16x16x64_bf16 v[208:211], v[228:231], v[180:187], v164 abid:1
    v_exp_f32 v113, v113
    v_smfmac_f32_32x32x32_bf16 v[144:159], v[76:79], v[136:143], v164
    v_exp_f32 v114, v114
    v_exp_f32 v115, v115
    v_mfma_f32_32x32x16_bf16 v[128:143], v[36:39], v[168:171], 0
    buffer_load_dwordx4 v[172:175], v1, s[20:23], s10 offen offset:0
    v_exp_f32 v116, v116
    v_exp_f32 v117, v117
    v_exp_f32 v118, v118
    v_exp_f32 v119, v119
    v_exp_f32 v120, v120
    s_waitcnt vmcnt(3)
    v_smfmac_f32_16x16x64_bf16 v[212:215], v[228:231], v[188:195], v164 abid:1
    v_exp_f32 v121, v121
    v_smfmac_f32_32x32x32_bf16 v[144:159], v[80:83], v[112:119], v164
    v_exp_f32 v122, v122
    v_exp_f32 v123, v123
    buffer_load_dwordx4 v[176:179], v1, s[20:23], s10 offen offset:1024
    v_exp_f32 v124, v124
    v_exp_f32 v125, v125
    s_setprio 1
    v_exp_f32 v126, v126
    v_exp_f32 v127, v127
    v_exp_f32 v128, v128
    s_waitcnt vmcnt(2)
    v_smfmac_f32_16x16x64_bf16 v[216:219], v[228:231], v[196:203], v164 abid:1
    v_exp_f32 v129, v129
    v_smfmac_f32_32x32x32_bf16 v[144:159], v[84:87], v[120:127], v164
    v_exp_f32 v130, v130
    v_exp_f32 v131, v131
    v_mfma_f32_32x32x16_bf16 v[112:127], v[40:43], v[168:171], 0
    buffer_load_dwordx4 v[180:183], v1, s[20:23], s10 offen offset:2048
    v_exp_f32 v132, v132
    v_exp_f32 v133, v133
    v_exp_f32 v134, v134
    v_exp_f32 v135, v135
    v_exp_f32 v136, v136
    v_exp_f32 v137, v137
    v_smfmac_f32_32x32x32_bf16 v[144:159], v[88:91], v[128:135], v164
    s_setprio 0
    v_exp_f32 v138, v138
    v_exp_f32 v139, v139
    buffer_load_dwordx4 v[184:187], v1, s[20:23], s10 offen offset:3072
    s_add_u32 s10, s10, 0x10000
    v_exp_f32 v140, v140
    v_exp_f32 v141, v141
    v_exp_f32 v142, v142
    v_exp_f32 v143, v143
    s_setprio 3
    v_exp_f32 v112, v112
    v_exp_f32 v113, v113
    v_smfmac_f32_32x32x32_bf16 v[144:159], v[92:95], v[136:143], v164
    v_exp_f32 v114, v114
    buffer_load_dwordx4 v[188:191], v1, s[20:23], s11 offen offset:0
    v_exp_f32 v115, v115
    v_mfma_f32_32x32x16_bf16 v[128:143], v[44:47], v[168:171], 0
    v_exp_f32 v116, v116
    ds_read_b128 v[168:171], v1 offset:7168
    v_exp_f32 v117, v117
    v_exp_f32 v118, v118
    v_exp_f32 v119, v119
    v_exp_f32 v120, v120
    v_exp_f32 v121, v121
    v_smfmac_f32_32x32x32_bf16 v[144:159], v[96:99], v[112:119], v164
    v_exp_f32 v122, v122
    buffer_load_dwordx4 v[192:195], v1, s[20:23], s11 offen offset:1024
    v_exp_f32 v123, v123
    v_exp_f32 v124, v124
    v_exp_f32 v125, v125
    v_exp_f32 v126, v126
    v_exp_f32 v127, v127
    v_exp_f32 v128, v128
    buffer_load_dwordx4 v[196:199], v1, s[20:23], s11 offen offset:2048
    v_exp_f32 v129, v129
    v_smfmac_f32_32x32x32_bf16 v[144:159], v[100:103], v[120:127], v164
    v_exp_f32 v130, v130
    v_exp_f32 v131, v131
    s_waitcnt lgkmcnt(0)
    v_mfma_f32_32x32x16_bf16 v[112:127], v[16:19], v[168:171], 0
    v_exp_f32 v132, v132
    v_exp_f32 v133, v133
    v_exp_f32 v134, v134
    v_exp_f32 v135, v135
    v_exp_f32 v136, v136
    s_setprio 2
    buffer_load_dwordx4 v[200:203], v1, s[20:23], s11 offen offset:3072
    s_add_u32 s11, s11, 0x10000
    v_exp_f32 v137, v137
    v_smfmac_f32_32x32x32_bf16 v[144:159], v[104:107], v[128:135], v164
    v_exp_f32 v138, v138
    v_exp_f32 v139, v139
    v_exp_f32 v140, v140
    v_exp_f32 v141, v141
    v_exp_f32 v142, v142
    s_waitcnt vmcnt(48)
    v_cmp_u_f32 vcc, v232, v234
    s_cbranch_vccnz A2_CKres_R
A2_CKres_K:
    v_exp_f32 v143, v143
    v_exp_f32 v112, v112
    v_exp_f32 v113, v113
    v_smfmac_f32_32x32x32_bf16 v[144:159], v[108:111], v[136:143], v164
    v_exp_f32 v114, v114
    v_exp_f32 v115, v115
    v_mfma_f32_32x32x16_bf16 v[128:143], v[20:23], v[168:171], 0
    v_exp_f32 v116, v116
    buffer_load_dwordx4 v[16:19], v1, s[20:23], s10 offen offset:0
    v_exp_f32 v117, v117
    v_exp_f32 v118, v118
    v_exp_f32 v119, v119
    v_exp_f32 v120, v120
    v_exp_f32 v121, v121
    buffer_load_dwordx4 v[20:23], v1, s[20:23], s10 offen offset:1024
    v_smfmac_f32_32x32x32_bf16 v[240:255], v[48:51], v[112:119], v164
    v_exp_f32 v122, v122
    v_exp_f32 v123, v123
    ds_write_b128 v4, v[144:147] offset:8192
    v_exp_f32 v124, v124
    ds_write_b128 v4, v[148:151] offset:8224
    v_exp_f32 v125, v125
    s_setprio 1
    ds_write_b32 v5, v152 offset:55296
    v_exp_f32 v126, v126
    v_exp_f32 v127, v127
    v_exp_f32 v128, v128
    v_exp_f32 v129, v129
    v_smfmac_f32_32x32x32_bf16 v[240:255], v[52:55], v[120:127], v164
    v_exp_f32 v130, v130
    v_exp_f32 v131, v131
    buffer_load_dwordx4 v[48:51], v1, s[20:23], s10 offen offset:2048
    v_mfma_f32_32x32x16_bf16 v[112:127], v[24:27], v[168:171], 0
    v_exp_f32 v132, v132
    v_exp_f32 v133, v133
    v_exp_f32 v134, v134
    v_exp_f32 v135, v135
    v_exp_f32 v136, v136
    v_exp_f32 v137, v137
    v_smfmac_f32_32x32x32_bf16 v[240:255], v[56:59], v[128:135], v164
    s_setprio 0
    v_exp_f32 v138, v138
    buffer_load_dwordx4 v[52:55], v1, s[20:23], s10 offen offset:3072
    s_add_u32 s10, s10, 0x10000
    v_exp_f32 v139, v139
    v_exp_f32 v140, v140
    v_exp_f32 v141, v141
    v_exp_f32 v142, v142
    v_exp_f32 v143, v143
    s_setprio 3
    v_exp_f32 v112, v112
    v_exp_f32 v113, v113
    v_smfmac_f32_32x32x32_bf16 v[240:255], v[60:63], v[136:143], v164
    v_exp_f32 v114, v114
    v_exp_f32 v115, v115
    buffer_load_dwordx4 v[56:59], v1, s[20:23], s11 offen offset:0
    v_mfma_f32_32x32x16_bf16 v[128:143], v[28:31], v[168:171], 0
    v_exp_f32 v116, v116
    v_exp_f32 v117, v117
    v_exp_f32 v118, v118
    ds_read_b32 v10, v239 offset:55296
    ds_read2st64_b32 v[220:221], v6 offset0:0 offset1:10
    ds_read2st64_b32 v[222:223], v6 offset0:20 offset1:30
    ds_read2st64_b32 v[224:225], v6 offset0:40 offset1:50
    ds_read2st64_b32 v[226:227], v6 offset0:60 offset1:70
    ds_read_b128 v[228:231], v237 offset:58624
    v_exp_f32 v119, v119
    v_exp_f32 v120, v120
    v_exp_f32 v121, v121
    v_smfmac_f32_32x32x32_bf16 v[240:255], v[64:67], v[112:119], v164
    v_exp_f32 v122, v122
    buffer_load_dwordx4 v[60:63], v1, s[20:23], s11 offen offset:1024
    v_exp_f32 v123, v123
    v_exp_f32 v124, v124
    v_exp_f32 v125, v125
    v_exp_f32 v126, v126
    v_exp_f32 v127, v127
    v_exp_f32 v128, v128
    v_exp_f32 v129, v129
    s_waitcnt lgkmcnt(0)
    v_cmp_gt_f32 vcc, 0, v10
    s_cbranch_vccnz A2_SP6
A2_OK6:
    v_add_f32 v10, v10, v10 quad_perm:[1,0,3,2] row_mask:0xf bank_mask:0xf
    v_pk_add_f32 v[220:221], v[220:221], v[222:223]
    v_pk_add_f32 v[224:225], v[224:225], v[226:227]
    v_add_f32 v10, v10, v10 quad_perm:[2,3,0,1] row_mask:0xf bank_mask:0xf
    v_pk_add_f32 v[220:221], v[220:221], v[224:225]
    v_add_f32 v220, v220, v221
    v_add_f32 v10, v10, v10 row_half_mirror row_mask:0xf bank_mask:0xf
    v_rcp_f32 v221, v10
    v_smfmac_f32_32x32x32_bf16 v[240:255], v[68:71], v[120:127], v164
    v_exp_f32 v130, v130
    v_mul_f32 v220, v220, v221
    v_max3_f32 v238, v238, v10, v221
    v_cvt_pk_bf16_f32 v220, v220, v220
    ds_write_b16 v236, v220 offset:57344
    v_exp_f32 v131, v131
    v_mfma_f32_32x32x16_bf16 v[112:127], v[32:35], v[168:171], 0
    v_exp_f32 v132, v132
    v_exp_f32 v133, v133
    buffer_load_dwordx4 v[24:27], v1, s[20:23], s11 offen offset:2048
    v_exp_f32 v134, v134
    v_exp_f32 v135, v135
    v_exp_f32 v136, v136
    s_setprio 2
    v_exp_f32 v137, v137
    s_waitcnt vmcnt(13)
    v_smfmac_f32_16x16x64_bf16 v[204:207], v[228:231], v[172:179], v164 abid:1
    v_smfmac_f32_32x32x32_bf16 v[240:255], v[72:75], v[128:135], v164
    v_exp_f32 v138, v138
    v_exp_f32 v139, v139
    v_exp_f32 v140, v140
    buffer_load_dwordx4 v[28:31], v1, s[20:23], s11 offen offset:3072
    s_add_u32 s11, s11, 0x10000
    v_exp_f32 v141, v141
    v_exp_f32 v142, v142
    v_exp_f32 v143, v143
    v_exp_f32 v112, v112
    s_waitcnt vmcnt(12)
    v_smfmac_f32_16x16x64_bf16 v[208:211], v[228:231], v[180:187], v164 abid:1
    v_exp_f32 v113, v113
    v_smfmac_f32_32x32x32_bf16 v[240:255], v[76:79], v[136:143], v164
    v_exp_f32 v114, v114
    v_exp_f32 v115, v115
    v_mfma_f32_32x32x16_bf16 v[128:143], v[36:39], v[168:171], 0
    buffer_load_dwordx4 v[172:175], v1, s[20:23], s30 offen offset:0
    v_exp_f32 v116, v116
    v_exp_f32 v117, v117
    v_exp_f32 v118, v118
    v_exp_f32 v119, v119
    v_exp_f32 v120, v120
    s_waitcnt vmcnt(11)
    v_smfmac_f32_16x16x64_bf16 v[212:215], v[228:231], v[188:195], v164 abid:1
    v_exp_f32 v121, v121
    v_smfmac_f32_32x32x32_bf16 v[240:255], v[80:83], v[112:119], v164
    v_exp_f32 v122, v122
    v_exp_f32 v123, v123
    buffer_load_dwordx4 v[176:179], v1, s[20:23], s30 offen offset:1024
    v_exp_f32 v124, v124
    v_exp_f32 v125, v125
    s_setprio 1
    v_exp_f32 v126, v126
    v_exp_f32 v127, v127
    v_exp_f32 v128, v128
    s_waitcnt vmcnt(10)
    v_smfmac_f32_16x16x64_bf16 v[216:219], v[228:231], v[196:203], v164 abid:1
    v_exp_f32 v129, v129
    v_smfmac_f32_32x32x32_bf16 v[240:255], v[84:87], v[120:127], v164
    v_exp_f32 v130, v130
    v_exp_f32 v131, v131
    v_mfma_f32_32x32x16_bf16 v[112:127], v[40:43], v[168:171], 0
    buffer_load_dwordx4 v[180:183], v1, s[20:23], s30 offen offset:2048
    v_exp_f32 v132, v132
    v_exp_f32 v133, v133
    v_exp_f32 v134, v134
    v_exp_f32 v135, v135
    v_exp_f32 v136, v136
    v_exp_f32 v137, v137
    v_smfmac_f32_32x32x32_bf16 v[240:255], v[88:91], v[128:135], v164
    s_setprio 0
    v_exp_f32 v138, v138
    v_exp_f32 v139, v139
    buffer_load_dwordx4 v[184:187], v1, s[20:23], s30 offen offset:3072
    v_exp_f32 v140, v140
    v_exp_f32 v141, v141
    v_exp_f32 v142, v142
    v_exp_f32 v143, v143
    s_setprio 3
    v_exp_f32 v112, v112
    v_exp_f32 v113, v113
    v_smfmac_f32_32x32x32_bf16 v[240:255], v[92:95], v[136:143], v164
    v_exp_f32 v114, v114
    buffer_load_dwordx4 v[188:191], v1, s[20:23], s31 offen offset:0
    v_exp_f32 v115, v115
    v_mfma_f32_32x32x16_bf16 v[128:143], v[44:47], v[168:171], 0
    v_exp_f32 v116, v116
    v_exp_f32 v117, v117
    v_exp_f32 v118, v118
    v_exp_f32 v119, v119
    v_exp_f32 v120, v120
    v_exp_f32 v121, v121
    v_smfmac_f32_32x32x32_bf16 v[240:255], v[96:99], v[112:119], v164
    v_exp_f32 v122, v122
    buffer_load_dwordx4 v[192:195], v1, s[20:23], s31 offen offset:1024
    v_exp_f32 v123, v123
    v_exp_f32 v124, v124
    v_exp_f32 v125, v125
    v_exp_f32 v126, v126
    v_exp_f32 v127, v127
    v_exp_f32 v128, v128
    v_exp_f32 v129, v129
    v_smfmac_f32_32x32x32_bf16 v[240:255], v[100:103], v[120:127], v164
    v_exp_f32 v130, v130
    buffer_load_dwordx4 v[196:199], v1, s[20:23], s31 offen offset:2048
    v_exp_f32 v131, v131
    v_exp_f32 v132, v132
    v_exp_f32 v133, v133
    v_exp_f32 v134, v134
    v_exp_f32 v135, v135
    v_exp_f32 v136, v136
    s_setprio 2
    v_exp_f32 v137, v137
    v_smfmac_f32_32x32x32_bf16 v[240:255], v[104:107], v[128:135], v164
    v_exp_f32 v138, v138
    buffer_load_dwordx4 v[200:203], v1, s[20:23], s31 offen offset:3072
    v_exp_f32 v139, v139
    v_exp_f32 v140, v140
    v_exp_f32 v141, v141
    v_exp_f32 v142, v142
    v_exp_f32 v143, v143
    s_nop 1
    v_smfmac_f32_32x32x32_bf16 v[240:255], v[108:111], v[136:143], v164
    s_mov_b32 s29, 0x67800000
    v_mov_b32 v12, 1
    s_lshr_b32 s13, s4, 7
    s_lshl_b32 s13, s13, 10
    s_lshr_b32 s24, s4, 4
    s_and_b32 s24, s24, 3
    s_lshl_b32 s24, s24, 8
    s_add_u32 s13, s13, s24
    s_lshr_b32 s24, s4, 6
    s_and_b32 s24, s24, 1
    s_lshl_b32 s24, s24, 4
    s_add_u32 s13, s13, s24
    s_and_b32 s24, s4, 15
    ds_write_b128 v4, v[240:243] offset:28672
    ds_write_b128 v4, v[244:247] offset:28704
    ds_write_b32 v5, v248 offset:56320
    v_lshlrev_b32 v112, 16, v232
    v_and_b32 v113, 0xffff0000, v232
    v_lshlrev_b32 v114, 16, v233
    v_and_b32 v115, 0xffff0000, v233
    v_lshlrev_b32 v116, 16, v234
    v_and_b32 v117, 0xffff0000, v234
    v_lshlrev_b32 v118, 16, v235
    v_and_b32 v119, 0xffff0000, v235
    s_waitcnt lgkmcnt(0)
    s_barrier
    ds_read_b32 v10, v239 offset:56320
    ds_read2st64_b32 v[220:221], v6 offset0:80 offset1:90
    ds_read2st64_b32 v[222:223], v6 offset0:100 offset1:110
    ds_read2st64_b32 v[224:225], v6 offset0:120 offset1:130
    ds_read2st64_b32 v[226:227], v6 offset0:140 offset1:150
    ds_read_b128 v[228:231], v237 offset:57344
    s_add_u32 s13, s13, s24
    s_lshl_b32 s13, s13, 10
    s_lshl_b32 s24, s3, 7
    s_add_u32 s13, s13, s24
    v_and_b32 v8, 16, v0
    v_lshlrev_b32 v8, 13, v8
    v_lshl_add_u32 v8, v2, 2, v8
    v_and_b32 v165, 32, v0
    v_lshl_add_u32 v8, v165, 1, v8
    s_add_u32 s26, s13, 0x8000
    s_add_u32 s27, s13, 0x10000
    s_add_u32 s28, s13, 0x18000
    s_mov_b32 s18, 0x200000
    s_mov_b32 s19, 0x20000
    s_waitcnt vmcnt(8)
    s_waitcnt lgkmcnt(1)
    v_add_f32 v10, v10, v10 quad_perm:[1,0,3,2] row_mask:0xf bank_mask:0xf
    v_pk_add_f32 v[220:221], v[220:221], v[222:223]
    v_pk_add_f32 v[224:225], v[224:225], v[226:227]
    s_waitcnt lgkmcnt(0)
    v_smfmac_f32_16x16x64_bf16 v[204:207], v[228:231], v[16:23], v164 abid:1
    v_add_f32 v10, v10, v10 quad_perm:[2,3,0,1] row_mask:0xf bank_mask:0xf
    v_pk_add_f32 v[220:221], v[220:221], v[224:225]
    v_add_f32 v220, v220, v221
    v_smfmac_f32_16x16x64_bf16 v[208:211], v[228:231], v[48:55], v164 abid:1
    v_add_f32 v10, v10, v10 row_half_mirror row_mask:0xf bank_mask:0xf
    v_rcp_f32 v221, v10
    v_smfmac_f32_16x16x64_bf16 v[212:215], v[228:231], v[56:63], v164 abid:1
    v_mul_f32 v220, v220, v221
    v_max3_f32 v238, v238, v10, v221
    v_cvt_pk_bf16_f32 v220, v220, v220
    ds_write_b16 v236, v220 offset:58624
    v_smfmac_f32_16x16x64_bf16 v[216:219], v[228:231], v[24:31], v164 abid:1
    v_cmp_lt_f32 vcc, s29, v238
    s_and_saveexec_b64 s[24:25], vcc
    ds_write_b32 v11, v12 offset:60416
    s_mov_b64 exec, -1
    s_waitcnt lgkmcnt(0)
    s_barrier
    ds_read_b32 v12, v11 offset:60416
    ds_read_b128 v[228:231], v237 offset:58624
    s_waitcnt vmcnt(0)
    s_waitcnt lgkmcnt(0)
    v_cmp_ne_u32 vcc, 0, v12
    v_smfmac_f32_16x16x64_bf16 v[204:207], v[228:231], v[172:179], v164 abid:1
    v_smfmac_f32_16x16x64_bf16 v[208:211], v[228:231], v[180:187], v164 abid:1
    v_smfmac_f32_16x16x64_bf16 v[212:215], v[228:231], v[188:195], v164 abid:1
    v_smfmac_f32_16x16x64_bf16 v[216:219], v[228:231], v[196:203], v164 abid:1
    s_cbranch_vccnz A2_SLOW
A2_FIN:
    s_nop 5
    v_permlane32_swap_b32 v204, v212
    v_permlane32_swap_b32 v205, v213
    v_permlane32_swap_b32 v206, v214
    v_permlane32_swap_b32 v207, v215
    v_permlane32_swap_b32 v208, v216
    v_permlane32_swap_b32 v209, v217
    v_permlane32_swap_b32 v210, v218
    v_permlane32_swap_b32 v211, v219
    v_pk_add_f32 v[112:113], v[112:113], v[204:205]
    v_pk_add_f32 v[114:115], v[114:115], v[206:207]
    v_pk_add_f32 v[116:117], v[116:117], v[208:209]
    v_pk_add_f32 v[118:119], v[118:119], v[210:211]
    v_pk_add_f32 v[112:113], v[112:113], v[212:213]
    v_pk_add_f32 v[114:115], v[114:115], v[214:215]
    v_pk_add_f32 v[116:117], v[116:117], v[216:217]
    v_pk_add_f32 v[118:119], v[118:119], v[218:219]
    v_cvt_pk_bf16_f32 v224, v112, v116
    buffer_store_dword v224, v8, s[16:19], s13 offen
    v_cvt_pk_bf16_f32 v225, v113, v117
    buffer_store_dword v225, v8, s[16:19], s26 offen
    v_cvt_pk_bf16_f32 v226, v114, v118
    buffer_store_dword v226, v8, s[16:19], s27 offen
    v_cvt_pk_bf16_f32 v227, v115, v119
    buffer_store_dword v227, v8, s[16:19], s28 offen
    s_endpgm
A2_SP0:
    ds_read_b32 v10, v239 offset:49152
    ds_read2st64_b32 v[220:221], v6 offset0:0 offset1:10
    ds_read2st64_b32 v[222:223], v6 offset0:20 offset1:30
    ds_read2st64_b32 v[224:225], v6 offset0:40 offset1:50
    ds_read2st64_b32 v[226:227], v6 offset0:60 offset1:70
    ds_read_b128 v[168:171], v1 offset:2048
    s_waitcnt lgkmcnt(0)
    v_cmp_gt_f32 vcc, 0, v10
    s_cbranch_vccnz A2_SP0
    s_branch A2_OK0
A2_SP1:
    ds_read_b32 v10, v239 offset:50176
    ds_read2st64_b32 v[220:221], v6 offset0:80 offset1:90
    ds_read2st64_b32 v[222:223], v6 offset0:100 offset1:110
    ds_read2st64_b32 v[224:225], v6 offset0:120 offset1:130
    ds_read2st64_b32 v[226:227], v6 offset0:140 offset1:150
    ds_read_b128 v[228:231], v237 offset:57344
    s_waitcnt lgkmcnt(0)
    v_cmp_gt_f32 vcc, 0, v10
    s_cbranch_vccnz A2_SP1
    s_branch A2_OK1
A2_SP2:
    ds_read_b32 v10, v239 offset:51200
    ds_read2st64_b32 v[220:221], v6 offset0:0 offset1:10
    ds_read2st64_b32 v[222:223], v6 offset0:20 offset1:30
    ds_read2st64_b32 v[224:225], v6 offset0:40 offset1:50
    ds_read2st64_b32 v[226:227], v6 offset0:60 offset1:70
    ds_read_b128 v[228:231], v237 offset:58624
    s_waitcnt lgkmcnt(0)
    v_cmp_gt_f32 vcc, 0, v10
    s_cbranch_vccnz A2_SP2
    s_branch A2_OK2
A2_SP3:
    ds_read_b32 v10, v239 offset:52224
    ds_read2st64_b32 v[220:221], v6 offset0:80 offset1:90
    ds_read2st64_b32 v[222:223], v6 offset0:100 offset1:110
    ds_read2st64_b32 v[224:225], v6 offset0:120 offset1:130
    ds_read2st64_b32 v[226:227], v6 offset0:140 offset1:150
    ds_read_b128 v[228:231], v237 offset:57344
    s_waitcnt lgkmcnt(0)
    v_cmp_gt_f32 vcc, 0, v10
    s_cbranch_vccnz A2_SP3
    s_branch A2_OK3
A2_SP4:
    ds_read_b32 v10, v239 offset:53248
    ds_read2st64_b32 v[220:221], v6 offset0:0 offset1:10
    ds_read2st64_b32 v[222:223], v6 offset0:20 offset1:30
    ds_read2st64_b32 v[224:225], v6 offset0:40 offset1:50
    ds_read2st64_b32 v[226:227], v6 offset0:60 offset1:70
    ds_read_b128 v[228:231], v237 offset:58624
    s_waitcnt lgkmcnt(0)
    v_cmp_gt_f32 vcc, 0, v10
    s_cbranch_vccnz A2_SP4
    s_branch A2_OK4
A2_SP5:
    ds_read_b32 v10, v239 offset:54272
    ds_read2st64_b32 v[220:221], v6 offset0:80 offset1:90
    ds_read2st64_b32 v[222:223], v6 offset0:100 offset1:110
    ds_read2st64_b32 v[224:225], v6 offset0:120 offset1:130
    ds_read2st64_b32 v[226:227], v6 offset0:140 offset1:150
    ds_read_b128 v[228:231], v237 offset:57344
    s_waitcnt lgkmcnt(0)
    v_cmp_gt_f32 vcc, 0, v10
    s_cbranch_vccnz A2_SP5
    s_branch A2_OK5
A2_SP6:
    ds_read_b32 v10, v239 offset:55296
    ds_read2st64_b32 v[220:221], v6 offset0:0 offset1:10
    ds_read2st64_b32 v[222:223], v6 offset0:20 offset1:30
    ds_read2st64_b32 v[224:225], v6 offset0:40 offset1:50
    ds_read2st64_b32 v[226:227], v6 offset0:60 offset1:70
    ds_read_b128 v[228:231], v237 offset:58624
    s_waitcnt lgkmcnt(0)
    v_cmp_gt_f32 vcc, 0, v10
    s_cbranch_vccnz A2_SP6
    s_branch A2_OK6
A2_CKq0_R:
    s_cmp_eq_u32 s41, 0
    s_cbranch_scc1 A2_CKq0_K
    s_sub_u32 s41, s41, 1
    buffer_load_dwordx4 v[168:171], v1, s[20:23], s5 offen sc1
    buffer_load_dwordx4 v[16:19], v1, s[20:23], s6 offen offset:0 sc1
    buffer_load_dwordx4 v[228:231], v1, s[20:23], s5 offen offset:1024 sc1
    s_mov_b64 exec, s[32:33]
    buffer_load_dwordx4 v[48:51], v1, s[20:23], s8 offen offset:0 sc1
    buffer_load_dwordx4 v[52:55], v1, s[20:23], s8 offen offset:256 sc1
    s_mov_b64 exec, -1
    buffer_load_dwordx4 v[20:23], v1, s[20:23], s6 offen offset:1024 sc1
    s_waitcnt vmcnt(0)
    v_cmp_u_f32 vcc, v168, v170
    s_cbranch_vccnz A2_CKq0_R
    v_cmp_u_f32 vcc, v16, v18
    s_cbranch_vccnz A2_CKq0_R
    s_branch A2_CKq0_K
A2_CKq1_R:
    s_cmp_eq_u32 s41, 0
    s_cbranch_scc1 A2_CKq1_K
    s_sub_u32 s41, s41, 1
    buffer_load_dwordx4 v[228:231], v1, s[20:23], s5 offen offset:1024 sc1
    s_mov_b64 exec, s[32:33]
    buffer_load_dwordx4 v[48:51], v1, s[20:23], s8 offen offset:0 sc1
    buffer_load_dwordx4 v[52:55], v1, s[20:23], s8 offen offset:256 sc1
    s_mov_b64 exec, -1
    buffer_load_dwordx4 v[20:23], v1, s[20:23], s6 offen offset:1024 sc1
    s_mov_b64 exec, s[32:33]
    buffer_load_dwordx4 v[56:59], v1, s[20:23], s8 offen offset:1024 sc1
    buffer_load_dwordx4 v[60:63], v1, s[20:23], s8 offen offset:1280 sc1
    s_mov_b64 exec, -1
    s_waitcnt vmcnt(0)
    v_cmp_u_f32 vcc, v228, v230
    s_cbranch_vccnz A2_CKq1_R
    s_branch A2_CKq1_K
A2_CKv0_R:
    s_cmp_eq_u32 s41, 0
    s_cbranch_scc1 A2_CKv0_K
    s_sub_u32 s41, s41, 1
    s_mov_b64 exec, s[32:33]
    buffer_load_dwordx4 v[48:51], v1, s[20:23], s8 offen offset:0 sc1
    buffer_load_dwordx4 v[52:55], v1, s[20:23], s8 offen offset:256 sc1
    s_mov_b64 exec, -1
    buffer_load_dwordx4 v[20:23], v1, s[20:23], s6 offen offset:1024 sc1
    s_mov_b64 exec, s[32:33]
    buffer_load_dwordx4 v[56:59], v1, s[20:23], s8 offen offset:1024 sc1
    buffer_load_dwordx4 v[60:63], v1, s[20:23], s8 offen offset:1280 sc1
    s_mov_b64 exec, -1
    buffer_load_dwordx4 v[24:27], v1, s[20:23], s6 offen offset:2048 sc1
    s_waitcnt vmcnt(0)
    v_cmp_u_f32 vcc, v48, v50
    s_cbranch_vccnz A2_CKv0_R
    v_cmp_u_f32 vcc, v52, v54
    s_cbranch_vccnz A2_CKv0_R
    s_branch A2_CKv0_K
A2_CKk1_R:
    s_cmp_eq_u32 s41, 0
    s_cbranch_scc1 A2_CKk1_K
    s_sub_u32 s41, s41, 1
    buffer_load_dwordx4 v[20:23], v1, s[20:23], s6 offen offset:1024 sc1
    s_mov_b64 exec, s[32:33]
    buffer_load_dwordx4 v[56:59], v1, s[20:23], s8 offen offset:1024 sc1
    buffer_load_dwordx4 v[60:63], v1, s[20:23], s8 offen offset:1280 sc1
    s_mov_b64 exec, -1
    buffer_load_dwordx4 v[24:27], v1, s[20:23], s6 offen offset:2048 sc1
    s_mov_b64 exec, s[32:33]
    buffer_load_dwordx4 v[64:67], v1, s[20:23], s8 offen offset:2048 sc1
    buffer_load_dwordx4 v[68:71], v1, s[20:23], s8 offen offset:2304 sc1
    s_mov_b64 exec, -1
    s_waitcnt vmcnt(0)
    v_cmp_u_f32 vcc, v20, v22
    s_cbranch_vccnz A2_CKk1_R
    s_branch A2_CKk1_K
A2_CKv1_R:
    s_cmp_eq_u32 s41, 0
    s_cbranch_scc1 A2_CKv1_K
    s_sub_u32 s41, s41, 1
    s_mov_b64 exec, s[32:33]
    buffer_load_dwordx4 v[56:59], v1, s[20:23], s8 offen offset:1024 sc1
    buffer_load_dwordx4 v[60:63], v1, s[20:23], s8 offen offset:1280 sc1
    s_mov_b64 exec, -1
    buffer_load_dwordx4 v[24:27], v1, s[20:23], s6 offen offset:2048 sc1
    s_mov_b64 exec, s[32:33]
    buffer_load_dwordx4 v[64:67], v1, s[20:23], s8 offen offset:2048 sc1
    buffer_load_dwordx4 v[68:71], v1, s[20:23], s8 offen offset:2304 sc1
    s_mov_b64 exec, -1
    buffer_load_dwordx4 v[28:31], v1, s[20:23], s6 offen offset:3072 sc1
    s_mov_b64 exec, s[32:33]
    buffer_load_dwordx4 v[72:75], v1, s[20:23], s8 offen offset:3072 sc1
    buffer_load_dwordx4 v[76:79], v1, s[20:23], s8 offen offset:3328 sc1
    s_mov_b64 exec, -1
    s_waitcnt vmcnt(0)
    v_cmp_u_f32 vcc, v56, v58
    s_cbranch_vccnz A2_CKv1_R
    v_cmp_u_f32 vcc, v60, v62
    s_cbranch_vccnz A2_CKv1_R
    s_branch A2_CKv1_K
A2_CKk2_R:
    s_cmp_eq_u32 s41, 0
    s_cbranch_scc1 A2_CKk2_K
    s_sub_u32 s41, s41, 1
    buffer_load_dwordx4 v[24:27], v1, s[20:23], s6 offen offset:2048 sc1
    s_mov_b64 exec, s[32:33]
    buffer_load_dwordx4 v[64:67], v1, s[20:23], s8 offen offset:2048 sc1
    buffer_load_dwordx4 v[68:71], v1, s[20:23], s8 offen offset:2304 sc1
    s_mov_b64 exec, -1
    buffer_load_dwordx4 v[28:31], v1, s[20:23], s6 offen offset:3072 sc1
    s_mov_b64 exec, s[32:33]
    buffer_load_dwordx4 v[72:75], v1, s[20:23], s8 offen offset:3072 sc1
    buffer_load_dwordx4 v[76:79], v1, s[20:23], s8 offen offset:3328 sc1
    s_mov_b64 exec, -1
    buffer_load_dwordx4 v[32:35], v1, s[20:23], s7 offen offset:0 sc1
    s_waitcnt vmcnt(0)
    v_cmp_u_f32 vcc, v24, v26
    s_cbranch_vccnz A2_CKk2_R
    s_branch A2_CKk2_K
A2_CKv2_R:
    s_cmp_eq_u32 s41, 0
    s_cbranch_scc1 A2_CKv2_K
    s_sub_u32 s41, s41, 1
    s_mov_b64 exec, s[32:33]
    buffer_load_dwordx4 v[64:67], v1, s[20:23], s8 offen offset:2048 sc1
    buffer_load_dwordx4 v[68:71], v1, s[20:23], s8 offen offset:2304 sc1
    s_mov_b64 exec, -1
    buffer_load_dwordx4 v[28:31], v1, s[20:23], s6 offen offset:3072 sc1
    s_mov_b64 exec, s[32:33]
    buffer_load_dwordx4 v[72:75], v1, s[20:23], s8 offen offset:3072 sc1
    buffer_load_dwordx4 v[76:79], v1, s[20:23], s8 offen offset:3328 sc1
    s_mov_b64 exec, -1
    buffer_load_dwordx4 v[32:35], v1, s[20:23], s7 offen offset:0 sc1
    s_mov_b64 exec, s[32:33]
    buffer_load_dwordx4 v[80:83], v1, s[20:23], s9 offen offset:0 sc1
    buffer_load_dwordx4 v[84:87], v1, s[20:23], s9 offen offset:256 sc1
    s_mov_b64 exec, -1
    buffer_load_dwordx4 v[36:39], v1, s[20:23], s7 offen offset:1024 sc1
    s_waitcnt vmcnt(0)
    v_cmp_u_f32 vcc, v64, v66
    s_cbranch_vccnz A2_CKv2_R
    v_cmp_u_f32 vcc, v68, v70
    s_cbranch_vccnz A2_CKv2_R
    s_branch A2_CKv2_K
A2_CKk3_R:
    s_cmp_eq_u32 s41, 0
    s_cbranch_scc1 A2_CKk3_K
    s_sub_u32 s41, s41, 1
    buffer_load_dwordx4 v[28:31], v1, s[20:23], s6 offen offset:3072 sc1
    s_mov_b64 exec, s[32:33]
    buffer_load_dwordx4 v[72:75], v1, s[20:23], s8 offen offset:3072 sc1
    buffer_load_dwordx4 v[76:79], v1, s[20:23], s8 offen offset:3328 sc1
    s_mov_b64 exec, -1
    buffer_load_dwordx4 v[32:35], v1, s[20:23], s7 offen offset:0 sc1
    s_mov_b64 exec, s[32:33]
    buffer_load_dwordx4 v[80:83], v1, s[20:23], s9 offen offset:0 sc1
    buffer_load_dwordx4 v[84:87], v1, s[20:23], s9 offen offset:256 sc1
    s_mov_b64 exec, -1
    buffer_load_dwordx4 v[36:39], v1, s[20:23], s7 offen offset:1024 sc1
    s_mov_b64 exec, s[32:33]
    buffer_load_dwordx4 v[88:91], v1, s[20:23], s9 offen offset:1024 sc1
    buffer_load_dwordx4 v[92:95], v1, s[20:23], s9 offen offset:1280 sc1
    s_mov_b64 exec, -1
    s_waitcnt vmcnt(0)
    v_cmp_u_f32 vcc, v28, v30
    s_cbranch_vccnz A2_CKk3_R
    s_branch A2_CKk3_K
A2_CKv3_R:
    s_cmp_eq_u32 s41, 0
    s_cbranch_scc1 A2_CKv3_K
    s_sub_u32 s41, s41, 1
    s_mov_b64 exec, s[32:33]
    buffer_load_dwordx4 v[72:75], v1, s[20:23], s8 offen offset:3072 sc1
    buffer_load_dwordx4 v[76:79], v1, s[20:23], s8 offen offset:3328 sc1
    s_mov_b64 exec, -1
    buffer_load_dwordx4 v[32:35], v1, s[20:23], s7 offen offset:0 sc1
    s_mov_b64 exec, s[32:33]
    buffer_load_dwordx4 v[80:83], v1, s[20:23], s9 offen offset:0 sc1
    buffer_load_dwordx4 v[84:87], v1, s[20:23], s9 offen offset:256 sc1
    s_mov_b64 exec, -1
    buffer_load_dwordx4 v[36:39], v1, s[20:23], s7 offen offset:1024 sc1
    s_mov_b64 exec, s[32:33]
    buffer_load_dwordx4 v[88:91], v1, s[20:23], s9 offen offset:1024 sc1
    buffer_load_dwordx4 v[92:95], v1, s[20:23], s9 offen offset:1280 sc1
    s_mov_b64 exec, -1
    buffer_load_dwordx4 v[40:43], v1, s[20:23], s7 offen offset:2048 sc1
    s_mov_b64 exec, s[32:33]
    buffer_load_dwordx4 v[96:99], v1, s[20:23], s9 offen offset:2048 sc1
    buffer_load_dwordx4 v[100:103], v1, s[20:23], s9 offen offset:2304 sc1
    s_mov_b64 exec, -1
    s_waitcnt vmcnt(0)
    v_cmp_u_f32 vcc, v72, v74
    s_cbranch_vccnz A2_CKv3_R
    v_cmp_u_f32 vcc, v76, v78
    s_cbranch_vccnz A2_CKv3_R
    s_branch A2_CKv3_K
A2_CKk4_R:
    s_cmp_eq_u32 s41, 0
    s_cbranch_scc1 A2_CKk4_K
    s_sub_u32 s41, s41, 1
    buffer_load_dwordx4 v[32:35], v1, s[20:23], s7 offen offset:0 sc1
    s_mov_b64 exec, s[32:33]
    buffer_load_dwordx4 v[80:83], v1, s[20:23], s9 offen offset:0 sc1
    buffer_load_dwordx4 v[84:87], v1, s[20:23], s9 offen offset:256 sc1
    s_mov_b64 exec, -1
    buffer_load_dwordx4 v[36:39], v1, s[20:23], s7 offen offset:1024 sc1
    s_mov_b64 exec, s[32:33]
    buffer_load_dwordx4 v[88:91], v1, s[20:23], s9 offen offset:1024 sc1
    buffer_load_dwordx4 v[92:95], v1, s[20:23], s9 offen offset:1280 sc1
    s_mov_b64 exec, -1
    buffer_load_dwordx4 v[40:43], v1, s[20:23], s7 offen offset:2048 sc1
    s_mov_b64 exec, s[32:33]
    buffer_load_dwordx4 v[96:99], v1, s[20:23], s9 offen offset:2048 sc1
    buffer_load_dwordx4 v[100:103], v1, s[20:23], s9 offen offset:2304 sc1
    s_mov_b64 exec, -1
    buffer_load_dwordx4 v[44:47], v1, s[20:23], s7 offen offset:3072 sc1
    s_waitcnt vmcnt(0)
    v_cmp_u_f32 vcc, v32, v34
    s_cbranch_vccnz A2_CKk4_R
    s_branch A2_CKk4_K
A2_CKk5_R:
    s_cmp_eq_u32 s41, 0
    s_cbranch_scc1 A2_CKk5_K
    s_sub_u32 s41, s41, 1
    s_mov_b64 exec, s[32:33]
    buffer_load_dwordx4 v[80:83], v1, s[20:23], s9 offen offset:0 sc1
    buffer_load_dwordx4 v[84:87], v1, s[20:23], s9 offen offset:256 sc1
    s_mov_b64 exec, -1
    buffer_load_dwordx4 v[36:39], v1, s[20:23], s7 offen offset:1024 sc1
    s_mov_b64 exec, s[32:33]
    buffer_load_dwordx4 v[88:91], v1, s[20:23], s9 offen offset:1024 sc1
    buffer_load_dwordx4 v[92:95], v1, s[20:23], s9 offen offset:1280 sc1
    s_mov_b64 exec, -1
    buffer_load_dwordx4 v[40:43], v1, s[20:23], s7 offen offset:2048 sc1
    s_mov_b64 exec, s[32:33]
    buffer_load_dwordx4 v[96:99], v1, s[20:23], s9 offen offset:2048 sc1
    buffer_load_dwordx4 v[100:103], v1, s[20:23], s9 offen offset:2304 sc1
    s_mov_b64 exec, -1
    buffer_load_dwordx4 v[44:47], v1, s[20:23], s7 offen offset:3072 sc1
    s_mov_b64 exec, s[32:33]
    buffer_load_dwordx4 v[104:107], v1, s[20:23], s9 offen offset:3072 sc1
    buffer_load_dwordx4 v[108:111], v1, s[20:23], s9 offen offset:3328 sc1
    s_mov_b64 exec, -1
    buffer_load_dwordx4 v[220:223], v1, s[20:23], s14 offen sc1
    s_waitcnt vmcnt(0)
    v_cmp_u_f32 vcc, v36, v38
    s_cbranch_vccnz A2_CKk5_R
    s_branch A2_CKk5_K
A2_CKv4_R:
    s_cmp_eq_u32 s41, 0
    s_cbranch_scc1 A2_CKv4_K
    s_sub_u32 s41, s41, 1
    s_mov_b64 exec, s[32:33]
    buffer_load_dwordx4 v[80:83], v1, s[20:23], s9 offen offset:0 sc1
    buffer_load_dwordx4 v[84:87], v1, s[20:23], s9 offen offset:256 sc1
    s_mov_b64 exec, -1
    s_mov_b64 exec, s[32:33]
    buffer_load_dwordx4 v[88:91], v1, s[20:23], s9 offen offset:1024 sc1
    buffer_load_dwordx4 v[92:95], v1, s[20:23], s9 offen offset:1280 sc1
    s_mov_b64 exec, -1
    buffer_load_dwordx4 v[40:43], v1, s[20:23], s7 offen offset:2048 sc1
    s_mov_b64 exec, s[32:33]
    buffer_load_dwordx4 v[96:99], v1, s[20:23], s9 offen offset:2048 sc1
    buffer_load_dwordx4 v[100:103], v1, s[20:23], s9 offen offset:2304 sc1
    s_mov_b64 exec, -1
    buffer_load_dwordx4 v[44:47], v1, s[20:23], s7 offen offset:3072 sc1
    s_mov_b64 exec, s[32:33]
    buffer_load_dwordx4 v[104:107], v1, s[20:23], s9 offen offset:3072 sc1
    buffer_load_dwordx4 v[108:111], v1, s[20:23], s9 offen offset:3328 sc1
    s_mov_b64 exec, -1
    buffer_load_dwordx4 v[220:223], v1, s[20:23], s14 offen sc1
    s_waitcnt vmcnt(0)
    v_cmp_u_f32 vcc, v80, v82
    s_cbranch_vccnz A2_CKv4_R
    v_cmp_u_f32 vcc, v84, v86
    s_cbranch_vccnz A2_CKv4_R
    s_branch A2_CKv4_K
A2_CKk6_R:
    s_cmp_eq_u32 s41, 0
    s_cbranch_scc1 A2_CKk6_K
    s_sub_u32 s41, s41, 1
    s_mov_b64 exec, s[32:33]
    buffer_load_dwordx4 v[88:91], v1, s[20:23], s9 offen offset:1024 sc1
    buffer_load_dwordx4 v[92:95], v1, s[20:23], s9 offen offset:1280 sc1
    s_mov_b64 exec, -1
    buffer_load_dwordx4 v[40:43], v1, s[20:23], s7 offen offset:2048 sc1
    s_mov_b64 exec, s[32:33]
    buffer_load_dwordx4 v[96:99], v1, s[20:23], s9 offen offset:2048 sc1
    buffer_load_dwordx4 v[100:103], v1, s[20:23], s9 offen offset:2304 sc1
    s_mov_b64 exec, -1
    buffer_load_dwordx4 v[44:47], v1, s[20:23], s7 offen offset:3072 sc1
    s_mov_b64 exec, s[32:33]
    buffer_load_dwordx4 v[104:107], v1, s[20:23], s9 offen offset:3072 sc1
    buffer_load_dwordx4 v[108:111], v1, s[20:23], s9 offen offset:3328 sc1
    s_mov_b64 exec, -1
    buffer_load_dwordx4 v[220:223], v1, s[20:23], s14 offen sc1
    buffer_load_dwordx2 v[232:233], v9, s[20:23], s15 offen offset:0 sc1
    s_waitcnt vmcnt(0)
    v_cmp_u_f32 vcc, v40, v42
    s_cbranch_vccnz A2_CKk6_R
    s_branch A2_CKk6_K
A2_CKv5_R:
    s_cmp_eq_u32 s41, 0
    s_cbranch_scc1 A2_CKv5_K
    s_sub_u32 s41, s41, 1
    s_mov_b64 exec, s[32:33]
    buffer_load_dwordx4 v[88:91], v1, s[20:23], s9 offen offset:1024 sc1
    buffer_load_dwordx4 v[92:95], v1, s[20:23], s9 offen offset:1280 sc1
    s_mov_b64 exec, -1
    s_mov_b64 exec, s[32:33]
    buffer_load_dwordx4 v[96:99], v1, s[20:23], s9 offen offset:2048 sc1
    buffer_load_dwordx4 v[100:103], v1, s[20:23], s9 offen offset:2304 sc1
    s_mov_b64 exec, -1
    buffer_load_dwordx4 v[44:47], v1, s[20:23], s7 offen offset:3072 sc1
    s_mov_b64 exec, s[32:33]
    buffer_load_dwordx4 v[104:107], v1, s[20:23], s9 offen offset:3072 sc1
    buffer_load_dwordx4 v[108:111], v1, s[20:23], s9 offen offset:3328 sc1
    s_mov_b64 exec, -1
    buffer_load_dwordx4 v[220:223], v1, s[20:23], s14 offen sc1
    buffer_load_dwordx2 v[232:233], v9, s[20:23], s15 offen offset:0 sc1
    buffer_load_dwordx2 v[234:235], v9, s[20:23], s15 offen offset:512 sc1
    s_waitcnt vmcnt(0)
    v_cmp_u_f32 vcc, v88, v90
    s_cbranch_vccnz A2_CKv5_R
    v_cmp_u_f32 vcc, v92, v94
    s_cbranch_vccnz A2_CKv5_R
    s_branch A2_CKv5_K
A2_CKk7_R:
    s_cmp_eq_u32 s41, 0
    s_cbranch_scc1 A2_CKk7_K
    s_sub_u32 s41, s41, 1
    s_mov_b64 exec, s[32:33]
    buffer_load_dwordx4 v[96:99], v1, s[20:23], s9 offen offset:2048 sc1
    buffer_load_dwordx4 v[100:103], v1, s[20:23], s9 offen offset:2304 sc1
    s_mov_b64 exec, -1
    buffer_load_dwordx4 v[44:47], v1, s[20:23], s7 offen offset:3072 sc1
    s_mov_b64 exec, s[32:33]
    buffer_load_dwordx4 v[104:107], v1, s[20:23], s9 offen offset:3072 sc1
    buffer_load_dwordx4 v[108:111], v1, s[20:23], s9 offen offset:3328 sc1
    s_mov_b64 exec, -1
    buffer_load_dwordx4 v[220:223], v1, s[20:23], s14 offen sc1
    buffer_load_dwordx2 v[232:233], v9, s[20:23], s15 offen offset:0 sc1
    buffer_load_dwordx2 v[234:235], v9, s[20:23], s15 offen offset:512 sc1
    s_waitcnt vmcnt(0)
    v_cmp_u_f32 vcc, v44, v46
    s_cbranch_vccnz A2_CKk7_R
    s_branch A2_CKk7_K
A2_CKv6_R:
    s_cmp_eq_u32 s41, 0
    s_cbranch_scc1 A2_CKv6_K
    s_sub_u32 s41, s41, 1
    s_mov_b64 exec, s[32:33]
    buffer_load_dwordx4 v[96:99], v1, s[20:23], s9 offen offset:2048 sc1
    buffer_load_dwordx4 v[100:103], v1, s[20:23], s9 offen offset:2304 sc1
    s_mov_b64 exec, -1
    s_mov_b64 exec, s[32:33]
    buffer_load_dwordx4 v[104:107], v1, s[20:23], s9 offen offset:3072 sc1
    buffer_load_dwordx4 v[108:111], v1, s[20:23], s9 offen offset:3328 sc1
    s_mov_b64 exec, -1
    buffer_load_dwordx4 v[220:223], v1, s[20:23], s14 offen sc1
    buffer_load_dwordx2 v[232:233], v9, s[20:23], s15 offen offset:0 sc1
    buffer_load_dwordx2 v[234:235], v9, s[20:23], s15 offen offset:512 sc1
    s_waitcnt vmcnt(0)
    v_cmp_u_f32 vcc, v96, v98
    s_cbranch_vccnz A2_CKv6_R
    v_cmp_u_f32 vcc, v100, v102
    s_cbranch_vccnz A2_CKv6_R
    s_branch A2_CKv6_K
A2_CKv7_R:
    s_cmp_eq_u32 s41, 0
    s_cbranch_scc1 A2_CKv7_K
    s_sub_u32 s41, s41, 1
    s_mov_b64 exec, s[32:33]
    buffer_load_dwordx4 v[104:107], v1, s[20:23], s9 offen offset:3072 sc1
    buffer_load_dwordx4 v[108:111], v1, s[20:23], s9 offen offset:3328 sc1
    s_mov_b64 exec, -1
    buffer_load_dwordx4 v[220:223], v1, s[20:23], s14 offen sc1
    buffer_load_dwordx2 v[232:233], v9, s[20:23], s15 offen offset:0 sc1
    buffer_load_dwordx2 v[234:235], v9, s[20:23], s15 offen offset:512 sc1
    s_waitcnt vmcnt(0)
    v_cmp_u_f32 vcc, v104, v106
    s_cbranch_vccnz A2_CKv7_R
    v_cmp_u_f32 vcc, v108, v110
    s_cbranch_vccnz A2_CKv7_R
    s_branch A2_CKv7_K
A2_CKqd_R:
    s_cmp_eq_u32 s41, 0
    s_cbranch_scc1 A2_CKqd_K
    s_sub_u32 s41, s41, 1
    buffer_load_dwordx4 v[220:223], v1, s[20:23], s14 offen sc1
    buffer_load_dwordx2 v[232:233], v9, s[20:23], s15 offen offset:0 sc1
    buffer_load_dwordx2 v[234:235], v9, s[20:23], s15 offen offset:512 sc1
    s_waitcnt vmcnt(0)
    v_cmp_u_f32 vcc, v220, v222
    s_cbranch_vccnz A2_CKqd_R
    s_branch A2_CKqd_K
A2_CKres_R:
    s_cmp_eq_u32 s41, 0
    s_cbranch_scc1 A2_CKres_K
    s_sub_u32 s41, s41, 1
    buffer_load_dwordx2 v[232:233], v9, s[20:23], s15 offen offset:0 sc1
    buffer_load_dwordx2 v[234:235], v9, s[20:23], s15 offen offset:512 sc1
    s_waitcnt vmcnt(0)
    v_cmp_u_f32 vcc, v232, v234
    s_cbranch_vccnz A2_CKres_R
    s_branch A2_CKres_K
A2_SLOW:
    s_nop 7
    v_mfma_f32_32x32x16_bf16 v[204:219], v[160:163], v[160:163], 0
    buffer_load_dwordx4 v[16:19], v1, s[20:23], s6 offen offset:0 sc1
    buffer_load_dwordx4 v[20:23], v1, s[20:23], s6 offen offset:1024 sc1
    buffer_load_dwordx4 v[24:27], v1, s[20:23], s6 offen offset:2048 sc1
    buffer_load_dwordx4 v[28:31], v1, s[20:23], s6 offen offset:3072 sc1
    buffer_load_dwordx4 v[32:35], v1, s[20:23], s7 offen offset:0 sc1
    buffer_load_dwordx4 v[36:39], v1, s[20:23], s7 offen offset:1024 sc1
    buffer_load_dwordx4 v[40:43], v1, s[20:23], s7 offen offset:2048 sc1
    buffer_load_dwordx4 v[44:47], v1, s[20:23], s7 offen offset:3072 sc1
    v_and_b32 v14, 59, v0
    v_cmp_eq_u32 vcc, 16, v14
    v_mov_b32 v15, 0xbf80bf80
    v_mov_b32 v220, 0xbafebf80
    v_mov_b32 v221, v220
    v_cndmask_b32 v224, 0, v15, vcc
    v_mov_b32 v222, v220
    v_mov_b32 v223, v220
    v_mov_b32 v225, 0
    v_mov_b32 v226, 0
    v_mov_b32 v227, 0
    s_nop 1
    v_mfma_f32_32x32x16_bf16 v[48:63], v[220:223], v[224:227], 0
    s_mov_b64 exec, s[32:33]
    s_nop 10
    buffer_load_dwordx4 v[48:51], v1, s[20:23], s8 offen offset:0 sc1
    buffer_load_dwordx4 v[52:55], v1, s[20:23], s8 offen offset:256 sc1
    s_mov_b64 exec, -1
    s_mov_b64 exec, s[32:33]
    buffer_load_dwordx4 v[56:59], v1, s[20:23], s8 offen offset:1024 sc1
    buffer_load_dwordx4 v[60:63], v1, s[20:23], s8 offen offset:1280 sc1
    s_mov_b64 exec, -1
    s_waitcnt vmcnt(0)
    v_and_b32 v15, 31, v0
    v_lshlrev_b32 v15, 2, v15
    s_lshl_b32 s24, s3, 7
    v_add_u32 v14, s24, v15
    v_mov_b32 v13, v1
    s_mov_b32 s12, 0
A2_S1:
    ds_read_b128 v[168:171], v13 offset:0
    v_mov_b32 v12, 0xff800000
    s_waitcnt lgkmcnt(0)
    v_mfma_f32_32x32x16_bf16 v[112:127], v[16:19], v[168:171], 0
    s_nop 11
    v_max3_f32 v12, v12, v112, v113
    v_max3_f32 v12, v12, v114, v115
    v_max3_f32 v12, v12, v116, v117
    v_max3_f32 v12, v12, v118, v119
    v_max3_f32 v12, v12, v120, v121
    v_max3_f32 v12, v12, v122, v123
    v_max3_f32 v12, v12, v124, v125
    v_max3_f32 v12, v12, v126, v127
    v_mfma_f32_32x32x16_bf16 v[112:127], v[20:23], v[168:171], 0
    s_nop 11
    v_max3_f32 v12, v12, v112, v113
    v_max3_f32 v12, v12, v114, v115
    v_max3_f32 v12, v12, v116, v117
    v_max3_f32 v12, v12, v118, v119
    v_max3_f32 v12, v12, v120, v121
    v_max3_f32 v12, v12, v122, v123
    v_max3_f32 v12, v12, v124, v125
    v_max3_f32 v12, v12, v126, v127
    v_mfma_f32_32x32x16_bf16 v[112:127], v[24:27], v[168:171], 0
    s_nop 11
    v_max3_f32 v12, v12, v112, v113
    v_max3_f32 v12, v12, v114, v115
    v_max3_f32 v12, v12, v116, v117
    v_max3_f32 v12, v12, v118, v119
    v_max3_f32 v12, v12, v120, v121
    v_max3_f32 v12, v12, v122, v123
    v_max3_f32 v12, v12, v124, v125
    v_max3_f32 v12, v12, v126, v127
    v_mfma_f32_32x32x16_bf16 v[112:127], v[28:31], v[168:171], 0
    s_nop 11
    v_max3_f32 v12, v12, v112, v113
    v_max3_f32 v12, v12, v114, v115
    v_max3_f32 v12, v12, v116, v117
    v_max3_f32 v12, v12, v118, v119
    v_max3_f32 v12, v12, v120, v121
    v_max3_f32 v12, v12, v122, v123
    v_max3_f32 v12, v12, v124, v125
    v_max3_f32 v12, v12, v126, v127
    v_mfma_f32_32x32x16_bf16 v[112:127], v[32:35], v[168:171], 0
    s_nop 11
    v_max3_f32 v12, v12, v112, v113
    v_max3_f32 v12, v12, v114, v115
    v_max3_f32 v12, v12, v116, v117
    v_max3_f32 v12, v12, v118, v119
    v_max3_f32 v12, v12, v120, v121
    v_max3_f32 v12, v12, v122, v123
    v_max3_f32 v12, v12, v124, v125
    v_max3_f32 v12, v12, v126, v127
    v_mfma_f32_32x32x16_bf16 v[112:127], v[36:39], v[168:171], 0
    s_nop 11
    v_max3_f32 v12, v12, v112, v113
    v_max3_f32 v12, v12, v114, v115
    v_max3_f32 v12, v12, v116, v117
    v_max3_f32 v12, v12, v118, v119
    v_max3_f32 v12, v12, v120, v121
    v_max3_f32 v12, v12, v122, v123
    v_max3_f32 v12, v12, v124, v125
    v_max3_f32 v12, v12, v126, v127
    v_mfma_f32_32x32x16_bf16 v[112:127], v[40:43], v[168:171], 0
    s_nop 11
    v_max3_f32 v12, v12, v112, v113
    v_max3_f32 v12, v12, v114, v115
    v_max3_f32 v12, v12, v116, v117
    v_max3_f32 v12, v12, v118, v119
    v_max3_f32 v12, v12, v120, v121
    v_max3_f32 v12, v12, v122, v123
    v_max3_f32 v12, v12, v124, v125
    v_max3_f32 v12, v12, v126, v127
    v_mfma_f32_32x32x16_bf16 v[112:127], v[44:47], v[168:171], 0
    s_nop 11
    v_max3_f32 v12, v12, v112, v113
    v_max3_f32 v12, v12, v114, v115
    v_max3_f32 v12, v12, v116, v117
    v_max3_f32 v12, v12, v118, v119
    v_max3_f32 v12, v12, v120, v121
    v_max3_f32 v12, v12, v122, v123
    v_max3_f32 v12, v12, v124, v125
    v_max3_f32 v12, v12, v126, v127
    v_mov_b32 v10, v12
    s_nop 1
    v_permlane32_swap_b32 v10, v12
    v_max_f32 v12, v12, v10
    ds_write_b32 v14, v12 offset:28672
    v_add_u32 v13, 0x400, v13
    v_add_u32 v14, 0x400, v14
    s_add_u32 s12, s12, 1
    s_cmp_lt_u32 s12, 8
    s_cbranch_scc1 A2_S1
    v_mov_b32 v13, v1
    s_sub_u32 s10, s10, 0x70000
    s_sub_u32 s11, s11, 0x70000
    s_mov_b32 s12, 0
    s_waitcnt lgkmcnt(0)
    s_barrier
A2_S2:
    buffer_load_dwordx4 v[172:175], v1, s[20:23], s10 offen offset:0
    buffer_load_dwordx4 v[176:179], v1, s[20:23], s10 offen offset:1024
    buffer_load_dwordx4 v[180:183], v1, s[20:23], s10 offen offset:2048
    buffer_load_dwordx4 v[184:187], v1, s[20:23], s10 offen offset:3072
    buffer_load_dwordx4 v[188:191], v1, s[20:23], s11 offen offset:0
    buffer_load_dwordx4 v[192:195], v1, s[20:23], s11 offen offset:1024
    buffer_load_dwordx4 v[196:199], v1, s[20:23], s11 offen offset:2048
    buffer_load_dwordx4 v[200:203], v1, s[20:23], s11 offen offset:3072
    ds_read_b128 v[168:171], v13 offset:0
    ds_read_b32 v220, v15 offset:28672
    ds_read_b32 v221, v15 offset:28800
    ds_read_b32 v222, v15 offset:28928
    ds_read_b32 v223, v15 offset:29056
    ds_read_b32 v224, v15 offset:29184
    ds_read_b32 v225, v15 offset:29312
    ds_read_b32 v226, v15 offset:29440
    ds_read_b32 v227, v15 offset:29568
    s_waitcnt lgkmcnt(0)
    v_max_f32 v12, v220, v221
    v_max3_f32 v12, v12, v222, v223
    v_max3_f32 v12, v12, v224, v225
    v_max3_f32 v12, v12, v226, v227
    v_sub_f32 v128, 0, v12
    v_sub_f32 v129, 0, v12
    v_sub_f32 v130, 0, v12
    v_sub_f32 v131, 0, v12
    v_sub_f32 v132, 0, v12
    v_sub_f32 v133, 0, v12
    v_sub_f32 v134, 0, v12
    v_sub_f32 v135, 0, v12
    v_sub_f32 v136, 0, v12
    v_sub_f32 v137, 0, v12
    v_sub_f32 v138, 0, v12
    v_sub_f32 v139, 0, v12
    v_sub_f32 v140, 0, v12
    v_sub_f32 v141, 0, v12
    v_sub_f32 v142, 0, v12
    v_sub_f32 v143, 0, v12
    v_mfma_f32_32x32x16_bf16 v[144:159], v[160:163], v[160:163], 0
    s_nop 0
    v_mfma_f32_32x32x16_bf16 v[112:127], v[16:19], v[168:171], v[128:143]
    s_nop 11
    v_exp_f32 v112, v112
    v_exp_f32 v113, v113
    v_exp_f32 v114, v114
    v_exp_f32 v115, v115
    v_exp_f32 v116, v116
    v_exp_f32 v117, v117
    v_exp_f32 v118, v118
    v_exp_f32 v119, v119
    v_exp_f32 v120, v120
    v_exp_f32 v121, v121
    v_exp_f32 v122, v122
    v_exp_f32 v123, v123
    v_exp_f32 v124, v124
    v_exp_f32 v125, v125
    v_exp_f32 v126, v126
    v_exp_f32 v127, v127
    v_smfmac_f32_32x32x32_bf16 v[144:159], v[48:51], v[112:119], v164
    s_nop 0
    v_smfmac_f32_32x32x32_bf16 v[144:159], v[52:55], v[120:127], v164
    v_mfma_f32_32x32x16_bf16 v[112:127], v[20:23], v[168:171], v[128:143]
    s_nop 11
    v_exp_f32 v112, v112
    v_exp_f32 v113, v113
    v_exp_f32 v114, v114
    v_exp_f32 v115, v115
    v_exp_f32 v116, v116
    v_exp_f32 v117, v117
    v_exp_f32 v118, v118
    v_exp_f32 v119, v119
    v_exp_f32 v120, v120
    v_exp_f32 v121, v121
    v_exp_f32 v122, v122
    v_exp_f32 v123, v123
    v_exp_f32 v124, v124
    v_exp_f32 v125, v125
    v_exp_f32 v126, v126
    v_exp_f32 v127, v127
    v_smfmac_f32_32x32x32_bf16 v[144:159], v[56:59], v[112:119], v164
    s_nop 0
    v_smfmac_f32_32x32x32_bf16 v[144:159], v[60:63], v[120:127], v164
    v_mfma_f32_32x32x16_bf16 v[112:127], v[24:27], v[168:171], v[128:143]
    s_nop 11
    v_exp_f32 v112, v112
    v_exp_f32 v113, v113
    v_exp_f32 v114, v114
    v_exp_f32 v115, v115
    v_exp_f32 v116, v116
    v_exp_f32 v117, v117
    v_exp_f32 v118, v118
    v_exp_f32 v119, v119
    v_exp_f32 v120, v120
    v_exp_f32 v121, v121
    v_exp_f32 v122, v122
    v_exp_f32 v123, v123
    v_exp_f32 v124, v124
    v_exp_f32 v125, v125
    v_exp_f32 v126, v126
    v_exp_f32 v127, v127
    v_smfmac_f32_32x32x32_bf16 v[144:159], v[64:67], v[112:119], v164
    s_nop 0
    v_smfmac_f32_32x32x32_bf16 v[144:159], v[68:71], v[120:127], v164
    v_mfma_f32_32x32x16_bf16 v[112:127], v[28:31], v[168:171], v[128:143]
    s_nop 11
    v_exp_f32 v112, v112
    v_exp_f32 v113, v113
    v_exp_f32 v114, v114
    v_exp_f32 v115, v115
    v_exp_f32 v116, v116
    v_exp_f32 v117, v117
    v_exp_f32 v118, v118
    v_exp_f32 v119, v119
    v_exp_f32 v120, v120
    v_exp_f32 v121, v121
    v_exp_f32 v122, v122
    v_exp_f32 v123, v123
    v_exp_f32 v124, v124
    v_exp_f32 v125, v125
    v_exp_f32 v126, v126
    v_exp_f32 v127, v127
    v_smfmac_f32_32x32x32_bf16 v[144:159], v[72:75], v[112:119], v164
    s_nop 0
    v_smfmac_f32_32x32x32_bf16 v[144:159], v[76:79], v[120:127], v164
    v_mfma_f32_32x32x16_bf16 v[112:127], v[32:35], v[168:171], v[128:143]
    s_nop 11
    v_exp_f32 v112, v112
    v_exp_f32 v113, v113
    v_exp_f32 v114, v114
    v_exp_f32 v115, v115
    v_exp_f32 v116, v116
    v_exp_f32 v117, v117
    v_exp_f32 v118, v118
    v_exp_f32 v119, v119
    v_exp_f32 v120, v120
    v_exp_f32 v121, v121
    v_exp_f32 v122, v122
    v_exp_f32 v123, v123
    v_exp_f32 v124, v124
    v_exp_f32 v125, v125
    v_exp_f32 v126, v126
    v_exp_f32 v127, v127
    v_smfmac_f32_32x32x32_bf16 v[144:159], v[80:83], v[112:119], v164
    s_nop 0
    v_smfmac_f32_32x32x32_bf16 v[144:159], v[84:87], v[120:127], v164
    v_mfma_f32_32x32x16_bf16 v[112:127], v[36:39], v[168:171], v[128:143]
    s_nop 11
    v_exp_f32 v112, v112
    v_exp_f32 v113, v113
    v_exp_f32 v114, v114
    v_exp_f32 v115, v115
    v_exp_f32 v116, v116
    v_exp_f32 v117, v117
    v_exp_f32 v118, v118
    v_exp_f32 v119, v119
    v_exp_f32 v120, v120
    v_exp_f32 v121, v121
    v_exp_f32 v122, v122
    v_exp_f32 v123, v123
    v_exp_f32 v124, v124
    v_exp_f32 v125, v125
    v_exp_f32 v126, v126
    v_exp_f32 v127, v127
    v_smfmac_f32_32x32x32_bf16 v[144:159], v[88:91], v[112:119], v164
    s_nop 0
    v_smfmac_f32_32x32x32_bf16 v[144:159], v[92:95], v[120:127], v164
    v_mfma_f32_32x32x16_bf16 v[112:127], v[40:43], v[168:171], v[128:143]
    s_nop 11
    v_exp_f32 v112, v112
    v_exp_f32 v113, v113
    v_exp_f32 v114, v114
    v_exp_f32 v115, v115
    v_exp_f32 v116, v116
    v_exp_f32 v117, v117
    v_exp_f32 v118, v118
    v_exp_f32 v119, v119
    v_exp_f32 v120, v120
    v_exp_f32 v121, v121
    v_exp_f32 v122, v122
    v_exp_f32 v123, v123
    v_exp_f32 v124, v124
    v_exp_f32 v125, v125
    v_exp_f32 v126, v126
    v_exp_f32 v127, v127
    v_smfmac_f32_32x32x32_bf16 v[144:159], v[96:99], v[112:119], v164
    s_nop 0
    v_smfmac_f32_32x32x32_bf16 v[144:159], v[100:103], v[120:127], v164
    v_mfma_f32_32x32x16_bf16 v[112:127], v[44:47], v[168:171], v[128:143]
    s_nop 11
    v_exp_f32 v112, v112
    v_exp_f32 v113, v113
    v_exp_f32 v114, v114
    v_exp_f32 v115, v115
    v_exp_f32 v116, v116
    v_exp_f32 v117, v117
    v_exp_f32 v118, v118
    v_exp_f32 v119, v119
    v_exp_f32 v120, v120
    v_exp_f32 v121, v121
    v_exp_f32 v122, v122
    v_exp_f32 v123, v123
    v_exp_f32 v124, v124
    v_exp_f32 v125, v125
    v_exp_f32 v126, v126
    v_exp_f32 v127, v127
    v_smfmac_f32_32x32x32_bf16 v[144:159], v[104:107], v[112:119], v164
    s_nop 0
    v_smfmac_f32_32x32x32_bf16 v[144:159], v[108:111], v[120:127], v164
    s_nop 11
    ds_write_b128 v4, v[144:147] offset:8192
    ds_write_b128 v4, v[148:151] offset:8224
    ds_write_b32 v5, v152 offset:49152
    s_waitcnt lgkmcnt(0)
    s_barrier
    ds_read_b32 v10, v239 offset:49152
    ds_read2st64_b32 v[220:221], v6 offset0:0 offset1:10
    ds_read2st64_b32 v[222:223], v6 offset0:20 offset1:30
    ds_read2st64_b32 v[224:225], v6 offset0:40 offset1:50
    ds_read2st64_b32 v[226:227], v6 offset0:60 offset1:70
    s_waitcnt lgkmcnt(0)
    v_add_f32 v10, v10, v10 quad_perm:[1,0,3,2] row_mask:0xf bank_mask:0xf
    v_pk_add_f32 v[220:221], v[220:221], v[222:223]
    v_pk_add_f32 v[224:225], v[224:225], v[226:227]
    v_add_f32 v10, v10, v10 quad_perm:[2,3,0,1] row_mask:0xf bank_mask:0xf
    v_pk_add_f32 v[220:221], v[220:221], v[224:225]
    v_add_f32 v220, v220, v221
    v_add_f32 v10, v10, v10 row_half_mirror row_mask:0xf bank_mask:0xf
    v_rcp_f32 v221, v10
    s_nop 0
    v_mul_f32 v220, v220, v221
    v_max3_f32 v238, v238, v10, v221
    v_cvt_pk_bf16_f32 v220, v220, v220
    ds_write_b16 v236, v220 offset:57344
    s_waitcnt lgkmcnt(0)
    s_barrier
    ds_read_b128 v[228:231], v237 offset:57344
    s_waitcnt vmcnt(0) lgkmcnt(0)
    v_smfmac_f32_16x16x64_bf16 v[204:207], v[228:231], v[172:179], v164 abid:1
    v_smfmac_f32_16x16x64_bf16 v[208:211], v[228:231], v[180:187], v164 abid:1
    v_smfmac_f32_16x16x64_bf16 v[212:215], v[228:231], v[188:195], v164 abid:1
    v_smfmac_f32_16x16x64_bf16 v[216:219], v[228:231], v[196:203], v164 abid:1
    v_add_u32 v13, 0x400, v13
    v_add_u32 v15, 0x400, v15
    s_add_u32 s10, s10, 0x10000
    s_add_u32 s11, s11, 0x10000
    s_add_u32 s12, s12, 1
    s_cmp_lt_u32 s12, 8
    s_cbranch_scc1 A2_S2
    v_lshlrev_b32 v112, 16, v232
    v_and_b32 v113, 0xffff0000, v232
    v_lshlrev_b32 v114, 16, v233
    v_and_b32 v115, 0xffff0000, v233
    v_lshlrev_b32 v116, 16, v234
    v_and_b32 v117, 0xffff0000, v234
    v_lshlrev_b32 v118, 16, v235
    v_and_b32 v119, 0xffff0000, v235
    s_nop 7
    s_branch A2_FIN
H2_ZR:
    s_cmp_eq_u32 s41, 0
    s_cbranch_scc1 H2_ZK
    s_sub_u32 s41, s41, 1
    s_mov_b64 exec, vcc
    buffer_load_dwordx4 v[192:195], v236, s[20:23], s12 offen sc1
    buffer_load_dwordx4 v[196:199], v236, s[20:23], s13 offen sc1
    buffer_load_dwordx4 v[200:203], v236, s[20:23], s14 offen sc1
    buffer_load_dwordx4 v[204:207], v236, s[20:23], s15 offen sc1
    s_branch H2_ZW
H2_XR0:
    s_cmp_eq_u32 s41, 0
    s_cbranch_scc1 H2_XK0
    s_sub_u32 s41, s41, 1
    s_add_u32 m0, s43, 0
    s_nop 0
    buffer_load_dwordx4 v240, s[20:23], s32 offen sc1 lds
    s_add_u32 m0, s43, 8192
    s_nop 0
    buffer_load_dwordx4 v240, s[20:23], s33 offen sc1 lds
    s_add_u32 m0, s43, 16384
    s_nop 0
    buffer_load_dwordx4 v240, s[20:23], s34 offen sc1 lds
    s_add_u32 m0, s43, 24576
    s_nop 0
    buffer_load_dwordx4 v240, s[20:23], s35 offen sc1 lds
    s_add_u32 m0, s43, 32768
    s_nop 0
    buffer_load_dwordx4 v240, s[20:23], s36 offen sc1 lds
    s_add_u32 m0, s43, 40960
    s_nop 0
    buffer_load_dwordx4 v240, s[20:23], s37 offen sc1 lds
    s_add_u32 m0, s43, 49152
    s_nop 0
    buffer_load_dwordx4 v240, s[20:23], s38 offen sc1 lds
    s_add_u32 m0, s43, 57344
    s_nop 0
    buffer_load_dwordx4 v240, s[20:23], s39 offen sc1 lds
    s_waitcnt vmcnt(7)
    ds_read_b128 v[192:195], v238 offset:0
    s_waitcnt lgkmcnt(0)
    v_cmp_u_f32 vcc, v192, v194
    s_cbranch_vccnz H2_XR0
    s_branch H2_XK0
H2_XR1:
    s_cmp_eq_u32 s41, 0
    s_cbranch_scc1 H2_XK1
    s_sub_u32 s41, s41, 1
    s_add_u32 m0, s43, 8192
    s_nop 0
    buffer_load_dwordx4 v240, s[20:23], s33 offen sc1 lds
    s_add_u32 m0, s43, 16384
    s_nop 0
    buffer_load_dwordx4 v240, s[20:23], s34 offen sc1 lds
    s_add_u32 m0, s43, 24576
    s_nop 0
    buffer_load_dwordx4 v240, s[20:23], s35 offen sc1 lds
    s_add_u32 m0, s43, 32768
    s_nop 0
    buffer_load_dwordx4 v240, s[20:23], s36 offen sc1 lds
    s_add_u32 m0, s43, 40960
    s_nop 0
    buffer_load_dwordx4 v240, s[20:23], s37 offen sc1 lds
    s_add_u32 m0, s43, 49152
    s_nop 0
    buffer_load_dwordx4 v240, s[20:23], s38 offen sc1 lds
    s_add_u32 m0, s43, 57344
    s_nop 0
    buffer_load_dwordx4 v240, s[20:23], s39 offen sc1 lds
    s_waitcnt vmcnt(6)
    ds_read_b128 v[196:199], v238 offset:8192
    s_waitcnt vmcnt(5)
    ds_read_b128 v[200:203], v238 offset:16384
    s_waitcnt lgkmcnt(0)
    v_max3_u32 v196, v196, v198, v200
    v_cmp_u_f32 vcc, v196, v202
    s_cbranch_vccnz H2_XR1
    s_branch H2_XK1
H2_XR3:
    s_cmp_eq_u32 s41, 0
    s_cbranch_scc1 H2_XK3
    s_sub_u32 s41, s41, 1
    s_add_u32 m0, s43, 24576
    s_nop 0
    buffer_load_dwordx4 v240, s[20:23], s35 offen sc1 lds
    s_add_u32 m0, s43, 32768
    s_nop 0
    buffer_load_dwordx4 v240, s[20:23], s36 offen sc1 lds
    s_add_u32 m0, s43, 40960
    s_nop 0
    buffer_load_dwordx4 v240, s[20:23], s37 offen sc1 lds
    s_add_u32 m0, s43, 49152
    s_nop 0
    buffer_load_dwordx4 v240, s[20:23], s38 offen sc1 lds
    s_add_u32 m0, s43, 57344
    s_nop 0
    buffer_load_dwordx4 v240, s[20:23], s39 offen sc1 lds
    s_waitcnt vmcnt(4)
    ds_read_b128 v[204:207], v238 offset:24576
    s_waitcnt vmcnt(3)
    ds_read_b128 v[208:211], v238 offset:32768
    s_waitcnt lgkmcnt(0)
    v_max3_u32 v204, v204, v206, v208
    v_cmp_u_f32 vcc, v204, v210
    s_cbranch_vccnz H2_XR3
    s_branch H2_XK3
H2_XR5:
    s_cmp_eq_u32 s41, 0
    s_cbranch_scc1 H2_XK5
    s_sub_u32 s41, s41, 1
    s_add_u32 m0, s43, 40960
    s_nop 0
    buffer_load_dwordx4 v240, s[20:23], s37 offen sc1 lds
    s_add_u32 m0, s43, 49152
    s_nop 0
    buffer_load_dwordx4 v240, s[20:23], s38 offen sc1 lds
    s_add_u32 m0, s43, 57344
    s_nop 0
    buffer_load_dwordx4 v240, s[20:23], s39 offen sc1 lds
    s_waitcnt vmcnt(2)
    ds_read_b128 v[212:215], v238 offset:40960
    s_waitcnt vmcnt(1)
    ds_read_b128 v[216:219], v238 offset:49152
    s_waitcnt vmcnt(0)
    ds_read_b128 v[220:223], v238 offset:57344
    s_waitcnt lgkmcnt(0)
    v_max3_u32 v212, v212, v214, v216
    v_max3_u32 v212, v212, v218, v220
    v_cmp_u_f32 vcc, v212, v222
    s_cbranch_vccnz H2_XR5
    s_branch H2_XK5
code_end:
.section .rodata,"a"
.p2align 6
.amdhsa_kernel s0_kernel
  .amdhsa_next_free_vgpr 108
  .amdhsa_next_free_sgpr 96
  .amdhsa_accum_offset 108
  .amdhsa_group_segment_fixed_size 0
  .amdhsa_kernarg_size 88
  .amdhsa_user_sgpr_count 2
  .amdhsa_user_sgpr_kernarg_segment_ptr 1
  .amdhsa_system_sgpr_workgroup_id_x 1
.end_amdhsa_kernel
.p2align 6
.amdhsa_kernel m_kernel
  .amdhsa_next_free_vgpr 256
  .amdhsa_next_free_sgpr 64
  .amdhsa_accum_offset 256
  .amdhsa_group_segment_fixed_size 0
  .amdhsa_kernarg_size 88
  .amdhsa_user_sgpr_count 2
  .amdhsa_user_sgpr_kernarg_segment_ptr 1
  .amdhsa_system_sgpr_workgroup_id_x 1
.end_amdhsa_kernel
```
